```python
import torch

def _softmax(x, axis=-1):
    return torch.softmax(x, dim=axis)
def _gelu(x):
    return torch.nn.functional.gelu(x, approximate="tanh")
def _silu(x):
    return torch.nn.functional.silu(x)
def _sigmoid(x):
    return torch.sigmoid(x)
def _layernorm(x, axis=-1, eps=1e-5):
    m = x.mean(dim=axis, keepdim=True)
    v = x.var(dim=axis, keepdim=True, unbiased=False)
    return (x - m) / torch.sqrt(v + eps)
def _scatter_add(tgt, idx, src, axis=0):
    return tgt.clone().index_add_(axis, idx, src)
def _segment_sum(src, seg, n):
    out = torch.zeros((n,) + src.shape[1:], dtype=src.dtype)
    return out.index_add_(0, seg, src)
def _pad(x, pw):
    flat = tuple(v for pair in reversed(pw) for v in pair)
    return torch.nn.functional.pad(x, flat)

kernel_name = 'interleave_layers__sliding_local_dilated__mixer_s_mlp__prompt'

def setup_inputs():

    _w = (lambda a: (lambda t: t.to(torch.bfloat16) if t.is_floating_point() else t)(torch.as_tensor(a)))
    def _A_setup():
        B, S, D = 1, 2048, 512
        return {
            "x": _w((lambda *s: torch.randn(*s, dtype=torch.bfloat16) * 0.05)(B, S, D)),
            "wqkv": _w((lambda *s: torch.randn(*s, dtype=torch.bfloat16) * 0.1)(D, 3 * D)),
            "wo": _w((lambda *s: torch.randn(*s, dtype=torch.bfloat16) * 0.1)(D, D)),
        }
    _A_in = _A_setup()

    def _B_setup():
        B, S, D, F = 1, 2048, 512, 1792
        return {
            "x":  _w((lambda *s: torch.randn(*s, dtype=torch.bfloat16) * 0.05)(B, S, D)),
            "w1": _w((lambda *s: torch.randn(*s, dtype=torch.bfloat16) * 3.2)(D, D) * (D ** -0.5)),
            "w2": _w((lambda *s: torch.randn(*s, dtype=torch.bfloat16) * 3.2)(D, D) * (D ** -0.5)),
            "w3": _w((lambda *s: torch.randn(*s, dtype=torch.bfloat16) * 3.2)(D, F) * (D ** -0.5)),
            "w4": _w((lambda *s: torch.randn(*s, dtype=torch.bfloat16) * 3.2)(F, D) * (F ** -0.5)),
        }
    _B_in = _B_setup()

    return {
        "A_x": _A_in["x"],
        "A_wqkv": _A_in["wqkv"],
        "A_wo": _A_in["wo"],
        "B_x": _B_in["x"],
        "B_w1": _B_in["w1"],
        "B_w2": _B_in["w2"],
        "B_w3": _B_in["w3"],
        "B_w4": _B_in["w4"],
    }

def reference(A_x, A_wqkv, A_wo, B_x, B_w1, B_w2, B_w3, B_w4):
    def _A_ref(x, wqkv, wo):
        B, S, D = x.shape
        H = 32; Dh = D // H
        W, dil = 8, 2
        qkv = (lambda x, *d: x.permute(*d))((x @ wqkv).reshape(B, S, 3, H, Dh), 2, 0, 3, 1, 4)
        q, k, v = qkv[0], qkv[1], qkv[2]
        scale = Dh ** -0.5
        pos = torch.arange(S)
        off = torch.arange(W) * dil
        idx = pos[:, None] - off[None, :]
        mask = idx >= 0
        idx_c = torch.where(mask, idx, 0).reshape(-1)
        kg = k[:, :, idx_c, :].reshape(B, H, S, W, Dh)
        vg = v[:, :, idx_c, :].reshape(B, H, S, W, Dh)
        logits = torch.einsum("bhsd,bhswd->bhsw", q, kg) * scale
        logits = torch.where(mask[None, None, :, :], logits, -1e9)
        attn = _softmax(logits, axis=-1)
        o = torch.einsum("bhsw,bhswd->bhsd", attn, vg)
        return (lambda x, *d: x.permute(*d))(o, 0, 2, 1, 3).reshape(B, S, D) @ wo

    def _B_ref(x, w1, w2, w3, w4):
        B, S, D = x.shape
        h = _gelu(_layernorm(x, axis=-1) @ w1)
        c = D // 4
        g0 = _pad(h[:, :, 0*c:1*c], ((0, 0), (1, 0), (0, 0)))[:, :S, :]
        g1 = _pad(h[:, :, 1*c:2*c], ((0, 0), (0, 1), (0, 0)))[:, 1:, :]
        g2 = _pad(h[:, :, 2*c:3*c], ((0, 0), (2, 0), (0, 0)))[:, :S, :]
        g3 = _pad(h[:, :, 3*c:   ], ((0, 0), (0, 2), (0, 0)))[:, 2:, :]
        hs = torch.concatenate([g0, g1, g2, g3], axis=-1) @ w2
        x1 = x + hs
        h2 = _gelu(_layernorm(x1, axis=-1) @ w3) @ w4
        return x1 + h2

    x = A_x
    x = x + _A_ref(_layernorm(x, axis=-1), A_wqkv, A_wo)
    x = x + _B_ref(_layernorm(x, axis=-1), B_w1, B_w2, B_w3, B_w4)
    x = x + _A_ref(_layernorm(x, axis=-1), A_wqkv, A_wo)
    x = x + _B_ref(_layernorm(x, axis=-1), B_w1, B_w2, B_w3, B_w4)
    return x
```

```asm
; @launch grid=(256,1,1) block=(256,1,1) lds=163840
.amdgcn_target "amdgcn-amd-amdhsa--gfx950"
.text
.globl interleave_layers__sliding_local_dilated__mixer_s_mlp__prompt_kernel
.p2align 8
.type interleave_layers__sliding_local_dilated__mixer_s_mlp__prompt_kernel,@function
interleave_layers__sliding_local_dilated__mixer_s_mlp__prompt_kernel:
s_cmp_ge_u32 s2, 256
s_cbranch_scc1 BAIL
s_load_dwordx16 s[64:79], s[0:1], 0
s_load_dwordx4 s[88:91], s[0:1], 64
s_load_dwordx2 s[92:93], s[0:1], 80
v_lshrrev_b32 v2, 6, v0
v_and_b32 v0, 63, v0
s_lshr_b32 s41, s2, 3
v_lshl_add_u32 v56, s41, 2, v2
v_lshl_add_u32 v56, v0, 7, v56
v_lshlrev_b32 v56, 7, v56
s_getpc_b64 s[94:95]
PC_1:
s_add_u32 s94, s94, PH0-PC_1
s_addc_u32 s95, s95, 0
v_min_u32 v11, PH13-PH0-4, v56
s_mov_b64 exec, 31
global_load_dword v54, v11, s[94:95]
s_mov_b64 exec, -1
v_lshl_add_u32 v78, s2, 2, v2
v_lshlrev_b32 v81, 7, v0
v_lshl_add_u32 v79, v78, 11, v81
v_lshl_add_u32 v80, v78, 9, v81
v_lshl_add_u32 v78, v78, 10, v80
PH0:
s_waitcnt lgkmcnt(0)
s_mov_b64 exec, 0xfff
global_load_dword v54, v78, s[66:67]
s_mov_b64 exec, 0xffff
global_load_dword v54, v79, s[64:65]
s_mov_b64 exec, 15
s_mov_b64 exec, -1
v_mov_b32 v42, v80
s_mov_b64 exec, -1
v_readfirstlane_b32 s34, v2
s_and_b32 s40, s2, 7
s_and_b32 s33, s41, 7
s_lshr_b32 s41, s41, 3
s_lshl_b32 s40, s40, 2
s_add_u32 s32, s40, s41
s_lshl_b32 s35, s32, 2
s_add_u32 s35, s35, s34
v_lshlrev_b32 v1, 4, v0
v_and_b32 v70, 15, v0
v_lshrrev_b32 v71, 4, v0
s_lshl_b32 s50, s35, 14
v_lshrrev_b32 v72, 2, v0
v_lshlrev_b32 v232, 10, v72
v_sub_u32 v72, 0, v71
v_xor_b32 v72, v72, v0
v_and_b32 v72, 3, v72
v_lshl_add_u32 v232, v72, 4, v232
v_lshrrev_b32 v72, 3, v0
v_mul_u32_u24 v230, 3072, v72
v_and_b32 v72, 2, v72
s_and_b32 s58, s34, 1
s_lshl_b32 s58, s58, 2
v_or_b32 v72, s58, v72
v_and_b32 v73, 7, v0
v_xor_b32 v72, v72, v73
v_lshl_add_u32 v230, v72, 4, v230
s_lshl_b32 s58, s33, 7
s_mul_i32 s59, s34, 24576
s_add_u32 s58, s58, s59
v_add_u32 v230, s58, v230
s_mov_b32 s80, s66
s_mov_b32 s81, s67
s_mov_b32 s82, 0x180000
s_mov_b32 s83, 0x20000
s_mov_b32 s12, s72
s_mov_b32 s13, s73
s_mov_b32 s14, 0x80000
s_mov_b32 s15, 0x20000
s_mov_b32 s16, s74
s_mov_b32 s17, s75
s_mov_b32 s18, 0x80000
s_mov_b32 s19, 0x20000
s_mov_b32 s20, s64
s_mov_b32 s21, s65
s_mov_b32 s22, 0x200000
s_mov_b32 s23, 0x20000
s_lshl_b32 s73, s34, 10
s_lshl_b32 s74, s34, 12
s_lshl_b32 s75, s34, 13
s_add_u32 m0, s73, 0
s_mov_b32 s48, 0
buffer_load_dwordx4 v230, s[80:83], s48 offen lds
s_add_u32 m0, s73, 4096
s_mov_b32 s48, 98304
buffer_load_dwordx4 v230, s[80:83], s48 offen lds
s_add_u32 m0, s73, 8192
s_mov_b32 s48, 196608
buffer_load_dwordx4 v230, s[80:83], s48 offen lds
s_add_u32 m0, s73, 12288
s_mov_b32 s48, 294912
buffer_load_dwordx4 v230, s[80:83], s48 offen lds
s_add_u32 m0, s74, 65536
s_add_u32 s48, s50, 0
buffer_load_dwordx4 v232, s[20:23], s48 offen lds
s_add_u32 m0, s74, 66560
s_add_u32 s48, s50, 64
buffer_load_dwordx4 v232, s[20:23], s48 offen lds
s_add_u32 m0, s74, 67584
s_add_u32 s48, s50, 128
buffer_load_dwordx4 v232, s[20:23], s48 offen lds
s_add_u32 m0, s74, 68608
s_add_u32 s48, s50, 192
buffer_load_dwordx4 v232, s[20:23], s48 offen lds
v_lshrrev_b32 v11, 7, v56
v_mul_u32_u24 v11, 3072, v11
s_mov_b32 s48, 393600
s_mov_b64 exec, 7
buffer_load_dword v54, v11, s[80:83], s48 offen offset:0
buffer_load_dword v54, v11, s[80:83], s48 offen offset:1024
buffer_load_dword v54, v11, s[80:83], s48 offen offset:2048
s_mov_b64 exec, -1
v_lshrrev_b32 v72, 2, v70
v_and_b32 v73, 3, v0
s_lshr_b32 s3, s2, 2
s_xor_b32 s3, s3, s2
s_and_b32 s3, s3, 2
s_mul_i32 s3, s3, 5
s_xor_b32 s3, s3, s2
s_cmp_ge_u32 s3, 112
s_cbranch_scc1 JOB4_2
s_mov_b32 s84, s76
s_mov_b32 s85, s77
s_mov_b32 s86, 0x1c0000
s_mov_b32 s96, 3584
s_mov_b32 s97, 3
s_and_b32 s40, s3, 1
s_lshr_b32 s41, s3, 1
s_mul_i32 s58, s41, 9363
s_lshr_b32 s58, s58, 16
s_add_u32 s58, s58, s41
s_lshl_b32 s58, s58, 15
s_lshl_b32 s59, s40, 14
s_add_u32 s58, s58, s59
s_add_u32 s58, s58, s74
s_mul_i32 s58, s58, 1
s_add_u32 s78, s58, 0x180000
s_lshl_b32 s58, s40, 13
s_add_u32 s79, s58, 0x540000
v_lshrrev_b32 v74, 1, v71
v_lshl_add_u32 v235, v74, 2, v72
v_lshlrev_b32 v235, 1, v235
v_and_b32 v74, 1, v71
v_or_b32 v235, v235, v74
s_branch JOBS_4
JOB4_2:
s_cmp_ge_u32 s3, 224
s_cbranch_scc1 JOB1_3
s_mov_b32 s84, s78
s_mov_b32 s85, s79
s_mov_b32 s86, 0x1c0000
s_mov_b32 s96, 1024
s_mov_b32 s97, 4
s_sub_u32 s58, s3, 112
s_lshr_b32 s40, s58, 4
s_and_b32 s41, s58, 15
s_lshr_b32 s58, s41, 1
s_xor_b32 s58, s58, s41
s_and_b32 s58, s58, 1
s_mul_i32 s58, s58, 3
s_xor_b32 s41, s41, s58
s_lshr_b32 s58, s41, 1
s_mul_i32 s58, s58, 224
s_and_b32 s59, s41, 1
s_lshl_b32 s59, s59, 1
s_add_u32 s58, s58, s59
s_mov_b32 s94, 0x43a29180
s_mov_b32 s95, 0x7d6c5b
s_lshl_b32 s59, s40, 2
s_add_u32 s59, s59, s34
s_lshl_b32 s59, s59, 1
s_add_u32 s59, s59, 0
s_mul_i32 s60, s59, 4682
s_lshr_b32 s60, s60, 16
s_mul_i32 s60, s60, 14
s_sub_u32 s59, s59, s60
s_lshl_b32 s59, s59, 2
s_lshr_b64 s[62:63], s[94:95], s59
s_and_b32 s62, s62, 15
s_add_u32 s60, s60, s62
s_lshl_b32 s60, s60, 2
s_add_u32 s60, s60, s58
s_mul_i32 s60, s60, 1024
s_add_u32 s78, s60, 0x380000
s_lshl_b32 s59, s40, 2
s_add_u32 s59, s59, s34
s_lshl_b32 s59, s59, 1
s_add_u32 s59, s59, 1
s_mul_i32 s60, s59, 4682
s_lshr_b32 s60, s60, 16
s_mul_i32 s60, s60, 14
s_sub_u32 s59, s59, s60
s_lshl_b32 s59, s59, 2
s_lshr_b64 s[62:63], s[94:95], s59
s_and_b32 s62, s62, 15
s_add_u32 s60, s60, s62
s_lshl_b32 s60, s60, 2
s_add_u32 s60, s60, s58
s_mul_i32 s60, s60, 1024
s_add_u32 s99, s60, 0x380000
s_mov_b32 s79, 0x545000
v_lshrrev_b32 v74, 1, v71
v_lshl_add_u32 v235, v74, 4, v72
v_and_b32 v74, 1, v71
v_lshl_add_u32 v235, v74, 2, v235
v_lshlrev_b32 v235, 1, v235
s_branch JOBS_4
JOB1_3:
s_mov_b32 s84, s12
s_mov_b32 s85, s13
s_mov_b32 s86, 0x80000
s_mov_b32 s96, 1024
s_mov_b32 s97, 1
s_sub_u32 s58, s3, 224
s_and_b32 s40, s58, 1
s_lshr_b32 s41, s58, 1
s_mov_b32 s78, 0
s_lshl_b32 s58, s40, 11
s_add_u32 s79, s58, 0x544000
v_lshl_add_u32 v235, v71, 2, v72
v_lshlrev_b32 v235, 1, v235
JOBS_4:
s_mov_b32 s87, 0x20000
v_lshlrev_b32 v235, 5, v235
v_lshl_add_u32 v235, v73, 3, v235
s_add_u32 s58, s74, 114688
v_add_u32 v235, s58, v235
s_lshl_b32 s58, s41, 7
s_add_u32 s79, s79, s58
s_lshl_b32 s40, s40, 8
s_lshl_b32 s58, s34, 6
s_add_u32 s40, s40, s58
s_mul_i32 s40, s40, s96
s_lshl_b32 s41, s41, 6
s_add_u32 s98, s40, s41
v_lshrrev_b32 v74, 2, v0
v_mul_lo_u32 v234, v74, s96
v_lshl_add_u32 v234, v73, 4, v234
s_lshl_b32 s96, s96, 4
s_mov_b32 s8, s68
s_mov_b32 s9, s69
s_mov_b32 s10, 0x80000
s_mov_b32 s11, 0x20000
s_mov_b32 s4, s92
s_mov_b32 s5, s93
s_mov_b32 s6, 0x4000000
s_mov_b32 s7, 0x20000
s_mov_b32 s24, s88
s_mov_b32 s25, s89
s_mov_b32 s26, 0x200000
s_mov_b32 s27, 0x20000
s_mov_b32 s28, s90
s_mov_b32 s29, s91
s_mov_b32 s30, 0x100
s_mov_b32 s31, 0x20000
s_mov_b32 s39, 0x80000
s_lshl_b32 s58, s33, 2
s_add_u32 s58, s58, s34
s_cmp_lg_u32 s58, 3
s_cbranch_scc1 CLR_5
v_mov_b32 v11, 0
v_lshlrev_b32 v240, 2, v0
s_lshl_b32 s58, s32, 8
s_add_u32 s58, s58, 0x549000
buffer_store_dword v11, v240, s[4:7], s58 offen sc1
v_and_b32 v240, 127, v240
s_lshl_b32 s58, s32, 7
s_add_u32 s58, s58, 0x548000
buffer_store_dword v11, v240, s[4:7], s58 offen sc1
s_add_u32 s58, s58, 0x3000
buffer_store_dword v11, v240, s[4:7], s58 offen sc1
CLR_5:
v_lshrrev_b32 v72, 2, v70
v_lshl_add_u32 v73, v71, 2, v72
v_lshrrev_b32 v74, 1, v73
v_and_b32 v74, 3, v74
v_lshlrev_b32 v73, 7, v73
v_and_b32 v72, 3, v0
v_lshl_add_u32 v73, v72, 3, v73
v_lshl_add_u32 v231, v71, 9, v73
v_xor_b32 v72, s34, v74
v_lshl_add_u32 v231, v72, 5, v231
v_xor_b32 v72, 0, v74
v_lshl_add_u32 v2, v72, 5, v73
v_xor_b32 v72, 1, v74
v_lshl_add_u32 v3, v72, 5, v73
v_xor_b32 v72, 2, v74
v_lshl_add_u32 v4, v72, 5, v73
v_xor_b32 v72, 3, v74
v_lshl_add_u32 v5, v72, 5, v73
s_cmp_eq_u32 s32, 0
s_cselect_b32 s58, 0x80000000, 0
v_cmp_lt_u32 vcc, 23, v0
s_nop 1
v_cndmask_b32 v50, 0, 0, vcc
v_lshl_add_u32 v50, v50, 1, v1
v_add_u32 v233, s58, v232
s_lshl_b32 s58, s32, 2
s_max_u32 s58, s58, 1
s_sub_u32 s58, s58, 1
s_lshl_b32 s53, s58, 14
s_lshl_b32 s54, s58, 10
s_lshl_b32 s61, s34, 8
s_add_u32 s61, s61, s53
PH1:
v_and_b32 v250, 15, v0
v_lshlrev_b32 v250, 2, v250
v_and_b32 v251, 48, v0
v_lshrrev_b32 v166, 2, v0
v_sub_u32 v166, 0, v166
v_lshrrev_b32 v167, 4, v0
v_xor_b32 v166, v166, v167
v_and_b32 v166, 3, v166
v_lshlrev_b32 v166, 4, v166
v_lshl_add_u32 v249, v250, 4, v166
v_add_u32 v249, 65536, v249
v_add_u32 v250, 147456, v250
s_add_u32 m0, s74, 131072
s_add_u32 s48, s61, 0
buffer_load_dwordx4 v233, s[20:23], s48 offen lds
v_add_u32 v251, 147456, v251
v_mov_b32 v186, 0x3f803f80
v_mov_b32 v187, 0x3f803f80
v_mov_b32 v188, 0x3f803f80
v_mov_b32 v189, 0x3f803f80
s_add_u32 m0, s74, 132096
s_add_u32 s48, s61, 64
buffer_load_dwordx4 v233, s[20:23], s48 offen lds
s_add_u32 m0, s74, 133120
s_add_u32 s48, s61, 128
buffer_load_dwordx4 v233, s[20:23], s48 offen lds
s_add_u32 m0, s74, 134144
s_add_u32 s48, s61, 192
buffer_load_dwordx4 v233, s[20:23], s48 offen lds
s_add_u32 m0, s74, 81920
s_add_u32 s48, s50, 256
buffer_load_dwordx4 v232, s[20:23], s48 offen lds
s_add_u32 m0, s74, 82944
s_add_u32 s48, s50, 320
buffer_load_dwordx4 v232, s[20:23], s48 offen lds
s_add_u32 m0, s74, 83968
s_add_u32 s48, s50, 384
buffer_load_dwordx4 v232, s[20:23], s48 offen lds
s_add_u32 m0, s74, 84992
s_add_u32 s48, s50, 448
buffer_load_dwordx4 v232, s[20:23], s48 offen lds
s_add_u32 m0, s74, 98304
s_add_u32 s48, s50, 512
buffer_load_dwordx4 v232, s[20:23], s48 offen lds
s_add_u32 m0, s74, 99328
s_add_u32 s48, s50, 576
buffer_load_dwordx4 v232, s[20:23], s48 offen lds
s_add_u32 m0, s74, 100352
s_add_u32 s48, s50, 640
buffer_load_dwordx4 v232, s[20:23], s48 offen lds
s_add_u32 m0, s74, 101376
s_add_u32 s48, s50, 704
buffer_load_dwordx4 v232, s[20:23], s48 offen lds
s_add_u32 m0, s73, 16384
s_mov_b32 s48, 1024
buffer_load_dwordx4 v230, s[80:83], s48 offen lds
s_add_u32 m0, s73, 20480
s_mov_b32 s48, 99328
buffer_load_dwordx4 v230, s[80:83], s48 offen lds
s_add_u32 m0, s73, 24576
s_mov_b32 s48, 197632
buffer_load_dwordx4 v230, s[80:83], s48 offen lds
s_add_u32 m0, s73, 28672
s_mov_b32 s48, 295936
buffer_load_dwordx4 v230, s[80:83], s48 offen lds
s_add_u32 m0, s73, 32768
s_mov_b32 s48, 2048
buffer_load_dwordx4 v230, s[80:83], s48 offen lds
s_add_u32 m0, s73, 36864
s_mov_b32 s48, 100352
buffer_load_dwordx4 v230, s[80:83], s48 offen lds
s_add_u32 m0, s73, 40960
s_mov_b32 s48, 198656
buffer_load_dwordx4 v230, s[80:83], s48 offen lds
s_add_u32 m0, s73, 45056
s_mov_b32 s48, 296960
buffer_load_dwordx4 v230, s[80:83], s48 offen lds
v_add_u32 v238, s74, v249
v_add_u32 v169, 65536, v249
s_waitcnt vmcnt(27)
s_waitcnt vmcnt(16)
s_barrier
ds_read_b64_tr_b16 a[0:1], v231 offset:0
ds_read_b64_tr_b16 a[2:3], v231 offset:512
ds_read_b64_tr_b16 a[12:13], v231 offset:4096
ds_read_b64_tr_b16 a[14:15], v231 offset:4608
ds_read_b64_tr_b16 a[24:25], v231 offset:8192
ds_read_b64_tr_b16 a[26:27], v231 offset:8704
ds_read_b64_tr_b16 a[36:37], v231 offset:12288
ds_read_b64_tr_b16 a[38:39], v231 offset:12800
ds_read_b128 v[114:117], v169 offset:0
ds_read_b128 v[118:121], v169 offset:1024
ds_read_b128 v[122:125], v169 offset:2048
ds_read_b128 v[126:129], v169 offset:3072
s_waitcnt lgkmcnt(3)
v_mfma_f32_16x16x32_bf16 v[206:209], v[186:189], v[114:117], 0
ds_read_b128 v[130:133], v169 offset:4096
v_mfma_f32_16x16x32_bf16 v[210:213], v[114:117], v[114:117], 0
s_add_u32 m0, s73, 49152
s_mov_b32 s48, 393216
buffer_load_dwordx4 v230, s[80:83], s48 offen lds
s_waitcnt lgkmcnt(3)
v_mfma_f32_16x16x32_bf16 v[206:209], v[186:189], v[118:121], v[206:209]
ds_read_b128 v[134:137], v169 offset:5120
v_mfma_f32_16x16x32_bf16 v[210:213], v[118:121], v[118:121], v[210:213]
s_add_u32 m0, s73, 53248
s_mov_b32 s48, 491520
buffer_load_dwordx4 v230, s[80:83], s48 offen lds
s_waitcnt lgkmcnt(3)
v_mfma_f32_16x16x32_bf16 v[206:209], v[186:189], v[122:125], v[206:209]
ds_read_b128 v[138:141], v169 offset:6144
v_mfma_f32_16x16x32_bf16 v[210:213], v[122:125], v[122:125], v[210:213]
s_add_u32 m0, s73, 57344
s_mov_b32 s48, 589824
buffer_load_dwordx4 v230, s[80:83], s48 offen lds
s_waitcnt lgkmcnt(3)
v_mfma_f32_16x16x32_bf16 v[206:209], v[186:189], v[126:129], v[206:209]
ds_read_b128 v[142:145], v169 offset:7168
v_mfma_f32_16x16x32_bf16 v[210:213], v[126:129], v[126:129], v[210:213]
s_add_u32 m0, s73, 61440
s_mov_b32 s48, 688128
buffer_load_dwordx4 v230, s[80:83], s48 offen lds
s_waitcnt lgkmcnt(3)
v_mfma_f32_16x16x32_bf16 v[206:209], v[186:189], v[130:133], v[206:209]
ds_read_b128 v[114:117], v169 offset:8192
v_mfma_f32_16x16x32_bf16 v[210:213], v[130:133], v[130:133], v[210:213]
s_add_u32 m0, s74, 114688
s_nop 0
buffer_load_dwordx4 v234, s[84:87], s98 offen lds
s_add_u32 s98, s98, s96
s_waitcnt lgkmcnt(3)
v_mfma_f32_16x16x32_bf16 v[206:209], v[186:189], v[134:137], v[206:209]
ds_read_b128 v[118:121], v169 offset:9216
v_mfma_f32_16x16x32_bf16 v[210:213], v[134:137], v[134:137], v[210:213]
s_add_u32 m0, s74, 115712
s_nop 0
buffer_load_dwordx4 v234, s[84:87], s98 offen lds
s_add_u32 s98, s98, s96
s_waitcnt lgkmcnt(3)
v_mfma_f32_16x16x32_bf16 v[206:209], v[186:189], v[138:141], v[206:209]
ds_read_b128 v[122:125], v169 offset:10240
v_mfma_f32_16x16x32_bf16 v[210:213], v[138:141], v[138:141], v[210:213]
s_add_u32 m0, s74, 116736
s_nop 0
buffer_load_dwordx4 v234, s[84:87], s98 offen lds
s_add_u32 s98, s98, s96
s_waitcnt lgkmcnt(3)
v_mfma_f32_16x16x32_bf16 v[206:209], v[186:189], v[142:145], v[206:209]
ds_read_b128 v[126:129], v169 offset:11264
v_mfma_f32_16x16x32_bf16 v[210:213], v[142:145], v[142:145], v[210:213]
s_add_u32 m0, s74, 117760
s_nop 0
buffer_load_dwordx4 v234, s[84:87], s98 offen lds
s_add_u32 s98, s98, s96
s_waitcnt lgkmcnt(3)
v_mfma_f32_16x16x32_bf16 v[206:209], v[186:189], v[114:117], v[206:209]
ds_read_b128 v[130:133], v169 offset:12288
v_mfma_f32_16x16x32_bf16 v[210:213], v[114:117], v[114:117], v[210:213]
s_waitcnt lgkmcnt(3)
v_mfma_f32_16x16x32_bf16 v[206:209], v[186:189], v[118:121], v[206:209]
ds_read_b128 v[134:137], v169 offset:13312
v_mfma_f32_16x16x32_bf16 v[210:213], v[118:121], v[118:121], v[210:213]
s_waitcnt lgkmcnt(3)
v_mfma_f32_16x16x32_bf16 v[206:209], v[186:189], v[122:125], v[206:209]
ds_read_b128 v[138:141], v169 offset:14336
v_mfma_f32_16x16x32_bf16 v[210:213], v[122:125], v[122:125], v[210:213]
s_waitcnt lgkmcnt(3)
v_mfma_f32_16x16x32_bf16 v[206:209], v[186:189], v[126:129], v[206:209]
ds_read_b128 v[142:145], v169 offset:15360
v_mfma_f32_16x16x32_bf16 v[210:213], v[126:129], v[126:129], v[210:213]
s_waitcnt lgkmcnt(3)
v_mfma_f32_16x16x32_bf16 v[206:209], v[186:189], v[130:133], v[206:209]
v_mfma_f32_16x16x32_bf16 v[210:213], v[130:133], v[130:133], v[210:213]
s_waitcnt lgkmcnt(2)
v_mfma_f32_16x16x32_bf16 v[206:209], v[186:189], v[134:137], v[206:209]
v_mfma_f32_16x16x32_bf16 v[210:213], v[134:137], v[134:137], v[210:213]
s_waitcnt lgkmcnt(1)
v_mfma_f32_16x16x32_bf16 v[206:209], v[186:189], v[138:141], v[206:209]
v_mfma_f32_16x16x32_bf16 v[210:213], v[138:141], v[138:141], v[210:213]
s_waitcnt lgkmcnt(0)
v_mfma_f32_16x16x32_bf16 v[206:209], v[186:189], v[142:145], v[206:209]
v_mfma_f32_16x16x32_bf16 v[210:213], v[142:145], v[142:145], v[210:213]
s_waitcnt vmcnt(12)
s_barrier
ds_read_b64_tr_b16 a[4:5], v231 offset:16384
ds_read_b64_tr_b16 a[6:7], v231 offset:16896
ds_read_b64_tr_b16 a[16:17], v231 offset:20480
ds_read_b64_tr_b16 a[18:19], v231 offset:20992
ds_read_b64_tr_b16 a[28:29], v231 offset:24576
ds_read_b64_tr_b16 a[30:31], v231 offset:25088
ds_read_b64_tr_b16 a[40:41], v231 offset:28672
ds_read_b64_tr_b16 a[42:43], v231 offset:29184
ds_read_b128 v[114:117], v238 offset:0
ds_read_b128 v[118:121], v238 offset:1024
ds_read_b128 v[122:125], v238 offset:2048
ds_read_b128 v[126:129], v238 offset:3072
s_waitcnt lgkmcnt(3)
v_mfma_f32_16x16x32_bf16 v[198:201], v[186:189], v[114:117], 0
ds_read_b128 v[130:133], v238 offset:16384
v_mfma_f32_16x16x32_bf16 v[202:205], v[114:117], v[114:117], 0
s_add_u32 m0, s73, 0
s_mov_b32 s48, 394240
buffer_load_dwordx4 v230, s[80:83], s48 offen lds
s_waitcnt lgkmcnt(3)
v_mfma_f32_16x16x32_bf16 v[198:201], v[186:189], v[118:121], v[198:201]
ds_read_b128 v[134:137], v238 offset:17408
v_mfma_f32_16x16x32_bf16 v[202:205], v[118:121], v[118:121], v[202:205]
s_add_u32 m0, s73, 4096
s_mov_b32 s48, 492544
buffer_load_dwordx4 v230, s[80:83], s48 offen lds
s_waitcnt lgkmcnt(3)
v_mfma_f32_16x16x32_bf16 v[198:201], v[186:189], v[122:125], v[198:201]
ds_read_b128 v[138:141], v238 offset:18432
v_mfma_f32_16x16x32_bf16 v[202:205], v[122:125], v[122:125], v[202:205]
s_add_u32 m0, s73, 8192
s_mov_b32 s48, 590848
buffer_load_dwordx4 v230, s[80:83], s48 offen lds
s_waitcnt lgkmcnt(3)
v_mfma_f32_16x16x32_bf16 v[198:201], v[186:189], v[126:129], v[198:201]
ds_read_b128 v[142:145], v238 offset:19456
v_mfma_f32_16x16x32_bf16 v[202:205], v[126:129], v[126:129], v[202:205]
s_add_u32 m0, s73, 12288
s_mov_b32 s48, 689152
buffer_load_dwordx4 v230, s[80:83], s48 offen lds
s_waitcnt lgkmcnt(3)
v_mfma_f32_16x16x32_bf16 v[198:201], v[186:189], v[130:133], v[198:201]
ds_read_b128 v[114:117], v238 offset:32768
v_mfma_f32_16x16x32_bf16 v[202:205], v[130:133], v[130:133], v[202:205]
s_waitcnt lgkmcnt(3)
v_mfma_f32_16x16x32_bf16 v[198:201], v[186:189], v[134:137], v[198:201]
ds_read_b128 v[118:121], v238 offset:33792
v_mfma_f32_16x16x32_bf16 v[202:205], v[134:137], v[134:137], v[202:205]
s_waitcnt lgkmcnt(3)
v_mfma_f32_16x16x32_bf16 v[198:201], v[186:189], v[138:141], v[198:201]
ds_read_b128 v[122:125], v238 offset:34816
v_mfma_f32_16x16x32_bf16 v[202:205], v[138:141], v[138:141], v[202:205]
s_waitcnt lgkmcnt(3)
v_mfma_f32_16x16x32_bf16 v[198:201], v[186:189], v[142:145], v[198:201]
ds_read_b128 v[126:129], v238 offset:35840
v_mfma_f32_16x16x32_bf16 v[202:205], v[142:145], v[142:145], v[202:205]
s_waitcnt lgkmcnt(3)
v_mfma_f32_16x16x32_bf16 v[198:201], v[186:189], v[114:117], v[198:201]
v_mfma_f32_16x16x32_bf16 v[202:205], v[114:117], v[114:117], v[202:205]
s_waitcnt lgkmcnt(2)
v_mfma_f32_16x16x32_bf16 v[198:201], v[186:189], v[118:121], v[198:201]
v_mfma_f32_16x16x32_bf16 v[202:205], v[118:121], v[118:121], v[202:205]
s_waitcnt lgkmcnt(1)
v_mfma_f32_16x16x32_bf16 v[198:201], v[186:189], v[122:125], v[198:201]
v_mfma_f32_16x16x32_bf16 v[202:205], v[122:125], v[122:125], v[202:205]
s_waitcnt lgkmcnt(0)
v_mfma_f32_16x16x32_bf16 v[198:201], v[186:189], v[126:129], v[198:201]
v_mfma_f32_16x16x32_bf16 v[202:205], v[126:129], v[126:129], v[202:205]
s_waitcnt vmcnt(12)
s_barrier
s_lshl_b32 s58, s33, 2
s_add_u32 s58, s58, s34
s_cmp_lg_u32 s58, 3
s_cbranch_scc1 W3_6
v_mov_b32 v11, 1
s_lshl_b32 s59, s32, 3
s_mov_b64 exec, 1
buffer_store_dword v11, off, s[28:31], s59 sc1
s_mov_b64 exec, -1
W3_6:
ds_read_b64_tr_b16 a[8:9], v231 offset:32768
ds_read_b64_tr_b16 a[10:11], v231 offset:33280
ds_read_b64_tr_b16 a[20:21], v231 offset:36864
ds_read_b64_tr_b16 a[22:23], v231 offset:37376
ds_read_b64_tr_b16 a[32:33], v231 offset:40960
ds_read_b64_tr_b16 a[34:35], v231 offset:41472
ds_read_b64_tr_b16 a[44:45], v231 offset:45056
ds_read_b64_tr_b16 a[46:47], v231 offset:45568
ds_read_b128 v[114:117], v249 offset:0
ds_read_b128 v[118:121], v249 offset:4096
ds_read_b128 v[122:125], v249 offset:8192
ds_read_b128 v[126:129], v249 offset:12288
ds_read_b128 v[146:149], v169 offset:0
ds_read_b128 v[150:153], v169 offset:1024
s_waitcnt lgkmcnt(6)
s_waitcnt lgkmcnt(5)
v_mfma_f32_16x16x32_bf16 v[58:61], a[0:3], v[114:117], 0
ds_read_b128 v[130:133], v249 offset:1024
v_mfma_f32_16x16x32_bf16 v[62:65], a[4:7], v[114:117], 0
s_add_u32 m0, s73, 16384
s_mov_b32 s48, 395264
buffer_load_dwordx4 v230, s[80:83], s48 offen lds
v_and_b32 v12, 15, v0
v_lshrrev_b32 v13, 4, v0
v_lshrrev_b32 v14, 3, v0
v_lshlrev_b32 v45, 10, v14
v_and_b32 v14, 7, v0
v_mfma_f32_16x16x32_bf16 v[66:69], v[114:117], a[8:11], 0
s_add_u32 m0, s73, 20480
s_mov_b32 s48, 493568
buffer_load_dwordx4 v230, s[80:83], s48 offen lds
v_lshlrev_b32 v15, 1, v13
v_xor_b32 v14, v14, v15
v_lshl_add_u32 v45, v14, 4, v45
s_lshl_b32 s100, s33, 7
v_add_u32 v45, s100, v45
v_mfma_f32_16x16x32_bf16 v[154:157], a[0:3], v[186:189], 0
s_waitcnt lgkmcnt(2)
v_mfma_f32_16x16x32_bf16 v[106:109], a[4:7], v[146:149], 0
v_mfma_f32_16x16x32_bf16 v[110:113], v[146:149], a[8:11], 0
ds_read_b128 v[146:149], v169 offset:2048
v_mfma_f32_16x16x32_bf16 v[70:73], a[0:3], v[118:121], 0
ds_read_b128 v[134:137], v249 offset:5120
v_mfma_f32_16x16x32_bf16 v[74:77], a[4:7], v[118:121], 0
s_add_u32 m0, s73, 24576
s_mov_b32 s48, 591872
buffer_load_dwordx4 v230, s[80:83], s48 offen lds
v_lshrrev_b32 v24, 2, v0
v_sub_u32 v24, 0, v24
v_lshrrev_b32 v25, 5, v0
v_xor_b32 v24, v24, v25
v_and_b32 v24, 3, v24
v_mfma_f32_16x16x32_bf16 v[78:81], v[118:121], a[8:11], 0
s_add_u32 m0, s73, 28672
s_mov_b32 s48, 690176
buffer_load_dwordx4 v230, s[80:83], s48 offen lds
v_and_b32 v25, 15, v0
v_lshlrev_b32 v25, 6, v25
v_lshrrev_b32 v26, 1, v0
v_and_b32 v26, 8, v26
s_lshr_b32 s100, s33, 1
v_mfma_f32_16x16x32_bf16 v[158:161], a[4:7], v[186:189], 0
v_mfma_f32_16x16x32_bf16 v[82:85], a[0:3], v[122:125], 0
ds_read_b128 v[138:141], v249 offset:9216
v_mfma_f32_16x16x32_bf16 v[86:89], a[4:7], v[122:125], 0
s_lshl_b32 s100, s100, 14
s_and_b32 s101, s33, 1
s_lshl_b32 s101, s101, 11
s_add_u32 s100, s100, s101
s_add_u32 s100, s100, s74
v_mfma_f32_16x16x32_bf16 v[90:93], v[122:125], a[8:11], 0
s_add_u32 s100, s100, 65536
v_add3_u32 v25, v25, v26, s100
v_lshl_add_u32 v240, v24, 4, v25
v_xor_b32 v24, 2, v24
v_lshl_add_u32 v241, v24, 4, v25
v_mfma_f32_16x16x32_bf16 v[162:165], v[186:189], a[8:11], 0
v_mfma_f32_16x16x32_bf16 v[94:97], a[0:3], v[126:129], 0
ds_read_b128 v[142:145], v249 offset:13312
v_mfma_f32_16x16x32_bf16 v[98:101], a[4:7], v[126:129], 0
s_getreg_b32 s72, hwreg(HW_REG_XCC_ID)
s_and_b32 s72, s72, 7
s_lshl_b32 s51, s35, 10
s_lshl_b32 s52, s33, 11
s_mul_i32 s100, s33, 7
v_mfma_f32_16x16x32_bf16 v[102:105], v[126:129], a[8:11], 0
s_lshl_b32 s101, s34, 1
s_add_u32 s71, s100, s101
s_lshl_b32 s100, s33, 2
s_add_u32 s100, s100, s34
s_mul_i32 s46, s100, 49152
s_waitcnt vmcnt(12)
s_barrier
ds_read_b64_tr_b16 a[48:49], v231 offset:49152
ds_read_b64_tr_b16 a[50:51], v231 offset:49664
s_add_u32 m0, s73, 32768
s_mov_b32 s48, 786432
buffer_load_dwordx4 v230, s[80:83], s48 offen lds
ds_read_b64_tr_b16 a[60:61], v231 offset:53248
ds_read_b64_tr_b16 a[62:63], v231 offset:53760
ds_read_b64_tr_b16 a[72:73], v231 offset:57344
ds_read_b64_tr_b16 a[74:75], v231 offset:57856
s_add_u32 m0, s73, 36864
s_mov_b32 s48, 884736
buffer_load_dwordx4 v230, s[80:83], s48 offen lds
ds_read_b64_tr_b16 a[84:85], v231 offset:61440
ds_read_b64_tr_b16 a[86:87], v231 offset:61952
s_waitcnt vmcnt(10)
s_waitcnt lgkmcnt(0)
v_mov_b32 v236, 0
v_mov_b32 v237, 0
s_cmp_lg_u32 s97, 3
s_cbranch_scc1 JR4_7
ds_read_b64_tr_b16 v[214:215], v235 offset:0
ds_read_b64_tr_b16 v[216:217], v235 offset:1024
ds_read_b64_tr_b16 v[218:219], v235 offset:512
ds_read_b64_tr_b16 v[220:221], v235 offset:1536
ds_read_b64_tr_b16 v[222:223], v235 offset:2048
ds_read_b64_tr_b16 v[224:225], v235 offset:3072
ds_read_b64_tr_b16 v[226:227], v235 offset:2560
ds_read_b64_tr_b16 v[228:229], v235 offset:3584
s_waitcnt lgkmcnt(0)
s_add_u32 s98, s78, 2048
v_add_u32 v234, 0, v50
v_dot2_f32_bf16 v236, v214, v186, v236
v_dot2_f32_bf16 v236, v215, v186, v236
v_dot2_f32_bf16 v236, v216, v186, v236
v_dot2_f32_bf16 v236, v217, v186, v236
v_dot2_f32_bf16 v236, v218, v186, v236
v_dot2_f32_bf16 v236, v219, v186, v236
v_dot2_f32_bf16 v236, v220, v186, v236
v_dot2_f32_bf16 v236, v221, v186, v236
v_dot2_f32_bf16 v236, v222, v186, v236
v_dot2_f32_bf16 v236, v223, v186, v236
v_dot2_f32_bf16 v236, v224, v186, v236
v_dot2_f32_bf16 v236, v225, v186, v236
v_dot2_f32_bf16 v236, v226, v186, v236
v_dot2_f32_bf16 v236, v227, v186, v236
v_dot2_f32_bf16 v236, v228, v186, v236
v_dot2_f32_bf16 v236, v229, v186, v236
s_nop 2
v_mov_b32 v237, v236
s_nop 1
v_permlane32_swap_b32 v236, v237
v_add_f32 v236, v236, v237
v_and_b32 v166, 31, v0
s_branch JRE_9
JR4_7:
s_cmp_lg_u32 s97, 4
s_cbranch_scc1 JR1_8
ds_read_b64_tr_b16 v[214:215], v235 offset:0
ds_read_b64_tr_b16 v[216:217], v235 offset:512
ds_read_b64_tr_b16 v[218:219], v235 offset:32
ds_read_b64_tr_b16 v[220:221], v235 offset:544
ds_read_b64_tr_b16 v[222:223], v235 offset:2048
ds_read_b64_tr_b16 v[224:225], v235 offset:2560
ds_read_b64_tr_b16 v[226:227], v235 offset:2080
ds_read_b64_tr_b16 v[228:229], v235 offset:2592
s_waitcnt lgkmcnt(0)
s_mov_b32 s98, s99
v_add_u32 v234, 0, v50
v_and_b32 v166, 31, v0
s_branch JRE_9
JR1_8:
ds_read_b64_tr_b16 v[214:215], v235 offset:0
ds_read_b64_tr_b16 v[216:217], v235 offset:1024
ds_read_b64_tr_b16 v[218:219], v235 offset:32
ds_read_b64_tr_b16 v[220:221], v235 offset:1056
ds_read_b64_tr_b16 v[222:223], v235 offset:2048
ds_read_b64_tr_b16 v[224:225], v235 offset:3072
ds_read_b64_tr_b16 v[226:227], v235 offset:2080
ds_read_b64_tr_b16 v[228:229], v235 offset:3104
s_waitcnt lgkmcnt(0)
s_add_u32 s98, s78, 0
v_add_u32 v234, 0x80000000, v50
v_dot2_f32_bf16 v236, v214, v186, v236
v_dot2_f32_bf16 v236, v215, v186, v236
v_dot2_f32_bf16 v236, v216, v186, v236
v_dot2_f32_bf16 v236, v217, v186, v236
v_dot2_f32_bf16 v237, v218, v186, v237
v_dot2_f32_bf16 v237, v219, v186, v237
v_dot2_f32_bf16 v237, v220, v186, v237
v_dot2_f32_bf16 v237, v221, v186, v237
v_dot2_f32_bf16 v236, v222, v186, v236
v_dot2_f32_bf16 v236, v223, v186, v236
v_dot2_f32_bf16 v236, v224, v186, v236
v_dot2_f32_bf16 v236, v225, v186, v236
v_dot2_f32_bf16 v237, v226, v186, v237
v_dot2_f32_bf16 v237, v227, v186, v237
v_dot2_f32_bf16 v237, v228, v186, v237
v_dot2_f32_bf16 v237, v229, v186, v237
s_nop 2
v_permlane32_swap_b32 v236, v237
v_add_f32 v236, v236, v237
v_mov_b32 v237, v236
s_nop 1
v_permlane16_swap_b32 v236, v237
v_add_f32 v236, v236, v237
v_lshrrev_b32 v166, 1, v0
v_and_b32 v166, 16, v166
v_and_b32 v167, 15, v0
v_or_b32 v166, v166, v167
JRE_9:
s_lshl_b32 s58, s34, 7
s_add_u32 s58, s58, 150528
v_lshlrev_b32 v166, 2, v166
v_add_u32 v166, s58, v166
ds_write_b32 v166, v236
v_mfma_f32_16x16x32_bf16 v[58:61], a[12:15], v[130:133], v[58:61]
ds_read_b128 v[114:117], v249 offset:2048
v_mfma_f32_16x16x32_bf16 v[62:65], a[16:19], v[130:133], v[62:65]
s_add_u32 m0, s73, 40960
s_mov_b32 s48, 983040
buffer_load_dwordx4 v230, s[80:83], s48 offen lds
s_mul_i32 s47, s100, 65536
s_add_u32 s47, s47, 0x180000
s_mul_i32 s49, s100, 57344
s_add_u32 s49, s49, 0x380000
s_sub_u32 s100, s49, 0
v_mfma_f32_16x16x32_bf16 v[66:69], v[130:133], a[20:23], v[66:69]
s_add_u32 m0, s73, 45056
s_mov_b32 s48, 1081344
buffer_load_dwordx4 v230, s[80:83], s48 offen lds
s_cmp_eq_u32 s34, 3
s_cselect_b32 s55, s100, s47
s_lshl_b32 s100, s35, 5
s_add_u32 s100, s100, 0x548000
s_lshl_b32 s101, s33, 2
s_add_u32 s42, s100, s101
v_mfma_f32_16x16x32_bf16 v[154:157], a[12:15], v[186:189], v[154:157]
v_mfma_f32_16x16x32_bf16 v[106:109], a[16:19], v[150:153], v[106:109]
v_mfma_f32_16x16x32_bf16 v[110:113], v[150:153], a[20:23], v[110:113]
ds_read_b128 v[150:153], v169 offset:3072
v_mfma_f32_16x16x32_bf16 v[70:73], a[12:15], v[134:137], v[70:73]
ds_read_b128 v[118:121], v249 offset:6144
v_mfma_f32_16x16x32_bf16 v[74:77], a[16:19], v[134:137], v[74:77]
v_and_b32 v14, 7, v0
v_lshlrev_b32 v14, 2, v14
v_add_u32 v6, s100, v14
s_lshl_b32 s100, s32, 8
s_add_u32 s100, s100, s101
v_mfma_f32_16x16x32_bf16 v[78:81], v[134:137], a[20:23], v[78:81]
s_cmp_eq_u32 s34, 0
s_cselect_b32 s101, 128, 0
s_add_u32 s100, s100, s101
s_add_u32 s43, s100, 0x549000
v_and_b32 v14, 15, v0
v_lshrrev_b32 v15, 5, v0
v_mfma_f32_16x16x32_bf16 v[158:161], a[16:19], v[186:189], v[158:161]
v_mfma_f32_16x16x32_bf16 v[82:85], a[12:15], v[138:141], v[82:85]
ds_read_b128 v[122:125], v249 offset:10240
v_mfma_f32_16x16x32_bf16 v[86:89], a[16:19], v[138:141], v[86:89]
v_lshlrev_b32 v44, 4, v14
v_lshl_add_u32 v44, v15, 2, v44
s_lshr_b32 s92, s33, 1
s_lshl_b32 s92, s92, 8
s_and_b32 s93, s33, 1
v_mfma_f32_16x16x32_bf16 v[90:93], v[138:141], a[20:23], v[90:93]
s_lshl_b32 s93, s93, 3
s_add_u32 s92, s92, s93
v_add_u32 v44, s92, v44
s_lshl_b32 s100, s32, 7
s_add_u32 s100, s100, 0x548000
v_mfma_f32_16x16x32_bf16 v[162:165], v[186:189], a[20:23], v[162:165]
v_mfma_f32_16x16x32_bf16 v[94:97], a[12:15], v[142:145], v[94:97]
ds_read_b128 v[126:129], v249 offset:14336
v_mfma_f32_16x16x32_bf16 v[98:101], a[16:19], v[142:145], v[98:101]
v_and_b32 v14, 31, v0
v_lshlrev_b32 v14, 2, v14
v_add_u32 v8, s100, v14
s_lshl_b32 s101, s34, 3
s_add_u32 s100, s100, s101
v_mfma_f32_16x16x32_bf16 v[102:105], v[142:145], a[20:23], v[102:105]
v_and_b32 v14, 3, v0
v_lshlrev_b32 v14, 5, v14
v_and_b32 v15, 4, v0
v_add3_u32 v10, v14, v15, s100
v_lshrrev_b32 v14, 5, v0
s_waitcnt vmcnt(8)
s_waitcnt lgkmcnt(5)
s_barrier
s_add_u32 m0, s73, 49152
s_mov_b32 s48, 787456
buffer_load_dwordx4 v230, s[80:83], s48 offen lds
s_add_u32 m0, s73, 53248
s_mov_b32 s48, 885760
buffer_load_dwordx4 v230, s[80:83], s48 offen lds
s_lshr_b32 s58, s2, 3
s_mul_i32 s58, s58, 4
s_lshr_b32 s58, s58, 5
s_cmp_lg_u32 s58, 0
s_cbranch_scc1 JS_10
buffer_store_dwordx4 v[214:217], v234, s[4:7], s78 offen offset:0 sc1
buffer_store_dwordx4 v[218:221], v234, s[4:7], s78 offen offset:1024 sc1
buffer_store_dwordx4 v[222:225], v234, s[4:7], s98 offen offset:0 sc1
buffer_store_dwordx4 v[226:229], v234, s[4:7], s98 offen offset:1024 sc1
JS_10:
s_mov_b64 exec, 15
buffer_load_dword v54, v42, s[8:11], 0 offen
buffer_load_dword v54, v42, s[12:15], 0 offen
buffer_load_dword v54, v42, s[16:19], 0 offen
s_mov_b64 exec, -1
v_and_b32 v166, 31, v0
v_lshlrev_b32 v166, 2, v166
v_add_u32 v167, 150528, v166
ds_read2_b32 v[242:243], v167 offset0:0 offset1:32
ds_read2_b32 v[244:245], v167 offset0:64 offset1:96
s_waitcnt lgkmcnt(0)
v_add_f32 v242, v242, v243
v_add_f32 v244, v244, v245
v_add_f32 v242, v242, v244
s_cmp_lg_u32 s34, 3
s_cbranch_scc1 JF_11
buffer_store_dword v242, v166, s[4:7], s79 offen sc1
JF_11:
v_mfma_f32_16x16x32_bf16 v[58:61], a[24:27], v[114:117], v[58:61]
ds_read_b128 v[130:133], v249 offset:3072
v_mfma_f32_16x16x32_bf16 v[62:65], a[28:31], v[114:117], v[62:65]
ds_read_b64_tr_b16 a[52:53], v231 offset:0
ds_read_b64_tr_b16 a[54:55], v231 offset:512
v_mfma_f32_16x16x32_bf16 v[66:69], v[114:117], a[32:35], v[66:69]
ds_read_b64_tr_b16 a[64:65], v231 offset:4096
ds_read_b64_tr_b16 a[66:67], v231 offset:4608
v_mfma_f32_16x16x32_bf16 v[154:157], a[24:27], v[186:189], v[154:157]
v_mfma_f32_16x16x32_bf16 v[106:109], a[28:31], v[146:149], v[106:109]
v_mfma_f32_16x16x32_bf16 v[110:113], v[146:149], a[32:35], v[110:113]
ds_read_b128 v[146:149], v169 offset:4096
v_mfma_f32_16x16x32_bf16 v[70:73], a[24:27], v[118:121], v[70:73]
ds_read_b128 v[134:137], v249 offset:7168
v_mfma_f32_16x16x32_bf16 v[74:77], a[28:31], v[118:121], v[74:77]
ds_read_b64_tr_b16 a[76:77], v231 offset:8192
ds_read_b64_tr_b16 a[78:79], v231 offset:8704
v_mfma_f32_16x16x32_bf16 v[78:81], v[118:121], a[32:35], v[78:81]
ds_read_b64_tr_b16 a[88:89], v231 offset:12288
ds_read_b64_tr_b16 a[90:91], v231 offset:12800
v_mfma_f32_16x16x32_bf16 v[158:161], a[28:31], v[186:189], v[158:161]
v_mfma_f32_16x16x32_bf16 v[82:85], a[24:27], v[122:125], v[82:85]
ds_read_b128 v[138:141], v249 offset:11264
v_mfma_f32_16x16x32_bf16 v[86:89], a[28:31], v[122:125], v[86:89]
s_add_u32 m0, s73, 57344
s_mov_b32 s48, 984064
buffer_load_dwordx4 v230, s[80:83], s48 offen lds
v_and_b32 v15, 31, v0
v_lshlrev_b32 v15, 4, v15
v_lshl_add_u32 v52, v14, 14, v15
s_and_b32 s100, s34, 1
s_lshl_b32 s100, s100, 9
v_mfma_f32_16x16x32_bf16 v[90:93], v[122:125], a[32:35], v[90:93]
s_add_u32 m0, s73, 61440
s_mov_b32 s48, 1082368
buffer_load_dwordx4 v230, s[80:83], s48 offen lds
v_add_u32 v52, s100, v52
v_and_b32 v15, 1, v13
v_mul_u32_u24 v15, 57344, v15
v_lshl_add_u32 v15, v14, 8, v15
v_lshl_add_u32 v53, v12, 4, v15
v_mfma_f32_16x16x32_bf16 v[162:165], v[186:189], a[32:35], v[162:165]
v_mfma_f32_16x16x32_bf16 v[94:97], a[24:27], v[126:129], v[94:97]
ds_read_b128 v[142:145], v249 offset:15360
v_mfma_f32_16x16x32_bf16 v[98:101], a[28:31], v[126:129], v[98:101]
v_mul_u32_u24 v15, 57344, v13
v_lshl_add_u32 v57, v12, 7, v15
s_mul_i32 s100, s32, 224
s_add_u32 s100, s100, s71
s_lshl_b32 s100, s100, 10
v_mfma_f32_16x16x32_bf16 v[102:105], v[126:129], a[32:35], v[102:105]
v_add_u32 v57, s100, v57
s_and_b32 s100, s33, 1
s_lshl_b32 s100, s100, 3
v_or_b32 v14, s100, v12
v_mov_b32 v15, 0x80000000
s_waitcnt vmcnt(11)
s_waitcnt lgkmcnt(2)
s_barrier
s_add_u32 m0, s73, 0
s_mov_b32 s48, 788480
buffer_load_dwordx4 v230, s[80:83], s48 offen lds
s_add_u32 m0, s73, 4096
s_mov_b32 s48, 886784
buffer_load_dwordx4 v230, s[80:83], s48 offen lds
s_lshr_b32 s58, s2, 3
s_mul_i32 s58, s58, 4
s_lshr_b32 s58, s58, 5
s_cmp_lg_u32 s58, 1
s_cbranch_scc1 JS_12
buffer_store_dwordx4 v[214:217], v234, s[4:7], s78 offen offset:0 sc1
buffer_store_dwordx4 v[218:221], v234, s[4:7], s78 offen offset:1024 sc1
buffer_store_dwordx4 v[222:225], v234, s[4:7], s98 offen offset:0 sc1
buffer_store_dwordx4 v[226:229], v234, s[4:7], s98 offen offset:1024 sc1
JS_12:
v_and_b32 v11, 31, v0
v_lshlrev_b32 v11, 3, v11
buffer_load_dword v255, v11, s[28:31], 0 offen sc1
v_mfma_f32_16x16x32_bf16 v[58:61], a[36:39], v[130:133], v[58:61]
ds_read_b128 v[114:117], v249 offset:16384
v_mfma_f32_16x16x32_bf16 v[62:65], a[40:43], v[130:133], v[62:65]
ds_read_b64_tr_b16 a[56:57], v231 offset:16384
ds_read_b64_tr_b16 a[58:59], v231 offset:16896
v_mfma_f32_16x16x32_bf16 v[66:69], v[130:133], a[44:47], v[66:69]
ds_read_b64_tr_b16 a[68:69], v231 offset:20480
ds_read_b64_tr_b16 a[70:71], v231 offset:20992
v_mfma_f32_16x16x32_bf16 v[154:157], a[36:39], v[186:189], v[154:157]
v_mfma_f32_16x16x32_bf16 v[106:109], a[40:43], v[150:153], v[106:109]
v_mfma_f32_16x16x32_bf16 v[110:113], v[150:153], a[44:47], v[110:113]
ds_read_b128 v[150:153], v169 offset:5120
v_mfma_f32_16x16x32_bf16 v[70:73], a[36:39], v[134:137], v[70:73]
ds_read_b128 v[118:121], v249 offset:20480
v_mfma_f32_16x16x32_bf16 v[74:77], a[40:43], v[134:137], v[74:77]
ds_read_b64_tr_b16 a[80:81], v231 offset:24576
ds_read_b64_tr_b16 a[82:83], v231 offset:25088
v_mfma_f32_16x16x32_bf16 v[78:81], v[134:137], a[44:47], v[78:81]
ds_read_b64_tr_b16 a[92:93], v231 offset:28672
ds_read_b64_tr_b16 a[94:95], v231 offset:29184
v_mfma_f32_16x16x32_bf16 v[158:161], a[40:43], v[186:189], v[158:161]
s_waitcnt lgkmcnt(12)
v_mfma_f32_16x16x32_bf16 v[82:85], a[36:39], v[138:141], v[82:85]
ds_read_b128 v[122:125], v249 offset:24576
v_mfma_f32_16x16x32_bf16 v[86:89], a[40:43], v[138:141], v[86:89]
s_add_u32 m0, s73, 8192
s_mov_b32 s48, 985088
buffer_load_dwordx4 v230, s[80:83], s48 offen lds
v_cmp_gt_u32 vcc, 8, v14
s_nop 1
v_cndmask_b32 v57, v57, v15, vcc
s_add_u32 s100, s34, 0
s_and_b32 s100, s100, 3
s_lshl_b32 s101, s32, 2
s_add_u32 s100, s100, s101
v_mfma_f32_16x16x32_bf16 v[90:93], v[138:141], a[44:47], v[90:93]
s_add_u32 m0, s73, 12288
s_mov_b32 s48, 1083392
buffer_load_dwordx4 v230, s[80:83], s48 offen lds
s_mul_i32 s100, s100, 56
s_mul_i32 s101, s34, 14
s_add_u32 s100, s100, s101
s_lshl_b32 s64, s100, 10
s_add_u32 s100, s34, 1
v_mfma_f32_16x16x32_bf16 v[162:165], v[186:189], a[44:47], v[162:165]
s_waitcnt lgkmcnt(12)
v_mfma_f32_16x16x32_bf16 v[94:97], a[36:39], v[142:145], v[94:97]
ds_read_b128 v[126:129], v249 offset:28672
v_mfma_f32_16x16x32_bf16 v[98:101], a[40:43], v[142:145], v[98:101]
s_and_b32 s100, s100, 3
s_mul_i32 s68, s100, 12288
s_add_u32 s68, s68, 8192
s_lshl_b32 s101, s32, 2
s_add_u32 s100, s100, s101
v_mfma_f32_16x16x32_bf16 v[102:105], v[142:145], a[44:47], v[102:105]
s_mul_i32 s100, s100, 56
s_mul_i32 s101, s34, 14
s_add_u32 s100, s100, s101
s_lshl_b32 s65, s100, 10
s_add_u32 s100, s34, 2
s_lshr_b32 s58, s33, 1
s_cmp_lg_u32 s58, 0
s_cbranch_scc1 XR_13
ds_read_b64 v[28:29], v240 offset:0
ds_read_b64 v[30:31], v241 offset:0
ds_read_b64 v[32:33], v240 offset:1024
ds_read_b64 v[34:35], v241 offset:1024
XR_13:
s_waitcnt lgkmcnt(2)
v_mfma_f32_16x16x32_bf16 v[58:61], a[48:51], v[114:117], v[58:61]
ds_read_b128 v[130:133], v249 offset:17408
v_mfma_f32_16x16x32_bf16 v[62:65], a[52:55], v[114:117], v[62:65]
s_and_b32 s100, s100, 3
s_mul_i32 s69, s100, 12288
s_add_u32 s69, s69, 4096
s_lshl_b32 s101, s32, 2
s_add_u32 s100, s100, s101
v_mfma_f32_16x16x32_bf16 v[66:69], v[114:117], a[56:59], v[66:69]
s_mul_i32 s100, s100, 56
s_mul_i32 s101, s34, 14
s_add_u32 s100, s100, s101
s_lshl_b32 s66, s100, 10
s_add_u32 s100, s34, 3
v_mfma_f32_16x16x32_bf16 v[154:157], a[48:51], v[186:189], v[154:157]
v_mfma_f32_16x16x32_bf16 v[106:109], a[52:55], v[146:149], v[106:109]
v_mfma_f32_16x16x32_bf16 v[110:113], v[146:149], a[56:59], v[110:113]
ds_read_b128 v[146:149], v169 offset:6144
v_mfma_f32_16x16x32_bf16 v[70:73], a[48:51], v[118:121], v[70:73]
ds_read_b128 v[134:137], v249 offset:21504
v_mfma_f32_16x16x32_bf16 v[74:77], a[52:55], v[118:121], v[74:77]
s_and_b32 s100, s100, 3
s_mul_i32 s70, s100, 12288
s_add_u32 s70, s70, 0
s_lshl_b32 s101, s32, 2
s_add_u32 s100, s100, s101
v_mfma_f32_16x16x32_bf16 v[78:81], v[118:121], a[56:59], v[78:81]
s_mul_i32 s100, s100, 56
s_mul_i32 s101, s34, 14
s_add_u32 s100, s100, s101
s_lshl_b32 s67, s100, 10
s_mov_b32 s56, 0x3eb8aa3b
v_mfma_f32_16x16x32_bf16 v[158:161], a[52:55], v[186:189], v[158:161]
s_waitcnt lgkmcnt(4)
v_mfma_f32_16x16x32_bf16 v[82:85], a[48:51], v[122:125], v[82:85]
ds_read_b128 v[138:141], v249 offset:25600
v_mfma_f32_16x16x32_bf16 v[86:89], a[52:55], v[122:125], v[86:89]
s_mov_b32 s57, 0x3eb8aa3b
v_and_b32 v18, 15, v0
v_lshlrev_b32 v18, 7, v18
s_add_u32 s100, s50, s52
s_add_u32 s101, s100, 0x800000
v_mfma_f32_16x16x32_bf16 v[90:93], v[122:125], a[56:59], v[90:93]
v_add_u32 v55, s101, v18
s_add_u32 s101, s100, 0xa00000
v_add_u32 v18, s101, v18
v_cmp_lt_u32 vcc, 15, v0
s_nop 1
v_cndmask_b32 v55, v55, v18, vcc
s_lshl_b32 s101, s33, 7
v_mfma_f32_16x16x32_bf16 v[162:165], v[186:189], a[56:59], v[162:165]
s_waitcnt lgkmcnt(4)
v_mfma_f32_16x16x32_bf16 v[94:97], a[48:51], v[126:129], v[94:97]
ds_read_b128 v[142:145], v249 offset:29696
v_mfma_f32_16x16x32_bf16 v[98:101], a[52:55], v[126:129], v[98:101]
s_add_u32 s101, s101, s51
s_add_u32 s101, s101, 0x1320000
v_mov_b32 v18, s101
v_cmp_lt_u32 vcc, 31, v0
s_nop 1
v_cndmask_b32 v55, v55, v18, vcc
v_and_b32 v18, 15, v0
v_mfma_f32_16x16x32_bf16 v[102:105], v[126:129], a[56:59], v[102:105]
v_lshrrev_b32 v19, 2, v0
v_and_b32 v19, 12, v19
v_sub_u32 v19, v18, v19
v_mov_b32 v22, 0xf149f2ca
s_cmp_eq_u32 s32, 0
s_cselect_b64 s[90:91], -1, 0
s_waitcnt vmcnt(12)
s_barrier
s_add_u32 m0, s73, 16384
s_mov_b32 s48, 1179648
buffer_load_dwordx4 v230, s[80:83], s48 offen lds
s_add_u32 m0, s73, 20480
s_mov_b32 s48, 1277952
buffer_load_dwordx4 v230, s[80:83], s48 offen lds
s_lshr_b32 s58, s2, 3
s_mul_i32 s58, s58, 4
s_lshr_b32 s58, s58, 5
s_cmp_lg_u32 s58, 2
s_cbranch_scc1 JS_14
buffer_store_dwordx4 v[214:217], v234, s[4:7], s78 offen offset:0 sc1
buffer_store_dwordx4 v[218:221], v234, s[4:7], s78 offen offset:1024 sc1
buffer_store_dwordx4 v[222:225], v234, s[4:7], s98 offen offset:0 sc1
buffer_store_dwordx4 v[226:229], v234, s[4:7], s98 offen offset:1024 sc1
JS_14:
v_lshrrev_b32 v11, 7, v56
v_mul_u32_u24 v11, 1024, v11
s_mov_b32 s48, 384
s_mov_b64 exec, 15
buffer_load_dword v54, v11, s[8:11], s48 offen offset:0
buffer_load_dword v54, v11, s[12:15], s48 offen offset:0
s_mov_b64 exec, -1
s_lshr_b32 s58, s33, 1
s_cmp_lg_u32 s58, 1
s_cbranch_scc1 XR_15
ds_read_b64 v[28:29], v240 offset:0
ds_read_b64 v[30:31], v241 offset:0
ds_read_b64 v[32:33], v240 offset:1024
ds_read_b64 v[34:35], v241 offset:1024
XR_15:
s_waitcnt lgkmcnt(4)
v_mfma_f32_16x16x32_bf16 v[58:61], a[60:63], v[130:133], v[58:61]
ds_read_b128 v[114:117], v249 offset:18432
v_mfma_f32_16x16x32_bf16 v[62:65], a[64:67], v[130:133], v[62:65]
ds_read_b64_tr_b16 a[96:97], v231 offset:32768
ds_read_b64_tr_b16 a[98:99], v231 offset:33280
v_mfma_f32_16x16x32_bf16 v[66:69], v[130:133], a[68:71], v[66:69]
ds_read_b64_tr_b16 a[108:109], v231 offset:36864
ds_read_b64_tr_b16 a[110:111], v231 offset:37376
v_mfma_f32_16x16x32_bf16 v[154:157], a[60:63], v[186:189], v[154:157]
v_mfma_f32_16x16x32_bf16 v[106:109], a[64:67], v[150:153], v[106:109]
v_mfma_f32_16x16x32_bf16 v[110:113], v[150:153], a[68:71], v[110:113]
ds_read_b128 v[150:153], v169 offset:7168
s_waitcnt lgkmcnt(8)
v_mfma_f32_16x16x32_bf16 v[70:73], a[60:63], v[134:137], v[70:73]
ds_read_b128 v[118:121], v249 offset:22528
v_mfma_f32_16x16x32_bf16 v[74:77], a[64:67], v[134:137], v[74:77]
ds_read_b64_tr_b16 a[120:121], v231 offset:40960
ds_read_b64_tr_b16 a[122:123], v231 offset:41472
v_mfma_f32_16x16x32_bf16 v[78:81], v[134:137], a[68:71], v[78:81]
ds_read_b64_tr_b16 a[132:133], v231 offset:45056
ds_read_b64_tr_b16 a[134:135], v231 offset:45568
v_mfma_f32_16x16x32_bf16 v[158:161], a[64:67], v[186:189], v[158:161]
s_waitcnt lgkmcnt(12)
v_mfma_f32_16x16x32_bf16 v[82:85], a[60:63], v[138:141], v[82:85]
ds_read_b128 v[122:125], v249 offset:26624
v_mfma_f32_16x16x32_bf16 v[86:89], a[64:67], v[138:141], v[86:89]
s_add_u32 m0, s73, 24576
s_mov_b32 s48, 1376256
buffer_load_dwordx4 v230, s[80:83], s48 offen lds
v_subrev_u32 v20, 0, v19
v_and_b32 v21, 0x80000001, v20
v_cmp_eq_u32 vcc, 0, v21
s_nop 1
v_cndmask_b32 v170, v22, 0, vcc
v_cmp_eq_u32 vcc, 0x80000000, v21
s_nop 1
v_cndmask_b32 v174, v22, 0, vcc
v_cndmask_b32 v178, v174, v22, s[90:91]
v_subrev_u32 v20, 1, v19
v_mfma_f32_16x16x32_bf16 v[90:93], v[138:141], a[68:71], v[90:93]
s_add_u32 m0, s73, 28672
s_mov_b32 s48, 1474560
buffer_load_dwordx4 v230, s[80:83], s48 offen lds
v_and_b32 v21, 0x80000001, v20
v_cmp_eq_u32 vcc, 0, v21
s_nop 1
v_cndmask_b32 v171, v22, 0, vcc
v_cmp_eq_u32 vcc, 0x80000000, v21
s_nop 1
v_cndmask_b32 v175, v22, 0, vcc
v_cndmask_b32 v179, v175, v22, s[90:91]
v_subrev_u32 v20, 2, v19
v_and_b32 v21, 0x80000001, v20
v_mfma_f32_16x16x32_bf16 v[162:165], v[186:189], a[68:71], v[162:165]
s_waitcnt lgkmcnt(12)
v_mfma_f32_16x16x32_bf16 v[94:97], a[60:63], v[142:145], v[94:97]
ds_read_b128 v[126:129], v249 offset:30720
v_mfma_f32_16x16x32_bf16 v[98:101], a[64:67], v[142:145], v[98:101]
s_add_u32 m0, s74, 114688
s_add_u32 s48, s50, 768
buffer_load_dwordx4 v232, s[20:23], s48 offen lds
v_cmp_eq_u32 vcc, 0, v21
s_nop 1
v_cndmask_b32 v172, v22, 0, vcc
v_cmp_eq_u32 vcc, 0x80000000, v21
s_nop 1
v_cndmask_b32 v176, v22, 0, vcc
v_cndmask_b32 v180, v176, v22, s[90:91]
v_subrev_u32 v20, 3, v19
v_and_b32 v21, 0x80000001, v20
v_cmp_eq_u32 vcc, 0, v21
s_nop 1
v_cndmask_b32 v173, v22, 0, vcc
v_mfma_f32_16x16x32_bf16 v[102:105], v[142:145], a[68:71], v[102:105]
s_add_u32 m0, s74, 115712
s_add_u32 s48, s50, 832
buffer_load_dwordx4 v232, s[20:23], s48 offen lds
v_cmp_eq_u32 vcc, 0x80000000, v21
s_nop 1
v_cndmask_b32 v177, v22, 0, vcc
v_cndmask_b32 v181, v177, v22, s[90:91]
v_cmp_eq_u32 vcc, 0, v174
s_nop 1
v_cndmask_b32 v20, 0, -1, vcc
v_cmp_eq_u32 vcc, 0, v175
s_nop 1
v_cndmask_b32 v21, 0, -1, vcc
v_and_b32 v20, 0xffff, v20
v_and_b32 v21, 0xffff0000, v21
s_waitcnt vmcnt(13)
s_waitcnt lgkmcnt(2)
s_barrier
s_add_u32 m0, s74, 116736
s_add_u32 s48, s50, 896
buffer_load_dwordx4 v232, s[20:23], s48 offen lds
s_add_u32 m0, s74, 117760
s_add_u32 s48, s50, 960
buffer_load_dwordx4 v232, s[20:23], s48 offen lds
s_lshr_b32 s58, s2, 3
s_mul_i32 s58, s58, 4
s_lshr_b32 s58, s58, 5
s_cmp_lg_u32 s58, 3
s_cbranch_scc1 JS_16
buffer_store_dwordx4 v[214:217], v234, s[4:7], s78 offen offset:0 sc1
buffer_store_dwordx4 v[218:221], v234, s[4:7], s78 offen offset:1024 sc1
buffer_store_dwordx4 v[222:225], v234, s[4:7], s98 offen offset:0 sc1
buffer_store_dwordx4 v[226:229], v234, s[4:7], s98 offen offset:1024 sc1
JS_16:
v_mfma_f32_16x16x32_bf16 v[58:61], a[72:75], v[114:117], v[58:61]
ds_read_b128 v[130:133], v249 offset:19456
v_mfma_f32_16x16x32_bf16 v[62:65], a[76:79], v[114:117], v[62:65]
ds_read_b64_tr_b16 a[100:101], v231 offset:49152
ds_read_b64_tr_b16 a[102:103], v231 offset:49664
v_mfma_f32_16x16x32_bf16 v[66:69], v[114:117], a[80:83], v[66:69]
ds_read_b64_tr_b16 a[112:113], v231 offset:53248
ds_read_b64_tr_b16 a[114:115], v231 offset:53760
v_mfma_f32_16x16x32_bf16 v[154:157], a[72:75], v[186:189], v[154:157]
v_mfma_f32_16x16x32_bf16 v[106:109], a[76:79], v[146:149], v[106:109]
v_mfma_f32_16x16x32_bf16 v[110:113], v[146:149], a[80:83], v[110:113]
ds_read_b128 v[146:149], v169 offset:8192
v_mfma_f32_16x16x32_bf16 v[70:73], a[72:75], v[118:121], v[70:73]
ds_read_b128 v[134:137], v249 offset:23552
v_mfma_f32_16x16x32_bf16 v[74:77], a[76:79], v[118:121], v[74:77]
ds_read_b64_tr_b16 a[124:125], v231 offset:57344
ds_read_b64_tr_b16 a[126:127], v231 offset:57856
v_mfma_f32_16x16x32_bf16 v[78:81], v[118:121], a[80:83], v[78:81]
ds_read_b64_tr_b16 a[136:137], v231 offset:61440
ds_read_b64_tr_b16 a[138:139], v231 offset:61952
v_mfma_f32_16x16x32_bf16 v[158:161], a[76:79], v[186:189], v[158:161]
s_waitcnt lgkmcnt(12)
v_mfma_f32_16x16x32_bf16 v[82:85], a[72:75], v[122:125], v[82:85]
ds_read_b128 v[138:141], v249 offset:27648
v_mfma_f32_16x16x32_bf16 v[86:89], a[76:79], v[122:125], v[86:89]
s_add_u32 m0, s73, 32768
s_mov_b32 s48, 1180672
buffer_load_dwordx4 v230, s[80:83], s48 offen lds
v_or_b32 v182, v20, v21
v_cmp_eq_u32 vcc, 0, v170
s_nop 1
v_cndmask_b32 v20, 0, -1, vcc
v_cmp_eq_u32 vcc, 0, v171
s_nop 1
v_cndmask_b32 v21, 0, -1, vcc
v_and_b32 v20, 0xffff, v20
v_and_b32 v21, 0xffff0000, v21
v_mfma_f32_16x16x32_bf16 v[90:93], v[122:125], a[80:83], v[90:93]
s_add_u32 m0, s73, 36864
s_mov_b32 s48, 1278976
buffer_load_dwordx4 v230, s[80:83], s48 offen lds
v_or_b32 v184, v20, v21
v_cmp_eq_u32 vcc, 0, v176
s_nop 1
v_cndmask_b32 v20, 0, -1, vcc
v_cmp_eq_u32 vcc, 0, v177
s_nop 1
v_cndmask_b32 v21, 0, -1, vcc
v_and_b32 v20, 0xffff, v20
v_and_b32 v21, 0xffff0000, v21
v_mfma_f32_16x16x32_bf16 v[162:165], v[186:189], a[80:83], v[162:165]
s_waitcnt lgkmcnt(12)
v_mfma_f32_16x16x32_bf16 v[94:97], a[72:75], v[126:129], v[94:97]
ds_read_b128 v[142:145], v249 offset:31744
v_mfma_f32_16x16x32_bf16 v[98:101], a[76:79], v[126:129], v[98:101]
s_add_u32 m0, s73, 40960
s_mov_b32 s48, 1377280
buffer_load_dwordx4 v230, s[80:83], s48 offen lds
v_or_b32 v183, v20, v21
v_cmp_eq_u32 vcc, 0, v172
s_nop 1
v_cndmask_b32 v20, 0, -1, vcc
v_cmp_eq_u32 vcc, 0, v173
s_nop 1
v_cndmask_b32 v21, 0, -1, vcc
v_and_b32 v20, 0xffff, v20
v_and_b32 v21, 0xffff0000, v21
v_mfma_f32_16x16x32_bf16 v[102:105], v[126:129], a[80:83], v[102:105]
s_add_u32 m0, s73, 45056
s_mov_b32 s48, 1475584
buffer_load_dwordx4 v230, s[80:83], s48 offen lds
v_or_b32 v185, v20, v21
s_waitcnt vmcnt(14)
s_waitcnt lgkmcnt(2)
s_barrier
s_add_u32 m0, s73, 49152
s_mov_b32 s48, 1181696
buffer_load_dwordx4 v230, s[80:83], s48 offen lds
s_add_u32 m0, s73, 53248
s_mov_b32 s48, 1280000
buffer_load_dwordx4 v230, s[80:83], s48 offen lds
v_mfma_f32_16x16x32_bf16 v[58:61], a[84:87], v[130:133], v[58:61]
ds_read_b128 v[114:117], v249 offset:32768
v_mfma_f32_16x16x32_bf16 v[62:65], a[88:91], v[130:133], v[62:65]
ds_read_b64_tr_b16 a[104:105], v231 offset:0
ds_read_b64_tr_b16 a[106:107], v231 offset:512
v_mfma_f32_16x16x32_bf16 v[66:69], v[130:133], a[92:95], v[66:69]
ds_read_b64_tr_b16 a[116:117], v231 offset:4096
ds_read_b64_tr_b16 a[118:119], v231 offset:4608
v_mfma_f32_16x16x32_bf16 v[154:157], a[84:87], v[186:189], v[154:157]
v_mfma_f32_16x16x32_bf16 v[106:109], a[88:91], v[150:153], v[106:109]
v_mfma_f32_16x16x32_bf16 v[110:113], v[150:153], a[92:95], v[110:113]
ds_read_b128 v[150:153], v169 offset:9216
v_mfma_f32_16x16x32_bf16 v[70:73], a[84:87], v[134:137], v[70:73]
ds_read_b128 v[118:121], v249 offset:36864
v_mfma_f32_16x16x32_bf16 v[74:77], a[88:91], v[134:137], v[74:77]
ds_read_b64_tr_b16 a[128:129], v231 offset:8192
ds_read_b64_tr_b16 a[130:131], v231 offset:8704
v_mfma_f32_16x16x32_bf16 v[78:81], v[134:137], a[92:95], v[78:81]
ds_read_b64_tr_b16 a[140:141], v231 offset:12288
ds_read_b64_tr_b16 a[142:143], v231 offset:12800
v_mfma_f32_16x16x32_bf16 v[158:161], a[88:91], v[186:189], v[158:161]
s_waitcnt lgkmcnt(12)
v_mfma_f32_16x16x32_bf16 v[82:85], a[84:87], v[138:141], v[82:85]
ds_read_b128 v[122:125], v249 offset:40960
v_mfma_f32_16x16x32_bf16 v[86:89], a[88:91], v[138:141], v[86:89]
s_add_u32 m0, s73, 57344
s_mov_b32 s48, 1378304
buffer_load_dwordx4 v230, s[80:83], s48 offen lds
v_mfma_f32_16x16x32_bf16 v[90:93], v[138:141], a[92:95], v[90:93]
s_add_u32 m0, s73, 61440
s_mov_b32 s48, 1476608
buffer_load_dwordx4 v230, s[80:83], s48 offen lds
v_mfma_f32_16x16x32_bf16 v[162:165], v[186:189], a[92:95], v[162:165]
s_waitcnt vmcnt(8)
ds_read_b128 v[190:193], v238 offset:49152
s_waitcnt lgkmcnt(13)
v_mfma_f32_16x16x32_bf16 v[94:97], a[84:87], v[142:145], v[94:97]
ds_read_b128 v[126:129], v249 offset:45056
v_mfma_f32_16x16x32_bf16 v[98:101], a[88:91], v[142:145], v[98:101]
s_add_u32 m0, s73, 65536
s_add_u32 s48, s75, 0
buffer_load_dwordx4 v45, s[12:15], s48 offen lds
v_mfma_f32_16x16x32_bf16 v[102:105], v[142:145], a[92:95], v[102:105]
s_add_u32 m0, s73, 69632
s_add_u32 s48, s75, 32768
buffer_load_dwordx4 v45, s[12:15], s48 offen lds
s_waitcnt lgkmcnt(3)
v_mfma_f32_16x16x32_bf16 v[58:61], a[96:99], v[114:117], v[58:61]
ds_read_b128 v[130:133], v249 offset:33792
v_mfma_f32_16x16x32_bf16 v[62:65], a[100:103], v[114:117], v[62:65]
s_add_u32 m0, s73, 73728
s_add_u32 s48, s75, 65536
buffer_load_dwordx4 v45, s[12:15], s48 offen lds
v_mfma_f32_16x16x32_bf16 v[66:69], v[114:117], a[104:107], v[66:69]
s_add_u32 m0, s73, 77824
s_add_u32 s48, s75, 98304
buffer_load_dwordx4 v45, s[12:15], s48 offen lds
v_mfma_f32_16x16x32_bf16 v[154:157], a[96:99], v[186:189], v[154:157]
v_mfma_f32_16x16x32_bf16 v[106:109], a[100:103], v[146:149], v[106:109]
v_mfma_f32_16x16x32_bf16 v[110:113], v[146:149], a[104:107], v[110:113]
ds_read_b128 v[146:149], v169 offset:10240
v_mfma_f32_16x16x32_bf16 v[70:73], a[96:99], v[118:121], v[70:73]
ds_read_b128 v[134:137], v249 offset:37888
v_mfma_f32_16x16x32_bf16 v[74:77], a[100:103], v[118:121], v[74:77]
v_mfma_f32_16x16x32_bf16 v[78:81], v[118:121], a[104:107], v[78:81]
v_mfma_f32_16x16x32_bf16 v[158:161], a[100:103], v[186:189], v[158:161]
ds_read_b128 v[194:197], v238 offset:50176
s_waitcnt lgkmcnt(6)
v_mfma_f32_16x16x32_bf16 v[82:85], a[96:99], v[122:125], v[82:85]
ds_read_b128 v[138:141], v249 offset:41984
v_mfma_f32_16x16x32_bf16 v[86:89], a[100:103], v[122:125], v[86:89]
v_mfma_f32_16x16x32_bf16 v[90:93], v[122:125], a[104:107], v[90:93]
v_mfma_f32_16x16x32_bf16 v[162:165], v[186:189], a[104:107], v[162:165]
s_waitcnt lgkmcnt(5)
v_mfma_f32_16x16x32_bf16 v[94:97], a[96:99], v[126:129], v[94:97]
ds_read_b128 v[142:145], v249 offset:46080
v_mfma_f32_16x16x32_bf16 v[98:101], a[100:103], v[126:129], v[98:101]
v_mfma_f32_16x16x32_bf16 v[102:105], v[126:129], a[104:107], v[102:105]
v_mfma_f32_16x16x32_bf16 v[198:201], v[186:189], v[190:193], v[198:201]
v_mfma_f32_16x16x32_bf16 v[202:205], v[190:193], v[190:193], v[202:205]
s_barrier
s_add_u32 m0, s73, 0
s_add_u32 s48, s75, 0
buffer_load_dwordx4 v45, s[8:11], s48 offen lds
s_add_u32 m0, s73, 4096
s_add_u32 s48, s75, 32768
buffer_load_dwordx4 v45, s[8:11], s48 offen lds
CHK_17:
v_cmp_ne_u32 vcc, 1, v255
s_cbranch_vccz CHKD_18
v_and_b32 v166, 31, v0
v_lshlrev_b32 v166, 3, v166
buffer_load_dword v255, v166, s[28:31], 0 offen sc1
s_waitcnt vmcnt(0)
s_sub_u32 s39, s39, 1
s_cbranch_scc0 CHK_17
s_branch BAIL
CHKD_18:
s_lshr_b32 s58, s33, 1
s_cmp_lg_u32 s58, 2
s_cbranch_scc1 XR_19
ds_read_b64 v[28:29], v240 offset:0
ds_read_b64 v[30:31], v241 offset:0
ds_read_b64 v[32:33], v240 offset:1024
ds_read_b64 v[34:35], v241 offset:1024
XR_19:
s_waitcnt lgkmcnt(5)
v_mfma_f32_16x16x32_bf16 v[58:61], a[108:111], v[130:133], v[58:61]
ds_read_b128 v[114:117], v249 offset:34816
v_mfma_f32_16x16x32_bf16 v[62:65], a[112:115], v[130:133], v[62:65]
ds_read_b64_tr_b16 a[144:145], v231 offset:16384
ds_read_b64_tr_b16 a[146:147], v231 offset:16896
v_mfma_f32_16x16x32_bf16 v[66:69], v[130:133], a[116:119], v[66:69]
ds_read_b64_tr_b16 a[156:157], v231 offset:20480
ds_read_b64_tr_b16 a[158:159], v231 offset:20992
v_mfma_f32_16x16x32_bf16 v[154:157], a[108:111], v[186:189], v[154:157]
v_mfma_f32_16x16x32_bf16 v[106:109], a[112:115], v[150:153], v[106:109]
v_mfma_f32_16x16x32_bf16 v[110:113], v[150:153], a[116:119], v[110:113]
ds_read_b128 v[150:153], v169 offset:11264
s_waitcnt lgkmcnt(9)
v_mfma_f32_16x16x32_bf16 v[70:73], a[108:111], v[134:137], v[70:73]
ds_read_b128 v[118:121], v249 offset:38912
v_mfma_f32_16x16x32_bf16 v[74:77], a[112:115], v[134:137], v[74:77]
ds_read_b64_tr_b16 a[168:169], v231 offset:24576
ds_read_b64_tr_b16 a[170:171], v231 offset:25088
v_mfma_f32_16x16x32_bf16 v[78:81], v[134:137], a[116:119], v[78:81]
ds_read_b64_tr_b16 a[180:181], v231 offset:28672
ds_read_b64_tr_b16 a[182:183], v231 offset:29184
v_mfma_f32_16x16x32_bf16 v[158:161], a[112:115], v[186:189], v[158:161]
ds_read_b128 v[190:193], v238 offset:51200
s_waitcnt lgkmcnt(13)
v_mfma_f32_16x16x32_bf16 v[82:85], a[108:111], v[138:141], v[82:85]
ds_read_b128 v[122:125], v249 offset:43008
v_mfma_f32_16x16x32_bf16 v[86:89], a[112:115], v[138:141], v[86:89]
s_add_u32 m0, s73, 8192
s_add_u32 s48, s75, 65536
buffer_load_dwordx4 v45, s[8:11], s48 offen lds
v_mfma_f32_16x16x32_bf16 v[90:93], v[138:141], a[116:119], v[90:93]
s_add_u32 m0, s73, 12288
s_add_u32 s48, s75, 98304
buffer_load_dwordx4 v45, s[8:11], s48 offen lds
v_mfma_f32_16x16x32_bf16 v[162:165], v[186:189], a[116:119], v[162:165]
s_waitcnt lgkmcnt(13)
v_mfma_f32_16x16x32_bf16 v[94:97], a[108:111], v[142:145], v[94:97]
ds_read_b128 v[126:129], v249 offset:47104
v_mfma_f32_16x16x32_bf16 v[98:101], a[112:115], v[142:145], v[98:101]
s_add_u32 m0, s73, 81920
s_add_u32 s48, s75, 131072
buffer_load_dwordx4 v45, s[12:15], s48 offen lds
v_mfma_f32_16x16x32_bf16 v[102:105], v[142:145], a[116:119], v[102:105]
s_add_u32 m0, s73, 86016
s_add_u32 s48, s75, 163840
buffer_load_dwordx4 v45, s[12:15], s48 offen lds
v_mfma_f32_16x16x32_bf16 v[198:201], v[186:189], v[194:197], v[198:201]
v_mfma_f32_16x16x32_bf16 v[202:205], v[194:197], v[194:197], v[202:205]
s_waitcnt vmcnt(14)
s_waitcnt lgkmcnt(3)
s_barrier
s_add_u32 m0, s73, 16384
s_add_u32 s48, s75, 131072
buffer_load_dwordx4 v45, s[8:11], s48 offen lds
s_add_u32 m0, s73, 20480
s_add_u32 s48, s75, 163840
buffer_load_dwordx4 v45, s[8:11], s48 offen lds
s_cmp_lg_u32 s34, 3
s_cbranch_scc1 W3_20
s_or_b32 s58, s72, 8
v_mov_b32 v11, s58
s_lshl_b32 s58, s32, 7
s_lshl_b32 s59, s33, 2
s_add_u32 s58, s58, s59
s_add_u32 s58, s58, 0x54b000
s_mov_b64 exec, 1
buffer_store_dword v11, off, s[4:7], s58 sc1
s_mov_b64 exec, -1
W3_20:
s_lshr_b32 s58, s33, 1
s_cmp_lg_u32 s58, 3
s_cbranch_scc1 XR_21
ds_read_b64 v[28:29], v240 offset:0
ds_read_b64 v[30:31], v241 offset:0
ds_read_b64 v[32:33], v240 offset:1024
ds_read_b64 v[34:35], v241 offset:1024
XR_21:
v_mfma_f32_16x16x32_bf16 v[58:61], a[120:123], v[114:117], v[58:61]
ds_read_b128 v[130:133], v249 offset:35840
v_mfma_f32_16x16x32_bf16 v[62:65], a[124:127], v[114:117], v[62:65]
ds_read_b64_tr_b16 a[148:149], v231 offset:32768
ds_read_b64_tr_b16 a[150:151], v231 offset:33280
v_mfma_f32_16x16x32_bf16 v[66:69], v[114:117], a[128:131], v[66:69]
ds_read_b64_tr_b16 a[160:161], v231 offset:36864
ds_read_b64_tr_b16 a[162:163], v231 offset:37376
v_mfma_f32_16x16x32_bf16 v[154:157], a[120:123], v[186:189], v[154:157]
v_mfma_f32_16x16x32_bf16 v[106:109], a[124:127], v[146:149], v[106:109]
v_mfma_f32_16x16x32_bf16 v[110:113], v[146:149], a[128:131], v[110:113]
ds_read_b128 v[146:149], v169 offset:12288
v_mfma_f32_16x16x32_bf16 v[70:73], a[120:123], v[118:121], v[70:73]
ds_read_b128 v[134:137], v249 offset:39936
v_mfma_f32_16x16x32_bf16 v[74:77], a[124:127], v[118:121], v[74:77]
ds_read_b64_tr_b16 a[172:173], v231 offset:40960
ds_read_b64_tr_b16 a[174:175], v231 offset:41472
v_mfma_f32_16x16x32_bf16 v[78:81], v[118:121], a[128:131], v[78:81]
ds_read_b64_tr_b16 a[184:185], v231 offset:45056
ds_read_b64_tr_b16 a[186:187], v231 offset:45568
v_mfma_f32_16x16x32_bf16 v[158:161], a[124:127], v[186:189], v[158:161]
ds_read_b128 v[194:197], v238 offset:52224
s_waitcnt lgkmcnt(13)
v_mfma_f32_16x16x32_bf16 v[82:85], a[120:123], v[122:125], v[82:85]
ds_read_b128 v[138:141], v249 offset:44032
v_mfma_f32_16x16x32_bf16 v[86:89], a[124:127], v[122:125], v[86:89]
s_add_u32 m0, s73, 24576
s_add_u32 s48, s75, 196608
buffer_load_dwordx4 v45, s[8:11], s48 offen lds
v_mfma_f32_16x16x32_bf16 v[90:93], v[122:125], a[128:131], v[90:93]
s_add_u32 m0, s73, 28672
s_add_u32 s48, s75, 229376
buffer_load_dwordx4 v45, s[8:11], s48 offen lds
v_mfma_f32_16x16x32_bf16 v[162:165], v[186:189], a[128:131], v[162:165]
s_waitcnt lgkmcnt(13)
v_mfma_f32_16x16x32_bf16 v[94:97], a[120:123], v[126:129], v[94:97]
ds_read_b128 v[142:145], v249 offset:48128
v_mfma_f32_16x16x32_bf16 v[98:101], a[124:127], v[126:129], v[98:101]
s_add_u32 m0, s73, 90112
s_add_u32 s48, s75, 196608
buffer_load_dwordx4 v45, s[12:15], s48 offen lds
v_mfma_f32_16x16x32_bf16 v[102:105], v[126:129], a[128:131], v[102:105]
s_add_u32 m0, s73, 94208
s_add_u32 s48, s75, 229376
buffer_load_dwordx4 v45, s[12:15], s48 offen lds
v_mfma_f32_16x16x32_bf16 v[198:201], v[186:189], v[190:193], v[198:201]
v_mfma_f32_16x16x32_bf16 v[202:205], v[190:193], v[190:193], v[202:205]
s_waitcnt vmcnt(16)
s_waitcnt lgkmcnt(3)
s_barrier
s_add_u32 m0, s73, 32768
s_add_u32 s48, s75, 262144
buffer_load_dwordx4 v45, s[8:11], s48 offen lds
s_add_u32 m0, s73, 36864
s_add_u32 s48, s75, 294912
buffer_load_dwordx4 v45, s[8:11], s48 offen lds
v_lshrrev_b32 v11, 7, v56
v_mul_u32_u24 v11, 1024, v11
s_mov_b32 s48, 384
s_mov_b64 exec, 15
buffer_load_dword v54, v11, s[16:19], s48 offen offset:0
s_mov_b64 exec, -1
v_mfma_f32_16x16x32_bf16 v[58:61], a[132:135], v[130:133], v[58:61]
ds_read_b128 v[114:117], v249 offset:49152
v_mfma_f32_16x16x32_bf16 v[62:65], a[136:139], v[130:133], v[62:65]
ds_read_b64_tr_b16 a[152:153], v231 offset:49152
ds_read_b64_tr_b16 a[154:155], v231 offset:49664
v_mfma_f32_16x16x32_bf16 v[66:69], v[130:133], a[140:143], v[66:69]
ds_read_b64_tr_b16 a[164:165], v231 offset:53248
ds_read_b64_tr_b16 a[166:167], v231 offset:53760
v_mfma_f32_16x16x32_bf16 v[154:157], a[132:135], v[186:189], v[154:157]
v_mfma_f32_16x16x32_bf16 v[106:109], a[136:139], v[150:153], v[106:109]
v_mfma_f32_16x16x32_bf16 v[110:113], v[150:153], a[140:143], v[110:113]
ds_read_b128 v[150:153], v169 offset:13312
v_mfma_f32_16x16x32_bf16 v[70:73], a[132:135], v[134:137], v[70:73]
ds_read_b128 v[118:121], v249 offset:53248
v_mfma_f32_16x16x32_bf16 v[74:77], a[136:139], v[134:137], v[74:77]
ds_read_b64_tr_b16 a[176:177], v231 offset:57344
ds_read_b64_tr_b16 a[178:179], v231 offset:57856
v_mfma_f32_16x16x32_bf16 v[78:81], v[134:137], a[140:143], v[78:81]
ds_read_b64_tr_b16 a[188:189], v231 offset:61440
ds_read_b64_tr_b16 a[190:191], v231 offset:61952
v_mfma_f32_16x16x32_bf16 v[158:161], a[136:139], v[186:189], v[158:161]
s_waitcnt lgkmcnt(12)
v_mfma_f32_16x16x32_bf16 v[82:85], a[132:135], v[138:141], v[82:85]
ds_read_b128 v[122:125], v249 offset:57344
v_mfma_f32_16x16x32_bf16 v[86:89], a[136:139], v[138:141], v[86:89]
s_add_u32 m0, s73, 40960
s_add_u32 s48, s75, 327680
buffer_load_dwordx4 v45, s[8:11], s48 offen lds
v_mfma_f32_16x16x32_bf16 v[90:93], v[138:141], a[140:143], v[90:93]
s_add_u32 m0, s73, 45056
s_add_u32 s48, s75, 360448
buffer_load_dwordx4 v45, s[8:11], s48 offen lds
v_mfma_f32_16x16x32_bf16 v[162:165], v[186:189], a[140:143], v[162:165]
s_waitcnt lgkmcnt(12)
v_mfma_f32_16x16x32_bf16 v[94:97], a[132:135], v[142:145], v[94:97]
ds_read_b128 v[126:129], v249 offset:61440
v_mfma_f32_16x16x32_bf16 v[98:101], a[136:139], v[142:145], v[98:101]
v_mfma_f32_16x16x32_bf16 v[102:105], v[142:145], a[140:143], v[102:105]
v_mfma_f32_16x16x32_bf16 v[198:201], v[186:189], v[194:197], v[198:201]
v_mfma_f32_16x16x32_bf16 v[202:205], v[194:197], v[194:197], v[202:205]
v_lshlrev_b32 v12, 16, v28
v_and_b32 v13, 0xffff0000, v28
v_lshlrev_b32 v14, 16, v29
v_and_b32 v15, 0xffff0000, v29
v_lshlrev_b32 v16, 16, v30
v_and_b32 v17, 0xffff0000, v30
v_lshlrev_b32 v18, 16, v31
v_and_b32 v19, 0xffff0000, v31
v_lshlrev_b32 v20, 16, v32
v_and_b32 v21, 0xffff0000, v32
v_lshlrev_b32 v22, 16, v33
v_and_b32 v23, 0xffff0000, v33
v_lshlrev_b32 v24, 16, v34
v_and_b32 v25, 0xffff0000, v34
v_lshlrev_b32 v26, 16, v35
v_and_b32 v27, 0xffff0000, v35
s_waitcnt lgkmcnt(2)
s_barrier
s_add_u32 m0, s73, 49152
s_add_u32 s48, s75, 393216
buffer_load_dwordx4 v45, s[8:11], s48 offen lds
s_add_u32 m0, s73, 53248
s_add_u32 s48, s75, 425984
buffer_load_dwordx4 v45, s[8:11], s48 offen lds
s_add_u32 m0, s73, 57344
s_add_u32 s48, s75, 458752
buffer_load_dwordx4 v45, s[8:11], s48 offen lds
s_add_u32 m0, s73, 61440
s_add_u32 s48, s75, 491520
buffer_load_dwordx4 v45, s[8:11], s48 offen lds
s_mov_b32 s48, 0
buffer_load_dword v54, v55, s[4:7], s48 offen sc1
v_mfma_f32_16x16x32_bf16 v[58:61], a[144:147], v[114:117], v[58:61]
ds_read_b128 v[130:133], v249 offset:50176
v_mfma_f32_16x16x32_bf16 v[62:65], a[148:151], v[114:117], v[62:65]
v_mfma_f32_16x16x32_bf16 v[66:69], v[114:117], a[152:155], v[66:69]
v_mfma_f32_16x16x32_bf16 v[154:157], a[144:147], v[186:189], v[154:157]
v_mfma_f32_16x16x32_bf16 v[106:109], a[148:151], v[146:149], v[106:109]
v_mfma_f32_16x16x32_bf16 v[110:113], v[146:149], a[152:155], v[110:113]
ds_read_b128 v[146:149], v169 offset:14336
v_mfma_f32_16x16x32_bf16 v[70:73], a[144:147], v[118:121], v[70:73]
ds_read_b128 v[134:137], v249 offset:54272
v_mfma_f32_16x16x32_bf16 v[74:77], a[148:151], v[118:121], v[74:77]
v_and_b32 v240, 1, v0
v_cmp_ne_u32 vcc, 0, v240
s_nop 1
v_cndmask_b32 v202, v202, v203, vcc
v_cndmask_b32 v204, v204, v205, vcc
v_and_b32 v240, 2, v0
v_mfma_f32_16x16x32_bf16 v[78:81], v[118:121], a[152:155], v[78:81]
v_cmp_ne_u32 vcc, 0, v240
s_nop 1
v_cndmask_b32 v202, v202, v204, vcc
v_lshrrev_b32 v240, 2, v0
v_lshrrev_b32 v241, 4, v0
v_mfma_f32_16x16x32_bf16 v[158:161], a[148:151], v[186:189], v[158:161]
s_waitcnt lgkmcnt(4)
v_mfma_f32_16x16x32_bf16 v[82:85], a[144:147], v[122:125], v[82:85]
ds_read_b128 v[138:141], v249 offset:58368
v_mfma_f32_16x16x32_bf16 v[86:89], a[148:151], v[122:125], v[86:89]
v_xor_b32 v240, v240, v241
v_and_b32 v240, 3, v240
v_cmp_eq_u32 vcc, 0, v240
s_nop 1
v_cndmask_b32 v202, 0, v202, vcc
v_mfma_f32_16x16x32_bf16 v[90:93], v[122:125], a[152:155], v[90:93]
v_mov_b32 v203, v202
s_nop 1
v_permlane32_swap_b32 v202, v203
v_add_f32 v202, v202, v203
v_mfma_f32_16x16x32_bf16 v[162:165], v[186:189], a[152:155], v[162:165]
s_waitcnt lgkmcnt(4)
v_mfma_f32_16x16x32_bf16 v[94:97], a[144:147], v[126:129], v[94:97]
ds_read_b128 v[142:145], v249 offset:62464
v_mfma_f32_16x16x32_bf16 v[98:101], a[148:151], v[126:129], v[98:101]
v_mov_b32 v203, v202
s_nop 1
v_permlane16_swap_b32 v202, v203
v_add_f32 v202, v202, v203
v_mfma_f32_16x16x32_bf16 v[102:105], v[126:129], a[152:155], v[102:105]
v_mul_f32 v166, 0x3b000000, v198
v_mul_f32 v202, 0x3b000000, v202
v_fma_f32 v167, -v166, v166, v202
s_waitcnt lgkmcnt(4)
v_mfma_f32_16x16x32_bf16 v[58:61], a[156:159], v[130:133], v[58:61]
ds_read_b128 v[114:117], v249 offset:51200
v_mfma_f32_16x16x32_bf16 v[62:65], a[160:163], v[130:133], v[62:65]
v_max_f32 v167, 0, v167
v_add_f32 v167, 0x3727c5ac, v167
v_rsq_f32 v167, v167
v_mfma_f32_16x16x32_bf16 v[66:69], v[130:133], a[164:167], v[66:69]
s_lshl_b32 s58, s34, 6
s_add_u32 s58, s58, 64
v_add_u32 v168, s58, v250
v_mfma_f32_16x16x32_bf16 v[154:157], a[156:159], v[186:189], v[154:157]
v_mfma_f32_16x16x32_bf16 v[106:109], a[160:163], v[150:153], v[106:109]
v_mfma_f32_16x16x32_bf16 v[110:113], v[150:153], a[164:167], v[110:113]
ds_read_b128 v[150:153], v169 offset:15360
s_waitcnt lgkmcnt(4)
v_mfma_f32_16x16x32_bf16 v[70:73], a[156:159], v[134:137], v[70:73]
ds_read_b128 v[118:121], v249 offset:55296
v_mfma_f32_16x16x32_bf16 v[74:77], a[160:163], v[134:137], v[74:77]
v_mul_f32 v166, v167, -v166
ds_write2_b32 v168, v167, v166 offset0:0 offset1:128
v_and_b32 v240, 1, v0
v_mfma_f32_16x16x32_bf16 v[78:81], v[134:137], a[164:167], v[78:81]
v_cmp_ne_u32 vcc, 0, v240
s_nop 1
v_cndmask_b32 v210, v210, v211, vcc
v_cndmask_b32 v212, v212, v213, vcc
v_and_b32 v240, 2, v0
v_cmp_ne_u32 vcc, 0, v240
s_nop 1
v_cndmask_b32 v210, v210, v212, vcc
v_mfma_f32_16x16x32_bf16 v[158:161], a[160:163], v[186:189], v[158:161]
s_waitcnt lgkmcnt(5)
v_mfma_f32_16x16x32_bf16 v[82:85], a[156:159], v[138:141], v[82:85]
ds_read_b128 v[122:125], v249 offset:59392
v_mfma_f32_16x16x32_bf16 v[86:89], a[160:163], v[138:141], v[86:89]
v_lshrrev_b32 v240, 2, v0
v_lshrrev_b32 v241, 4, v0
v_xor_b32 v240, v240, v241
v_mfma_f32_16x16x32_bf16 v[90:93], v[138:141], a[164:167], v[90:93]
v_and_b32 v240, 3, v240
v_cmp_eq_u32 vcc, 0, v240
s_nop 1
v_cndmask_b32 v210, 0, v210, vcc
v_mov_b32 v211, v210
v_mfma_f32_16x16x32_bf16 v[162:165], v[186:189], a[164:167], v[162:165]
s_waitcnt lgkmcnt(5)
v_mfma_f32_16x16x32_bf16 v[94:97], a[156:159], v[142:145], v[94:97]
ds_read_b128 v[126:129], v249 offset:63488
v_mfma_f32_16x16x32_bf16 v[98:101], a[160:163], v[142:145], v[98:101]
v_permlane32_swap_b32 v210, v211
v_add_f32 v210, v210, v211
v_mov_b32 v211, v210
v_mfma_f32_16x16x32_bf16 v[102:105], v[142:145], a[164:167], v[102:105]
s_nop 0
v_permlane16_swap_b32 v210, v211
v_add_f32 v210, v210, v211
v_mul_f32 v166, 0x3b000000, v206
s_waitcnt lgkmcnt(5)
v_mfma_f32_16x16x32_bf16 v[58:61], a[168:171], v[114:117], v[58:61]
ds_read_b128 v[130:133], v249 offset:52224
v_mfma_f32_16x16x32_bf16 v[62:65], a[172:175], v[114:117], v[62:65]
v_mul_f32 v210, 0x3b000000, v210
v_fma_f32 v167, -v166, v166, v210
v_max_f32 v167, 0, v167
v_mfma_f32_16x16x32_bf16 v[66:69], v[114:117], a[176:179], v[66:69]
v_add_f32 v167, 0x3727c5ac, v167
v_rsq_f32 v167, v167
s_nop 0
v_mul_f32 v166, v167, -v166
v_mfma_f32_16x16x32_bf16 v[154:157], a[168:171], v[186:189], v[154:157]
v_mfma_f32_16x16x32_bf16 v[106:109], a[172:175], v[146:149], v[106:109]
v_mfma_f32_16x16x32_bf16 v[110:113], v[146:149], a[176:179], v[110:113]
s_waitcnt lgkmcnt(4)
v_mfma_f32_16x16x32_bf16 v[70:73], a[168:171], v[118:121], v[70:73]
ds_read_b128 v[134:137], v249 offset:56320
v_mfma_f32_16x16x32_bf16 v[74:77], a[172:175], v[118:121], v[74:77]
ds_write2_b32 v250, v167, v166 offset0:0 offset1:128
v_mfma_f32_16x16x32_bf16 v[78:81], v[118:121], a[176:179], v[78:81]
v_mfma_f32_16x16x32_bf16 v[158:161], a[172:175], v[186:189], v[158:161]
s_waitcnt lgkmcnt(4)
v_mfma_f32_16x16x32_bf16 v[82:85], a[168:171], v[122:125], v[82:85]
ds_read_b128 v[138:141], v249 offset:60416
v_mfma_f32_16x16x32_bf16 v[86:89], a[172:175], v[122:125], v[86:89]
v_mfma_f32_16x16x32_bf16 v[90:93], v[122:125], a[176:179], v[90:93]
v_mfma_f32_16x16x32_bf16 v[162:165], v[186:189], a[176:179], v[162:165]
s_waitcnt lgkmcnt(4)
v_mfma_f32_16x16x32_bf16 v[94:97], a[168:171], v[126:129], v[94:97]
ds_read_b128 v[142:145], v249 offset:64512
v_mfma_f32_16x16x32_bf16 v[98:101], a[172:175], v[126:129], v[98:101]
v_mfma_f32_16x16x32_bf16 v[102:105], v[126:129], a[176:179], v[102:105]
s_waitcnt lgkmcnt(2)
s_barrier
ds_read2_b32 v[238:239], v250 offset0:0 offset1:128
ds_read_b128 v[190:193], v251 offset:0
ds_read_b128 v[194:197], v251 offset:512
ds_read2_b32 v[240:241], v250 offset0:16 offset1:144
ds_read_b128 v[198:201], v251 offset:64
ds_read_b128 v[202:205], v251 offset:576
ds_read2_b32 v[242:243], v250 offset0:32 offset1:160
ds_read_b128 v[206:209], v251 offset:128
ds_read_b128 v[210:213], v251 offset:640
ds_read2_b32 v[244:245], v250 offset0:48 offset1:176
ds_read_b128 v[214:217], v251 offset:192
ds_read_b128 v[218:221], v251 offset:704
ds_read2_b32 v[246:247], v250 offset0:64 offset1:192
ds_read_b128 v[222:225], v251 offset:256
ds_read_b128 v[226:229], v251 offset:768
v_mfma_f32_16x16x32_bf16 v[58:61], a[180:183], v[130:133], v[58:61]
s_add_u32 m0, s73, 98304
s_add_u32 s48, s75, 262144
buffer_load_dwordx4 v45, s[12:15], s48 offen lds
v_mfma_f32_16x16x32_bf16 v[62:65], a[184:187], v[130:133], v[62:65]
s_add_u32 m0, s73, 102400
s_add_u32 s48, s75, 294912
buffer_load_dwordx4 v45, s[12:15], s48 offen lds
v_mfma_f32_16x16x32_bf16 v[66:69], v[130:133], a[188:191], v[66:69]
s_add_u32 m0, s73, 106496
s_add_u32 s48, s75, 327680
buffer_load_dwordx4 v45, s[12:15], s48 offen lds
v_mfma_f32_16x16x32_bf16 v[154:157], a[180:183], v[186:189], v[154:157]
v_mfma_f32_16x16x32_bf16 v[106:109], a[184:187], v[150:153], v[106:109]
v_mfma_f32_16x16x32_bf16 v[110:113], v[150:153], a[188:191], v[110:113]
v_mfma_f32_16x16x32_bf16 v[70:73], a[180:183], v[134:137], v[70:73]
s_add_u32 m0, s73, 110592
s_add_u32 s48, s75, 360448
buffer_load_dwordx4 v45, s[12:15], s48 offen lds
v_mfma_f32_16x16x32_bf16 v[74:77], a[184:187], v[134:137], v[74:77]
v_mfma_f32_16x16x32_bf16 v[78:81], v[134:137], a[188:191], v[78:81]
v_mfma_f32_16x16x32_bf16 v[158:161], a[184:187], v[186:189], v[158:161]
s_waitcnt lgkmcnt(15)
v_mfma_f32_16x16x32_bf16 v[82:85], a[180:183], v[138:141], v[82:85]
v_mfma_f32_16x16x32_bf16 v[86:89], a[184:187], v[138:141], v[86:89]
v_mfma_f32_16x16x32_bf16 v[90:93], v[138:141], a[188:191], v[90:93]
v_mfma_f32_16x16x32_bf16 v[162:165], v[186:189], a[188:191], v[162:165]
s_waitcnt lgkmcnt(15)
v_mfma_f32_16x16x32_bf16 v[94:97], a[180:183], v[142:145], v[94:97]
v_mfma_f32_16x16x32_bf16 v[98:101], a[184:187], v[142:145], v[98:101]
v_mfma_f32_16x16x32_bf16 v[102:105], v[142:145], a[188:191], v[102:105]
s_lshl_b32 s58, s34, 6
v_add_u32 v166, s58, v251
v_add_u32 v167, s58, v250
ds_write_b128 v166, v[154:157] offset:1024
ds_write_b128 v166, v[158:161] offset:1280
ds_write_b32 v167, v162 offset:1536
s_waitcnt vmcnt(5)
s_waitcnt lgkmcnt(0)
s_barrier
v_lshrrev_b32 v166, 1, v0
v_lshlrev_b32 v166, 3, v166
v_and_b32 v252, 1, v0
v_or_b32 v166, v166, v252
v_lshlrev_b32 v166, 4, v166
s_mov_b32 s48, 0x54b000
buffer_load_dwordx4 v[252:255], v166, s[4:7], s48 offen sc1
v_pk_mul_f32 v[230:231], v[158:159], v[240:241] op_sel:[0,1]
v_pk_mul_f32 v[232:233], v[160:161], v[240:241] op_sel:[0,1]
v_pk_fma_f32 v[230:231], v[62:63], v[240:241], v[230:231] op_sel_hi:[1,0,1]
v_pk_fma_f32 v[232:233], v[64:65], v[240:241], v[232:233] op_sel_hi:[1,0,1]
v_cvt_pk_bf16_f32 v126, v230, v231
v_cvt_pk_bf16_f32 v127, v232, v233
v_pk_mul_f32 v[230:231], v[154:155], v[240:241] op_sel:[0,1]
v_pk_mul_f32 v[232:233], v[156:157], v[240:241] op_sel:[0,1]
s_add_u32 m0, s73, 114688
s_add_u32 s48, s75, 393216
v_pk_fma_f32 v[230:231], v[58:59], v[240:241], v[230:231] op_sel_hi:[1,0,1]
v_pk_fma_f32 v[232:233], v[60:61], v[240:241], v[232:233] op_sel_hi:[1,0,1]
v_cvt_pk_bf16_f32 v134, v230, v231
v_cvt_pk_bf16_f32 v135, v232, v233
buffer_load_dwordx4 v45, s[12:15], s48 offen lds
v_pk_mul_f32 v[234:235], v[202:203], v[162:163] op_sel_hi:[1,0]
v_pk_mul_f32 v[236:237], v[204:205], v[162:163] op_sel_hi:[1,0]
v_pk_fma_f32 v[234:235], v[66:67], v[198:199], v[234:235]
v_pk_fma_f32 v[236:237], v[68:69], v[200:201], v[236:237]
v_cvt_pk_bf16_f32 v116, v234, v235
v_cvt_pk_bf16_f32 v117, v236, v237
v_pk_mul_f32 v[230:231], v[158:159], v[242:243] op_sel:[0,1]
v_pk_mul_f32 v[232:233], v[160:161], v[242:243] op_sel:[0,1]
s_add_u32 m0, s73, 118784
s_add_u32 s48, s75, 425984
v_pk_fma_f32 v[230:231], v[74:75], v[242:243], v[230:231] op_sel_hi:[1,0,1]
v_pk_fma_f32 v[232:233], v[76:77], v[242:243], v[232:233] op_sel_hi:[1,0,1]
v_cvt_pk_bf16_f32 v128, v230, v231
v_cvt_pk_bf16_f32 v129, v232, v233
buffer_load_dwordx4 v45, s[12:15], s48 offen lds
v_pk_mul_f32 v[230:231], v[154:155], v[242:243] op_sel:[0,1]
v_pk_mul_f32 v[232:233], v[156:157], v[242:243] op_sel:[0,1]
v_pk_fma_f32 v[230:231], v[70:71], v[242:243], v[230:231] op_sel_hi:[1,0,1]
v_pk_fma_f32 v[232:233], v[72:73], v[242:243], v[232:233] op_sel_hi:[1,0,1]
v_cvt_pk_bf16_f32 v136, v230, v231
v_cvt_pk_bf16_f32 v137, v232, v233
v_pk_mul_f32 v[234:235], v[210:211], v[162:163] op_sel_hi:[1,0]
v_pk_mul_f32 v[236:237], v[212:213], v[162:163] op_sel_hi:[1,0]
s_add_u32 m0, s73, 122880
s_add_u32 s48, s75, 458752
v_pk_fma_f32 v[234:235], v[78:79], v[206:207], v[234:235]
v_pk_fma_f32 v[236:237], v[80:81], v[208:209], v[236:237]
v_cvt_pk_bf16_f32 v118, v234, v235
v_cvt_pk_bf16_f32 v119, v236, v237
buffer_load_dwordx4 v45, s[12:15], s48 offen lds
v_pk_mul_f32 v[230:231], v[158:159], v[244:245] op_sel:[0,1]
v_pk_mul_f32 v[232:233], v[160:161], v[244:245] op_sel:[0,1]
v_pk_fma_f32 v[230:231], v[86:87], v[244:245], v[230:231] op_sel_hi:[1,0,1]
v_pk_fma_f32 v[232:233], v[88:89], v[244:245], v[232:233] op_sel_hi:[1,0,1]
v_cvt_pk_bf16_f32 v130, v230, v231
v_cvt_pk_bf16_f32 v131, v232, v233
v_pk_mul_f32 v[230:231], v[154:155], v[244:245] op_sel:[0,1]
v_pk_mul_f32 v[232:233], v[156:157], v[244:245] op_sel:[0,1]
s_add_u32 m0, s73, 126976
s_add_u32 s48, s75, 491520
v_pk_fma_f32 v[230:231], v[82:83], v[244:245], v[230:231] op_sel_hi:[1,0,1]
v_pk_fma_f32 v[232:233], v[84:85], v[244:245], v[232:233] op_sel_hi:[1,0,1]
v_cvt_pk_bf16_f32 v138, v230, v231
v_cvt_pk_bf16_f32 v139, v232, v233
buffer_load_dwordx4 v45, s[12:15], s48 offen lds
v_pk_mul_f32 v[234:235], v[218:219], v[162:163] op_sel_hi:[1,0]
v_pk_mul_f32 v[236:237], v[220:221], v[162:163] op_sel_hi:[1,0]
v_pk_fma_f32 v[234:235], v[90:91], v[214:215], v[234:235]
v_pk_fma_f32 v[236:237], v[92:93], v[216:217], v[236:237]
v_cvt_pk_bf16_f32 v120, v234, v235
v_cvt_pk_bf16_f32 v121, v236, v237
v_pk_mul_f32 v[230:231], v[158:159], v[246:247] op_sel:[0,1]
v_pk_mul_f32 v[232:233], v[160:161], v[246:247] op_sel:[0,1]
s_add_u32 m0, s73, 131072
s_add_u32 s48, s75, 0
v_pk_fma_f32 v[230:231], v[98:99], v[246:247], v[230:231] op_sel_hi:[1,0,1]
v_pk_fma_f32 v[232:233], v[100:101], v[246:247], v[232:233] op_sel_hi:[1,0,1]
v_cvt_pk_bf16_f32 v132, v230, v231
v_cvt_pk_bf16_f32 v133, v232, v233
buffer_load_dwordx4 v45, s[16:19], s48 offen lds
v_pk_mul_f32 v[230:231], v[154:155], v[246:247] op_sel:[0,1]
v_pk_mul_f32 v[232:233], v[156:157], v[246:247] op_sel:[0,1]
v_pk_fma_f32 v[230:231], v[94:95], v[246:247], v[230:231] op_sel_hi:[1,0,1]
v_pk_fma_f32 v[232:233], v[96:97], v[246:247], v[232:233] op_sel_hi:[1,0,1]
v_cvt_pk_bf16_f32 v140, v230, v231
v_cvt_pk_bf16_f32 v141, v232, v233
v_pk_mul_f32 v[234:235], v[226:227], v[162:163] op_sel_hi:[1,0]
v_pk_mul_f32 v[236:237], v[228:229], v[162:163] op_sel_hi:[1,0]
s_add_u32 m0, s73, 135168
s_add_u32 s48, s75, 32768
v_pk_fma_f32 v[234:235], v[102:103], v[222:223], v[234:235]
v_pk_fma_f32 v[236:237], v[104:105], v[224:225], v[236:237]
v_cvt_pk_bf16_f32 v122, v234, v235
v_cvt_pk_bf16_f32 v123, v236, v237
buffer_load_dwordx4 v45, s[16:19], s48 offen lds
v_pk_mul_f32 v[230:231], v[158:159], v[238:239] op_sel:[0,1]
v_pk_mul_f32 v[232:233], v[160:161], v[238:239] op_sel:[0,1]
v_pk_fma_f32 v[230:231], v[106:107], v[238:239], v[230:231] op_sel_hi:[1,0,1]
v_pk_fma_f32 v[232:233], v[108:109], v[238:239], v[232:233] op_sel_hi:[1,0,1]
v_cvt_pk_bf16_f32 v124, v230, v231
v_cvt_pk_bf16_f32 v125, v232, v233
v_pk_mul_f32 v[234:235], v[194:195], v[162:163] op_sel_hi:[1,0]
v_pk_mul_f32 v[236:237], v[196:197], v[162:163] op_sel_hi:[1,0]
s_add_u32 m0, s73, 139264
s_add_u32 s48, s75, 65536
v_pk_fma_f32 v[234:235], v[110:111], v[190:191], v[234:235]
v_pk_fma_f32 v[236:237], v[112:113], v[192:193], v[236:237]
v_cvt_pk_bf16_f32 v114, v234, v235
v_cvt_pk_bf16_f32 v115, v236, v237
buffer_load_dwordx4 v45, s[16:19], s48 offen lds
v_mfma_f32_16x16x16_bf16 v[58:61], v[124:125], v[134:135], v[178:181]
v_mfma_f32_16x16x16_bf16 v[62:65], v[126:127], v[134:135], v[170:173]
v_mfma_f32_16x16x16_bf16 v[66:69], v[126:127], v[136:137], v[174:177]
s_add_u32 m0, s73, 143360
s_add_u32 s48, s75, 98304
v_mfma_f32_16x16x16_bf16 v[70:73], v[128:129], v[136:137], v[170:173]
buffer_load_dwordx4 v45, s[16:19], s48 offen lds
v_mfma_f32_16x16x16_bf16 v[74:77], v[128:129], v[138:139], v[174:177]
v_mfma_f32_16x16x16_bf16 v[78:81], v[130:131], v[138:139], v[170:173]
v_mfma_f32_16x16x16_bf16 v[82:85], v[130:131], v[140:141], v[174:177]
s_add_u32 m0, s73, 151552
s_add_u32 s48, s75, 131072
v_mfma_f32_16x16x16_bf16 v[86:89], v[132:133], v[140:141], v[170:173]
buffer_load_dwordx4 v45, s[16:19], s48 offen lds
v_max3_f32 v190, v58, v59, v62
v_max3_f32 v191, v60, v61, v64
v_max_f32 v190, v190, v63
v_max_f32 v191, v191, v65
v_max_f32 v198, v190, v191
v_max3_f32 v192, v66, v67, v70
v_max3_f32 v193, v68, v69, v72
v_max_f32 v192, v192, v71
v_max_f32 v193, v193, v73
s_add_u32 m0, s73, 155648
s_add_u32 s48, s75, 163840
v_max_f32 v199, v192, v193
v_max3_f32 v194, v74, v75, v78
v_max3_f32 v195, v76, v77, v80
buffer_load_dwordx4 v45, s[16:19], s48 offen lds
v_max_f32 v194, v194, v79
v_max_f32 v195, v195, v81
v_max_f32 v200, v194, v195
v_max3_f32 v196, v82, v83, v86
v_max3_f32 v197, v84, v85, v88
v_max_f32 v196, v196, v87
v_max_f32 v197, v197, v89
v_max_f32 v201, v196, v197
s_add_u32 m0, s73, 159744
s_add_u32 s48, s75, 196608
v_permlane32_swap_b32 v198, v199
v_permlane32_swap_b32 v200, v201
buffer_load_dwordx4 v45, s[16:19], s48 offen lds
v_max_f32 v198, v198, v199
v_max_f32 v200, v200, v201
s_nop 1
v_permlane16_swap_b32 v198, v200
v_max_f32 v198, v198, v200
v_mul_f32 v198, s56, -v198
v_mov_b32 v200, v198
s_nop 1
v_permlane16_swap_b32 v198, v200
v_mov_b32 v199, v198
v_mov_b32 v201, v200
s_nop 0
v_permlane32_swap_b32 v198, v199
v_permlane32_swap_b32 v200, v201
v_pk_fma_f32 v[190:191], v[190:191], s[56:57], v[198:199] op_sel_hi:[1,1,0]
v_pk_fma_f32 v[192:193], v[192:193], s[56:57], v[198:199] op_sel:[0,0,1]
v_pk_fma_f32 v[194:195], v[194:195], s[56:57], v[200:201] op_sel_hi:[1,1,0]
v_pk_fma_f32 v[196:197], v[196:197], s[56:57], v[200:201] op_sel:[0,0,1]
v_exp_f32 v190, v190
v_exp_f32 v191, v191
v_exp_f32 v192, v192
v_exp_f32 v193, v193
v_exp_f32 v194, v194
v_exp_f32 v195, v195
v_exp_f32 v196, v196
v_exp_f32 v197, v197
v_cvt_pk_bf16_f32 v190, v190, v190
v_cvt_pk_bf16_f32 v191, v191, v191
v_cvt_pk_bf16_f32 v192, v192, v192
v_cvt_pk_bf16_f32 v193, v193, v193
v_cvt_pk_bf16_f32 v194, v194, v194
v_cvt_pk_bf16_f32 v195, v195, v195
v_cvt_pk_bf16_f32 v196, v196, v196
v_cvt_pk_bf16_f32 v197, v197, v197
v_and_b32 v206, v182, v190
v_and_b32 v207, v183, v191
v_and_b32 v208, v184, v190
v_and_b32 v209, v185, v191
v_and_b32 v210, v182, v192
v_and_b32 v211, v183, v193
v_and_b32 v212, v184, v192
v_and_b32 v213, v185, v193
v_and_b32 v214, v182, v194
v_and_b32 v215, v183, v195
v_and_b32 v216, v184, v194
v_and_b32 v217, v185, v195
v_and_b32 v218, v182, v196
v_and_b32 v219, v183, v197
v_and_b32 v220, v184, v196
v_and_b32 v221, v185, v197
v_mfma_f32_16x16x32_bf16 v[74:77], v[186:189], v[206:209], 0
v_mfma_f32_16x16x32_bf16 v[58:61], v[114:117], v[206:209], 0
v_mfma_f32_16x16x32_bf16 v[78:81], v[186:189], v[210:213], 0
v_mfma_f32_16x16x32_bf16 v[62:65], v[116:119], v[210:213], 0
v_mfma_f32_16x16x32_bf16 v[82:85], v[186:189], v[214:217], 0
v_mfma_f32_16x16x32_bf16 v[66:69], v[118:121], v[214:217], 0
v_mfma_f32_16x16x32_bf16 v[86:89], v[186:189], v[218:221], 0
v_mfma_f32_16x16x32_bf16 v[70:73], v[120:123], v[218:221], 0
s_lshl_b32 s58, s32, 16
s_add_u32 s58, s58, s52
s_lshr_b32 s59, s34, 1
s_lshl_b32 s59, s59, 10
s_add_u32 s58, s58, s59
s_add_u32 s61, s58, 0x800000
s_add_u32 s94, s61, 0x8000
v_rcp_f32 v74, v74
v_rcp_f32 v78, v78
v_rcp_f32 v82, v82
v_rcp_f32 v86, v86
v_pk_mul_f32 v[58:59], v[58:59], v[74:75] op_sel_hi:[1,0]
v_pk_mul_f32 v[60:61], v[60:61], v[74:75] op_sel_hi:[1,0]
v_pk_mul_f32 v[62:63], v[62:63], v[78:79] op_sel_hi:[1,0]
v_pk_mul_f32 v[64:65], v[64:65], v[78:79] op_sel_hi:[1,0]
v_pk_mul_f32 v[66:67], v[66:67], v[82:83] op_sel_hi:[1,0]
v_pk_mul_f32 v[68:69], v[68:69], v[82:83] op_sel_hi:[1,0]
v_pk_mul_f32 v[70:71], v[70:71], v[86:87] op_sel_hi:[1,0]
v_pk_mul_f32 v[72:73], v[72:73], v[86:87] op_sel_hi:[1,0]
v_cvt_pk_bf16_f32 v190, v58, v59
v_cvt_pk_bf16_f32 v191, v60, v61
v_cvt_pk_bf16_f32 v192, v62, v63
v_cvt_pk_bf16_f32 v193, v64, v65
v_cvt_pk_bf16_f32 v194, v66, v67
v_cvt_pk_bf16_f32 v195, v68, v69
v_cvt_pk_bf16_f32 v196, v70, v71
v_cvt_pk_bf16_f32 v197, v72, v73
v_permlane32_swap_b32 v190, v192
v_permlane32_swap_b32 v191, v193
v_permlane32_swap_b32 v194, v196
v_permlane32_swap_b32 v195, v197
s_waitcnt vmcnt(11)
CHK_22:
v_and_b32 v166, v252, v253
v_and_b32 v166, v166, v254
v_and_b32 v166, v166, v255
v_cmp_gt_u32 vcc, 8, v166
s_cbranch_vccz CHKD_23
v_lshrrev_b32 v166, 1, v0
v_lshlrev_b32 v166, 3, v166
v_and_b32 v252, 1, v0
v_or_b32 v166, v166, v252
v_lshlrev_b32 v166, 4, v166
s_mov_b32 s48, 0x54b000
buffer_load_dwordx4 v[252:255], v166, s[4:7], s48 offen sc1
s_waitcnt vmcnt(0)
s_sub_u32 s39, s39, 1
s_cbranch_scc0 CHK_22
s_branch BAIL
CHKD_23:
v_or_b32 v167, v252, v253
v_or3_b32 v167, v167, v254, v255
s_or_b32 s58, s72, 8
v_cmp_eq_u32 vcc, s58, v166
v_cmp_eq_u32 s[88:89], s58, v167
s_nop 0
s_and_b64 vcc, vcc, s[88:89]
s_lshr_b64 s[88:89], vcc, 1
s_and_b64 vcc, vcc, s[88:89]
s_lshl_b32 s58, s32, 1
s_lshr_b64 s[88:89], vcc, s58
s_and_b32 s99, s88, 5
s_sub_u32 s58, s58, 2
s_lshr_b64 s[88:89], vcc, s58
s_and_b32 s45, s88, 1
s_and_b32 s36, s99, 1
s_xor_b32 s36, s36, 1
s_cmp_lg_u32 s36, 0
s_cbranch_scc1 ALT_24
buffer_store_dwordx4 v[190:193], v52, s[4:7], s61 offen
buffer_store_dwordx4 v[194:197], v52, s[4:7], s94 offen
ALTE_25:
s_cmp_lg_u32 s36, 0
s_cbranch_scc1 ALT_26
v_mov_b32 v11, 1
s_waitcnt vmcnt(0)
s_mov_b64 exec, 1
buffer_store_dword v11, off, s[4:7], s42
s_mov_b64 exec, -1
ALTE_27:
v_lshlrev_b32 v166, 2, v0
s_mul_i32 s48, s33, 896
s_lshl_b32 s3, s34, 8
s_add_u32 s48, s48, s3
s_add_u32 s48, s48, 0x540000
s_add_u32 s3, s48, 0x2000
buffer_load_dword v252, v166, s[4:7], s48 offen sc1
buffer_load_dword v253, v166, s[4:7], s3 offen sc1
s_lshl_b32 s48, s33, 8
s_add_u32 s48, s48, 0x544000
buffer_load_dword v254, v166, s[4:7], s48 offen sc1
buffer_load_dword v255, v166, s[4:7], s48 offen offset:2048 sc1
s_and_b32 s44, s45, s99
s_cmp_eq_u32 s99, 5
s_cselect_b32 s45, 1, 0
s_cmp_eq_u32 s32, 0
s_cselect_b32 s44, 1, s44
s_cmp_eq_u32 s32, 31
s_cselect_b32 s45, 1, s45
s_xor_b32 s100, s45, 1
s_cmp_eq_u32 s34, 3
s_cselect_b32 s37, s100, 0
s_xor_b32 s100, s44, 1
s_cmp_eq_u32 s34, 0
s_cselect_b32 s38, s100, 0
s_or_b32 s38, s38, s37
s_lshl_b32 s100, s35, 5
s_add_u32 s93, s100, 0x548000
s_lshl_b32 s101, s32, 8
s_add_u32 s94, s101, 0x548f00
s_add_u32 s95, s101, 0x549180
s_lshl_b32 s101, s32, 7
s_add_u32 s92, s101, 0x547fe0
s_cmp_eq_u32 s44, 1
s_cselect_b32 s92, s92, s94
s_cmp_eq_u32 s32, 0
s_cselect_b32 s92, s93, s92
s_sub_u32 s90, s93, 32
s_cmp_eq_u32 s34, 0
s_cselect_b32 s90, s92, s90
s_add_u32 s91, s93, 32
s_cmp_eq_u32 s45, 1
s_cselect_b32 s95, s91, s95
s_cmp_eq_u32 s32, 31
s_cselect_b32 s95, s93, s95
s_cmp_eq_u32 s34, 3
s_cselect_b32 s91, s95, s91
v_and_b32 v246, 7, v0
v_lshlrev_b32 v246, 2, v246
v_and_b32 v247, 8, v0
v_cmp_ne_u32 vcc, 0, v247
v_add_u32 v248, s92, v246
s_nop 0
v_cndmask_b32 v7, v6, v248, vcc
s_lshl_b32 s101, s32, 7
s_add_u32 s101, s101, 0x548080
s_cmp_eq_u32 s45, 1
s_cselect_b32 s101, s101, s93
s_cmp_eq_u32 s32, 31
s_cselect_b32 s101, s93, s101
v_and_b32 v247, 16, v0
v_cmp_ne_u32 vcc, 0, v247
v_add_u32 v248, s101, v246
s_nop 0
v_cndmask_b32 v7, v7, v248, vcc
v_and_b32 v247, 0x1a, v0
v_cmp_eq_u32 vcc, 8, v247
v_add_u32 v248, s90, v246
s_nop 0
v_cndmask_b32 v9, v6, v248, vcc
PH2:
v_lshrrev_b32 v242, 5, v0
v_lshl_add_u32 v234, v242, 10, v2
v_lshl_add_u32 v235, v242, 10, v3
v_lshl_add_u32 v236, v242, 10, v4
v_lshl_add_u32 v237, v242, 10, v5
s_add_u32 s60, s47, 0
buffer_load_dwordx4 a[192:195], v50, s[4:7], s60 offen offset:0
ds_read_b64_tr_b16 v[90:91], v234 offset:0
ds_read_b64_tr_b16 v[92:93], v234 offset:1024
ds_read_b64_tr_b16 v[94:95], v235 offset:0
ds_read_b64_tr_b16 v[96:97], v235 offset:1024
ds_read_b64_tr_b16 v[98:99], v236 offset:0
ds_read_b64_tr_b16 v[100:101], v236 offset:1024
ds_read_b64_tr_b16 v[102:103], v237 offset:0
ds_read_b64_tr_b16 v[104:105], v237 offset:1024
buffer_load_dwordx4 a[196:199], v50, s[4:7], s60 offen offset:1024
ds_read_b64_tr_b16 v[106:107], v234 offset:4096
ds_read_b64_tr_b16 v[108:109], v234 offset:5120
ds_read_b64_tr_b16 v[110:111], v235 offset:4096
ds_read_b64_tr_b16 v[112:113], v235 offset:5120
ds_read_b64_tr_b16 v[114:115], v236 offset:4096
ds_read_b64_tr_b16 v[116:117], v236 offset:5120
ds_read_b64_tr_b16 v[118:119], v237 offset:4096
ds_read_b64_tr_b16 v[120:121], v237 offset:5120
buffer_load_dwordx4 a[200:203], v50, s[4:7], s60 offen offset:2048
ds_read_b64_tr_b16 v[122:123], v234 offset:8192
ds_read_b64_tr_b16 v[124:125], v234 offset:9216
ds_read_b64_tr_b16 v[126:127], v235 offset:8192
ds_read_b64_tr_b16 v[128:129], v235 offset:9216
ds_read_b64_tr_b16 v[130:131], v236 offset:8192
ds_read_b64_tr_b16 v[132:133], v236 offset:9216
ds_read_b64_tr_b16 v[134:135], v237 offset:8192
ds_read_b64_tr_b16 v[136:137], v237 offset:9216
buffer_load_dwordx4 a[204:207], v50, s[4:7], s60 offen offset:3072
ds_read_b64_tr_b16 v[138:139], v234 offset:12288
ds_read_b64_tr_b16 v[140:141], v234 offset:13312
ds_read_b64_tr_b16 v[142:143], v235 offset:12288
ds_read_b64_tr_b16 v[144:145], v235 offset:13312
ds_read_b64_tr_b16 v[146:147], v236 offset:12288
ds_read_b64_tr_b16 v[148:149], v236 offset:13312
ds_read_b64_tr_b16 v[150:151], v237 offset:12288
ds_read_b64_tr_b16 v[152:153], v237 offset:13312
s_add_u32 s60, s47, 4096
buffer_load_dwordx4 a[208:211], v50, s[4:7], s60 offen offset:0
POLL_28:
buffer_load_dword v11, v8, s[4:7], 0 offen sc1
s_waitcnt vmcnt(0)
v_cmp_gt_u32 vcc, 1, v11
s_cbranch_vccz POLLD_29
s_sub_u32 s39, s39, 1
s_cbranch_scc0 POLL_28
s_branch BAIL
POLLD_29:
s_add_u32 s61, s50, 0x800000
buffer_load_dwordx4 v[58:61], v1, s[4:7], s61 offen offset:0 sc1
buffer_load_dwordx4 v[62:65], v1, s[4:7], s61 offen offset:1024 sc1
buffer_load_dwordx4 v[66:69], v1, s[4:7], s61 offen offset:2048 sc1
ds_read_b64_tr_b16 v[154:155], v234 offset:16384
ds_read_b64_tr_b16 v[156:157], v234 offset:17408
ds_read_b64_tr_b16 v[158:159], v235 offset:16384
ds_read_b64_tr_b16 v[160:161], v235 offset:17408
ds_read_b64_tr_b16 v[162:163], v236 offset:16384
ds_read_b64_tr_b16 v[164:165], v236 offset:17408
ds_read_b64_tr_b16 v[166:167], v237 offset:16384
ds_read_b64_tr_b16 v[168:169], v237 offset:17408
buffer_load_dwordx4 v[70:73], v1, s[4:7], s61 offen offset:3072 sc1
s_add_u32 s61, s50, 0x801000
buffer_load_dwordx4 v[74:77], v1, s[4:7], s61 offen offset:0 sc1
ds_read_b64_tr_b16 v[170:171], v234 offset:20480
ds_read_b64_tr_b16 v[172:173], v234 offset:21504
ds_read_b64_tr_b16 v[174:175], v235 offset:20480
ds_read_b64_tr_b16 v[176:177], v235 offset:21504
ds_read_b64_tr_b16 v[178:179], v236 offset:20480
ds_read_b64_tr_b16 v[180:181], v236 offset:21504
ds_read_b64_tr_b16 v[182:183], v237 offset:20480
ds_read_b64_tr_b16 v[184:185], v237 offset:21504
buffer_load_dwordx4 v[78:81], v1, s[4:7], s61 offen offset:1024 sc1
buffer_load_dwordx4 v[82:85], v1, s[4:7], s61 offen offset:2048 sc1
ds_read_b64_tr_b16 v[186:187], v234 offset:24576
ds_read_b64_tr_b16 v[188:189], v234 offset:25600
ds_read_b64_tr_b16 v[190:191], v235 offset:24576
ds_read_b64_tr_b16 v[192:193], v235 offset:25600
ds_read_b64_tr_b16 v[194:195], v236 offset:24576
ds_read_b64_tr_b16 v[196:197], v236 offset:25600
ds_read_b64_tr_b16 v[198:199], v237 offset:24576
ds_read_b64_tr_b16 v[200:201], v237 offset:25600
ds_read_b64_tr_b16 v[202:203], v234 offset:28672
ds_read_b64_tr_b16 v[204:205], v234 offset:29696
ds_read_b64_tr_b16 v[206:207], v235 offset:28672
ds_read_b64_tr_b16 v[208:209], v235 offset:29696
ds_read_b64_tr_b16 v[210:211], v236 offset:28672
ds_read_b64_tr_b16 v[212:213], v236 offset:29696
ds_read_b64_tr_b16 v[214:215], v237 offset:28672
ds_read_b64_tr_b16 v[216:217], v237 offset:29696
s_waitcnt vmcnt(6) lgkmcnt(15)
v_mfma_f32_16x16x32_bf16 v[12:15], v[90:93], v[58:61], v[12:15]
buffer_load_dwordx4 v[86:89], v1, s[4:7], s61 offen offset:3072 sc1
ds_read_b64_tr_b16 v[90:91], v234 offset:32768
ds_read_b64_tr_b16 v[92:93], v234 offset:33792
v_mfma_f32_16x16x32_bf16 v[16:19], v[94:97], v[58:61], v[16:19]
ds_read_b64_tr_b16 v[94:95], v235 offset:32768
ds_read_b64_tr_b16 v[96:97], v235 offset:33792
v_mfma_f32_16x16x32_bf16 v[20:23], v[98:101], v[58:61], v[20:23]
ds_read_b64_tr_b16 v[98:99], v236 offset:32768
ds_read_b64_tr_b16 v[100:101], v236 offset:33792
v_mfma_f32_16x16x32_bf16 v[24:27], v[102:105], v[58:61], v[24:27]
ds_read_b64_tr_b16 v[102:103], v237 offset:32768
ds_read_b64_tr_b16 v[104:105], v237 offset:33792
s_waitcnt vmcnt(6) lgkmcnt(15)
v_mfma_f32_16x16x32_bf16 v[12:15], v[106:109], v[62:65], v[12:15]
s_add_u32 s61, s50, 0x802000
buffer_load_dwordx4 v[58:61], v1, s[4:7], s61 offen offset:0 sc1
ds_read_b64_tr_b16 v[106:107], v234 offset:36864
ds_read_b64_tr_b16 v[108:109], v234 offset:37888
v_mfma_f32_16x16x32_bf16 v[16:19], v[110:113], v[62:65], v[16:19]
ds_read_b64_tr_b16 v[110:111], v235 offset:36864
ds_read_b64_tr_b16 v[112:113], v235 offset:37888
v_mfma_f32_16x16x32_bf16 v[20:23], v[114:117], v[62:65], v[20:23]
ds_read_b64_tr_b16 v[114:115], v236 offset:36864
ds_read_b64_tr_b16 v[116:117], v236 offset:37888
v_mfma_f32_16x16x32_bf16 v[24:27], v[118:121], v[62:65], v[24:27]
ds_read_b64_tr_b16 v[118:119], v237 offset:36864
ds_read_b64_tr_b16 v[120:121], v237 offset:37888
s_waitcnt vmcnt(6) lgkmcnt(15)
v_mfma_f32_16x16x32_bf16 v[12:15], v[122:125], v[66:69], v[12:15]
buffer_load_dwordx4 v[62:65], v1, s[4:7], s61 offen offset:1024 sc1
ds_read_b64_tr_b16 v[122:123], v234 offset:40960
ds_read_b64_tr_b16 v[124:125], v234 offset:41984
v_mfma_f32_16x16x32_bf16 v[16:19], v[126:129], v[66:69], v[16:19]
ds_read_b64_tr_b16 v[126:127], v235 offset:40960
ds_read_b64_tr_b16 v[128:129], v235 offset:41984
v_mfma_f32_16x16x32_bf16 v[20:23], v[130:133], v[66:69], v[20:23]
ds_read_b64_tr_b16 v[130:131], v236 offset:40960
ds_read_b64_tr_b16 v[132:133], v236 offset:41984
v_mfma_f32_16x16x32_bf16 v[24:27], v[134:137], v[66:69], v[24:27]
ds_read_b64_tr_b16 v[134:135], v237 offset:40960
ds_read_b64_tr_b16 v[136:137], v237 offset:41984
s_waitcnt vmcnt(6) lgkmcnt(15)
v_mfma_f32_16x16x32_bf16 v[12:15], v[138:141], v[70:73], v[12:15]
buffer_load_dwordx4 v[66:69], v1, s[4:7], s61 offen offset:2048 sc1
ds_read_b64_tr_b16 v[138:139], v234 offset:45056
ds_read_b64_tr_b16 v[140:141], v234 offset:46080
v_mfma_f32_16x16x32_bf16 v[16:19], v[142:145], v[70:73], v[16:19]
ds_read_b64_tr_b16 v[142:143], v235 offset:45056
ds_read_b64_tr_b16 v[144:145], v235 offset:46080
v_mfma_f32_16x16x32_bf16 v[20:23], v[146:149], v[70:73], v[20:23]
ds_read_b64_tr_b16 v[146:147], v236 offset:45056
ds_read_b64_tr_b16 v[148:149], v236 offset:46080
v_mfma_f32_16x16x32_bf16 v[24:27], v[150:153], v[70:73], v[24:27]
ds_read_b64_tr_b16 v[150:151], v237 offset:45056
ds_read_b64_tr_b16 v[152:153], v237 offset:46080
s_waitcnt vmcnt(6) lgkmcnt(15)
v_mfma_f32_16x16x32_bf16 v[12:15], v[154:157], v[74:77], v[12:15]
buffer_load_dwordx4 v[70:73], v1, s[4:7], s61 offen offset:3072 sc1
ds_read_b64_tr_b16 v[154:155], v234 offset:49152
ds_read_b64_tr_b16 v[156:157], v234 offset:50176
v_mfma_f32_16x16x32_bf16 v[16:19], v[158:161], v[74:77], v[16:19]
ds_read_b64_tr_b16 v[158:159], v235 offset:49152
ds_read_b64_tr_b16 v[160:161], v235 offset:50176
v_mfma_f32_16x16x32_bf16 v[20:23], v[162:165], v[74:77], v[20:23]
ds_read_b64_tr_b16 v[162:163], v236 offset:49152
ds_read_b64_tr_b16 v[164:165], v236 offset:50176
v_mfma_f32_16x16x32_bf16 v[24:27], v[166:169], v[74:77], v[24:27]
ds_read_b64_tr_b16 v[166:167], v237 offset:49152
ds_read_b64_tr_b16 v[168:169], v237 offset:50176
s_waitcnt vmcnt(6) lgkmcnt(15)
v_mfma_f32_16x16x32_bf16 v[12:15], v[170:173], v[78:81], v[12:15]
s_add_u32 s61, s50, 0x803000
buffer_load_dwordx4 v[74:77], v1, s[4:7], s61 offen offset:0 sc1
ds_read_b64_tr_b16 v[170:171], v234 offset:53248
ds_read_b64_tr_b16 v[172:173], v234 offset:54272
v_mfma_f32_16x16x32_bf16 v[16:19], v[174:177], v[78:81], v[16:19]
ds_read_b64_tr_b16 v[174:175], v235 offset:53248
ds_read_b64_tr_b16 v[176:177], v235 offset:54272
v_mfma_f32_16x16x32_bf16 v[20:23], v[178:181], v[78:81], v[20:23]
ds_read_b64_tr_b16 v[178:179], v236 offset:53248
ds_read_b64_tr_b16 v[180:181], v236 offset:54272
v_mfma_f32_16x16x32_bf16 v[24:27], v[182:185], v[78:81], v[24:27]
ds_read_b64_tr_b16 v[182:183], v237 offset:53248
ds_read_b64_tr_b16 v[184:185], v237 offset:54272
s_waitcnt vmcnt(6) lgkmcnt(15)
v_mfma_f32_16x16x32_bf16 v[12:15], v[186:189], v[82:85], v[12:15]
buffer_load_dwordx4 v[78:81], v1, s[4:7], s61 offen offset:1024 sc1
ds_read_b64_tr_b16 v[186:187], v234 offset:57344
ds_read_b64_tr_b16 v[188:189], v234 offset:58368
v_mfma_f32_16x16x32_bf16 v[16:19], v[190:193], v[82:85], v[16:19]
ds_read_b64_tr_b16 v[190:191], v235 offset:57344
ds_read_b64_tr_b16 v[192:193], v235 offset:58368
v_mfma_f32_16x16x32_bf16 v[20:23], v[194:197], v[82:85], v[20:23]
ds_read_b64_tr_b16 v[194:195], v236 offset:57344
ds_read_b64_tr_b16 v[196:197], v236 offset:58368
v_mfma_f32_16x16x32_bf16 v[24:27], v[198:201], v[82:85], v[24:27]
ds_read_b64_tr_b16 v[198:199], v237 offset:57344
ds_read_b64_tr_b16 v[200:201], v237 offset:58368
s_waitcnt vmcnt(6) lgkmcnt(15)
v_mfma_f32_16x16x32_bf16 v[12:15], v[202:205], v[86:89], v[12:15]
buffer_load_dwordx4 v[82:85], v1, s[4:7], s61 offen offset:2048 sc1
ds_read_b64_tr_b16 v[202:203], v234 offset:61440
ds_read_b64_tr_b16 v[204:205], v234 offset:62464
v_mfma_f32_16x16x32_bf16 v[16:19], v[206:209], v[86:89], v[16:19]
ds_read_b64_tr_b16 v[206:207], v235 offset:61440
ds_read_b64_tr_b16 v[208:209], v235 offset:62464
v_mfma_f32_16x16x32_bf16 v[20:23], v[210:213], v[86:89], v[20:23]
ds_read_b64_tr_b16 v[210:211], v236 offset:61440
ds_read_b64_tr_b16 v[212:213], v236 offset:62464
v_mfma_f32_16x16x32_bf16 v[24:27], v[214:217], v[86:89], v[24:27]
ds_read_b64_tr_b16 v[214:215], v237 offset:61440
ds_read_b64_tr_b16 v[216:217], v237 offset:62464
s_waitcnt vmcnt(6) lgkmcnt(15)
v_mfma_f32_16x16x32_bf16 v[12:15], v[90:93], v[58:61], v[12:15]
v_add_f32 v252, v252, v253
buffer_load_dwordx4 v[86:89], v1, s[4:7], s61 offen offset:3072 sc1
v_mfma_f32_16x16x32_bf16 v[16:19], v[94:97], v[58:61], v[16:19]
v_add_f32 v254, v254, v255
v_lshlrev_b32 v253, 2, v0
v_mfma_f32_16x16x32_bf16 v[20:23], v[98:101], v[58:61], v[20:23]
s_lshl_b32 s58, s34, 8
s_add_u32 s58, s58, 149504
v_mfma_f32_16x16x32_bf16 v[24:27], v[102:105], v[58:61], v[24:27]
v_add_u32 v255, s58, v253
v_add_u32 v253, 149248, v253
s_waitcnt vmcnt(6) lgkmcnt(15)
v_mfma_f32_16x16x32_bf16 v[12:15], v[106:109], v[62:65], v[12:15]
ds_write_b32 v255, v252
buffer_load_dwordx4 a[212:215], v50, s[4:7], s60 offen offset:1024
v_mfma_f32_16x16x32_bf16 v[16:19], v[110:113], v[62:65], v[16:19]
ds_write_b32 v253, v254
v_cmp_eq_u32 vcc, 0x12, v247
v_add_u32 v248, s91, v246
s_nop 0
v_cndmask_b32 v9, v9, v248, vcc
v_mfma_f32_16x16x32_bf16 v[20:23], v[114:117], v[62:65], v[20:23]
s_add_u32 s100, s34, 0
s_and_b32 s100, s100, 3
v_mfma_f32_16x16x32_bf16 v[24:27], v[118:121], v[62:65], v[24:27]
s_lshl_b32 s101, s32, 2
s_add_u32 s100, s100, s101
s_waitcnt vmcnt(6) lgkmcnt(15)
v_mfma_f32_16x16x32_bf16 v[12:15], v[122:125], v[66:69], v[12:15]
s_lshl_b32 s100, s100, 14
buffer_load_dwordx4 a[216:219], v50, s[4:7], s60 offen offset:2048
v_mfma_f32_16x16x32_bf16 v[16:19], v[126:129], v[66:69], v[16:19]
s_add_u32 s100, s100, s74
s_add_u32 s80, s100, 0x800000
v_mfma_f32_16x16x32_bf16 v[20:23], v[130:133], v[66:69], v[20:23]
s_add_u32 s100, s34, 1
s_and_b32 s100, s100, 3
v_mfma_f32_16x16x32_bf16 v[24:27], v[134:137], v[66:69], v[24:27]
s_lshl_b32 s101, s32, 2
s_add_u32 s100, s100, s101
s_waitcnt vmcnt(6) lgkmcnt(15)
v_mfma_f32_16x16x32_bf16 v[12:15], v[138:141], v[70:73], v[12:15]
s_lshl_b32 s100, s100, 14
buffer_load_dwordx4 a[220:223], v50, s[4:7], s60 offen offset:3072
v_mfma_f32_16x16x32_bf16 v[16:19], v[142:145], v[70:73], v[16:19]
s_add_u32 s100, s100, s74
s_add_u32 s81, s100, 0x800000
v_mfma_f32_16x16x32_bf16 v[20:23], v[146:149], v[70:73], v[20:23]
s_add_u32 s100, s34, 2
s_and_b32 s100, s100, 3
v_mfma_f32_16x16x32_bf16 v[24:27], v[150:153], v[70:73], v[24:27]
s_lshl_b32 s101, s32, 2
s_add_u32 s100, s100, s101
s_waitcnt vmcnt(6) lgkmcnt(15)
v_mfma_f32_16x16x32_bf16 v[12:15], v[154:157], v[74:77], v[12:15]
s_lshl_b32 s100, s100, 14
s_add_u32 s60, s47, 8192
buffer_load_dwordx4 a[224:227], v50, s[4:7], s60 offen offset:0
v_mfma_f32_16x16x32_bf16 v[16:19], v[158:161], v[74:77], v[16:19]
s_add_u32 s100, s100, s74
s_add_u32 s82, s100, 0x800000
v_mfma_f32_16x16x32_bf16 v[20:23], v[162:165], v[74:77], v[20:23]
s_add_u32 s100, s34, 3
s_and_b32 s100, s100, 3
v_mfma_f32_16x16x32_bf16 v[24:27], v[166:169], v[74:77], v[24:27]
s_lshl_b32 s101, s32, 2
s_add_u32 s100, s100, s101
s_waitcnt vmcnt(6) lgkmcnt(15)
v_mfma_f32_16x16x32_bf16 v[12:15], v[170:173], v[78:81], v[12:15]
s_lshl_b32 s100, s100, 14
buffer_load_dwordx4 a[228:231], v50, s[4:7], s60 offen offset:1024
v_mfma_f32_16x16x32_bf16 v[16:19], v[174:177], v[78:81], v[16:19]
s_add_u32 s100, s100, s74
s_add_u32 s83, s100, 0x800000
v_mfma_f32_16x16x32_bf16 v[20:23], v[178:181], v[78:81], v[20:23]
s_lshl_b32 s100, s32, 15
v_mfma_f32_16x16x32_bf16 v[24:27], v[182:185], v[78:81], v[24:27]
s_waitcnt vmcnt(6) lgkmcnt(10)
v_mfma_f32_16x16x32_bf16 v[12:15], v[186:189], v[82:85], v[12:15]
buffer_load_dwordx4 a[232:235], v50, s[4:7], s60 offen offset:2048
v_mfma_f32_16x16x32_bf16 v[16:19], v[190:193], v[82:85], v[16:19]
v_mfma_f32_16x16x32_bf16 v[20:23], v[194:197], v[82:85], v[20:23]
v_mfma_f32_16x16x32_bf16 v[24:27], v[198:201], v[82:85], v[24:27]
s_waitcnt vmcnt(6) lgkmcnt(2)
v_mfma_f32_16x16x32_bf16 v[12:15], v[202:205], v[86:89], v[12:15]
buffer_load_dwordx4 a[236:239], v50, s[4:7], s60 offen offset:3072
v_mfma_f32_16x16x32_bf16 v[16:19], v[206:209], v[86:89], v[16:19]
v_mfma_f32_16x16x32_bf16 v[20:23], v[210:213], v[86:89], v[20:23]
v_mfma_f32_16x16x32_bf16 v[24:27], v[214:217], v[86:89], v[24:27]
s_add_u32 s58, s50, s52
s_add_u32 s58, s58, 0xa00000
s_nop 1
v_cvt_pk_bf16_f32 v106, v12, v13
v_cvt_pk_bf16_f32 v107, v14, v15
v_cvt_pk_bf16_f32 v108, v16, v17
v_cvt_pk_bf16_f32 v109, v18, v19
v_cvt_pk_bf16_f32 v110, v20, v21
v_cvt_pk_bf16_f32 v111, v22, v23
v_cvt_pk_bf16_f32 v112, v24, v25
v_cvt_pk_bf16_f32 v113, v26, v27
s_cmp_lg_u32 s36, 0
s_cbranch_scc1 ALT_30
buffer_store_dwordx4 v[106:109], v1, s[4:7], s58 offen
buffer_store_dwordx4 v[110:113], v1, s[4:7], s58 offen offset:1024
ALTE_31:
v_pk_add_f32 v[242:243], v[12:13], v[14:15]
v_pk_mul_f32 v[244:245], v[12:13], v[12:13]
v_pk_fma_f32 v[244:245], v[14:15], v[14:15], v[244:245]
v_pk_add_f32 v[242:243], v[242:243], v[16:17]
v_pk_fma_f32 v[244:245], v[16:17], v[16:17], v[244:245]
v_pk_add_f32 v[242:243], v[242:243], v[18:19]
v_pk_fma_f32 v[244:245], v[18:19], v[18:19], v[244:245]
v_pk_add_f32 v[242:243], v[242:243], v[20:21]
v_pk_fma_f32 v[244:245], v[20:21], v[20:21], v[244:245]
v_pk_add_f32 v[242:243], v[242:243], v[22:23]
v_pk_fma_f32 v[244:245], v[22:23], v[22:23], v[244:245]
v_pk_add_f32 v[242:243], v[242:243], v[24:25]
v_pk_fma_f32 v[244:245], v[24:25], v[24:25], v[244:245]
v_pk_add_f32 v[242:243], v[242:243], v[26:27]
v_pk_fma_f32 v[244:245], v[26:27], v[26:27], v[244:245]
v_add_f32 v242, v242, v243
v_add_f32 v244, v244, v245
s_nop 1
v_permlane32_swap_b32 v242, v244
v_add_f32 v242, v242, v244
v_mov_b32 v243, v242
s_nop 1
v_permlane16_swap_b32 v242, v243
v_add_f32 v242, v242, v243
s_add_u32 s58, s51, 0x1320000
s_cmp_lg_u32 s36, 0
s_cbranch_scc1 ALT_32
buffer_store_dword v242, v44, s[4:7], s58 offen
v_mov_b32 v11, 2
s_waitcnt vmcnt(0)
s_mov_b64 exec, 1
buffer_store_dword v11, off, s[4:7], s42
s_mov_b64 exec, -1
ALTE_33:
s_waitcnt lgkmcnt(0)
s_barrier
PH3:
v_add_u32 v234, 65536, v2
v_add_u32 v235, 65536, v3
v_add_u32 v236, 65536, v4
v_add_u32 v237, 65536, v5
v_and_b32 v252, 48, v0
v_add_u32 v252, 149248, v252
s_add_u32 m0, s73, 0
s_add_u32 s48, s75, 229376
buffer_load_dwordx4 v45, s[16:19], s48 offen lds
ds_read_b64_tr_b16 v[90:91], v234 offset:0
ds_read_b64_tr_b16 v[92:93], v234 offset:2048
ds_read_b64_tr_b16 v[94:95], v235 offset:0
ds_read_b64_tr_b16 v[96:97], v235 offset:2048
ds_read_b64_tr_b16 v[98:99], v236 offset:0
ds_read_b64_tr_b16 v[100:101], v236 offset:2048
ds_read_b64_tr_b16 v[102:103], v237 offset:0
ds_read_b64_tr_b16 v[104:105], v237 offset:2048
s_add_u32 m0, s73, 4096
s_add_u32 s48, s75, 262144
buffer_load_dwordx4 v45, s[16:19], s48 offen lds
ds_read_b64_tr_b16 v[106:107], v234 offset:4096
ds_read_b64_tr_b16 v[108:109], v234 offset:6144
ds_read_b64_tr_b16 v[110:111], v235 offset:4096
ds_read_b64_tr_b16 v[112:113], v235 offset:6144
ds_read_b64_tr_b16 v[114:115], v236 offset:4096
ds_read_b64_tr_b16 v[116:117], v236 offset:6144
ds_read_b64_tr_b16 v[118:119], v237 offset:4096
ds_read_b64_tr_b16 v[120:121], v237 offset:6144
s_add_u32 m0, s73, 8192
s_add_u32 s48, s75, 294912
buffer_load_dwordx4 v45, s[16:19], s48 offen lds
ds_read_b64_tr_b16 v[122:123], v234 offset:8192
ds_read_b64_tr_b16 v[124:125], v234 offset:10240
ds_read_b64_tr_b16 v[126:127], v235 offset:8192
ds_read_b64_tr_b16 v[128:129], v235 offset:10240
ds_read_b64_tr_b16 v[130:131], v236 offset:8192
ds_read_b64_tr_b16 v[132:133], v236 offset:10240
ds_read_b64_tr_b16 v[134:135], v237 offset:8192
ds_read_b64_tr_b16 v[136:137], v237 offset:10240
s_add_u32 m0, s73, 12288
s_add_u32 s48, s75, 327680
buffer_load_dwordx4 v45, s[16:19], s48 offen lds
ds_read_b64_tr_b16 v[138:139], v234 offset:12288
ds_read_b64_tr_b16 v[140:141], v234 offset:14336
ds_read_b64_tr_b16 v[142:143], v235 offset:12288
ds_read_b64_tr_b16 v[144:145], v235 offset:14336
ds_read_b64_tr_b16 v[146:147], v236 offset:12288
ds_read_b64_tr_b16 v[148:149], v236 offset:14336
ds_read_b64_tr_b16 v[150:151], v237 offset:12288
ds_read_b64_tr_b16 v[152:153], v237 offset:14336
s_add_u32 m0, s73, 16384
s_add_u32 s48, s75, 360448
buffer_load_dwordx4 v45, s[16:19], s48 offen lds
s_add_u32 s100, s100, 0x13f8000
s_add_u32 s101, s100, 0x4000
s_add_u32 s53, s53, 0xa00000
s_add_u32 s54, s54, 0x1320000
s_cmp_eq_u32 s44, 1
s_cselect_b32 s53, s53, s100
s_cselect_b32 s54, s54, s101
v_and_b32 v250, 15, v0
v_lshrrev_b32 v251, 4, v0
s_lshl_b32 s100, s32, 15
s_add_u32 s94, s100, 0xcf8000
s_add_u32 s95, s100, 0xd0c000
s_sub_u32 s90, s50, 0x4000
s_add_u32 s91, s50, 0x4000
s_cmp_eq_u32 s44, 1
s_cselect_b32 s94, s90, s94
s_cmp_eq_u32 s32, 0
s_cselect_b32 s94, 0x80000000, s94
s_cmp_eq_u32 s34, 0
s_cselect_b32 s90, s94, s90
s_cmp_eq_u32 s45, 1
s_cselect_b32 s95, s91, s95
s_cmp_eq_u32 s32, 31
s_cselect_b32 s95, 0x80000000, s95
s_cmp_eq_u32 s34, 3
s_cselect_b32 s91, s95, s91
v_add_u32 v246, -1, v250
v_cmp_lt_u32 vcc, 15, v246
v_and_b32 v246, 15, v246
v_lshlrev_b32 v246, 4, v246
v_lshl_add_u32 v246, v251, 8, v246
v_mov_b32 v247, s50
v_mov_b32 v248, s90
v_cndmask_b32 v247, v247, v248, vcc
v_add_u32 v46, v246, v247
v_add_u32 v246, 1, v250
v_cmp_lt_u32 vcc, 15, v246
v_and_b32 v246, 15, v246
v_lshlrev_b32 v246, 4, v246
v_lshl_add_u32 v246, v251, 8, v246
v_mov_b32 v247, s50
v_mov_b32 v248, s91
v_cndmask_b32 v247, v247, v248, vcc
v_add_u32 v47, v246, v247
v_add_u32 v246, -2, v250
v_cmp_lt_u32 vcc, 15, v246
v_and_b32 v246, 15, v246
v_lshlrev_b32 v246, 4, v246
v_lshl_add_u32 v246, v251, 8, v246
v_mov_b32 v247, s50
v_mov_b32 v248, s90
v_cndmask_b32 v247, v247, v248, vcc
v_add_u32 v48, v246, v247
v_add_u32 v246, 2, v250
v_cmp_lt_u32 vcc, 15, v246
v_and_b32 v246, 15, v246
v_lshlrev_b32 v246, 4, v246
v_lshl_add_u32 v246, v251, 8, v246
v_mov_b32 v247, s50
v_mov_b32 v248, s91
v_cndmask_b32 v247, v247, v248, vcc
v_add_u32 v49, v246, v247
POLL_34:
buffer_load_dword v11, v6, s[4:7], 0 offen sc1
s_waitcnt vmcnt(0)
v_cmp_gt_u32 vcc, 2, v11
s_cbranch_vccz POLLD_35
s_sub_u32 s39, s39, 1
s_cbranch_scc0 POLL_34
s_branch BAIL
POLLD_35:
s_add_u32 s61, s50, 0xa00000
buffer_load_dwordx4 v[58:61], v1, s[4:7], s61 offen offset:0 sc1
buffer_load_dwordx4 v[62:65], v1, s[4:7], s61 offen offset:1024 sc1
buffer_load_dwordx4 v[66:69], v1, s[4:7], s61 offen offset:2048 sc1
ds_read_b64_tr_b16 v[154:155], v234 offset:16384
ds_read_b64_tr_b16 v[156:157], v234 offset:18432
ds_read_b64_tr_b16 v[158:159], v235 offset:16384
ds_read_b64_tr_b16 v[160:161], v235 offset:18432
ds_read_b64_tr_b16 v[162:163], v236 offset:16384
ds_read_b64_tr_b16 v[164:165], v236 offset:18432
ds_read_b64_tr_b16 v[166:167], v237 offset:16384
ds_read_b64_tr_b16 v[168:169], v237 offset:18432
buffer_load_dwordx4 v[70:73], v1, s[4:7], s61 offen offset:3072 sc1
s_add_u32 s61, s50, 0xa01000
buffer_load_dwordx4 v[74:77], v1, s[4:7], s61 offen offset:0 sc1
ds_read_b64_tr_b16 v[170:171], v234 offset:20480
ds_read_b64_tr_b16 v[172:173], v234 offset:22528
ds_read_b64_tr_b16 v[174:175], v235 offset:20480
ds_read_b64_tr_b16 v[176:177], v235 offset:22528
ds_read_b64_tr_b16 v[178:179], v236 offset:20480
ds_read_b64_tr_b16 v[180:181], v236 offset:22528
ds_read_b64_tr_b16 v[182:183], v237 offset:20480
ds_read_b64_tr_b16 v[184:185], v237 offset:22528
buffer_load_dwordx4 v[78:81], v1, s[4:7], s61 offen offset:1024 sc1
buffer_load_dwordx4 v[82:85], v1, s[4:7], s61 offen offset:2048 sc1
ds_read_b64_tr_b16 v[186:187], v234 offset:24576
ds_read_b64_tr_b16 v[188:189], v234 offset:26624
ds_read_b64_tr_b16 v[190:191], v235 offset:24576
ds_read_b64_tr_b16 v[192:193], v235 offset:26624
ds_read_b64_tr_b16 v[194:195], v236 offset:24576
ds_read_b64_tr_b16 v[196:197], v236 offset:26624
ds_read_b64_tr_b16 v[198:199], v237 offset:24576
ds_read_b64_tr_b16 v[200:201], v237 offset:26624
ds_read_b64_tr_b16 v[202:203], v234 offset:28672
ds_read_b64_tr_b16 v[204:205], v234 offset:30720
ds_read_b64_tr_b16 v[206:207], v235 offset:28672
ds_read_b64_tr_b16 v[208:209], v235 offset:30720
ds_read_b64_tr_b16 v[210:211], v236 offset:28672
ds_read_b64_tr_b16 v[212:213], v236 offset:30720
ds_read_b64_tr_b16 v[214:215], v237 offset:28672
ds_read_b64_tr_b16 v[216:217], v237 offset:30720
s_waitcnt vmcnt(6) lgkmcnt(15)
v_mfma_f32_16x16x32_bf16 v[218:221], v[90:93], v[58:61], 0
buffer_load_dwordx4 v[86:89], v1, s[4:7], s61 offen offset:3072 sc1
ds_read_b64_tr_b16 v[90:91], v234 offset:32768
ds_read_b64_tr_b16 v[92:93], v234 offset:34816
v_mfma_f32_16x16x32_bf16 v[222:225], v[94:97], v[58:61], 0
ds_read_b64_tr_b16 v[94:95], v235 offset:32768
ds_read_b64_tr_b16 v[96:97], v235 offset:34816
v_mfma_f32_16x16x32_bf16 v[226:229], v[98:101], v[58:61], 0
ds_read_b64_tr_b16 v[98:99], v236 offset:32768
ds_read_b64_tr_b16 v[100:101], v236 offset:34816
v_mfma_f32_16x16x32_bf16 v[230:233], v[102:105], v[58:61], 0
ds_read_b64_tr_b16 v[102:103], v237 offset:32768
ds_read_b64_tr_b16 v[104:105], v237 offset:34816
s_waitcnt vmcnt(6) lgkmcnt(15)
v_mfma_f32_16x16x32_bf16 v[218:221], v[106:109], v[62:65], v[218:221]
s_add_u32 s61, s50, 0xa02000
buffer_load_dwordx4 v[58:61], v1, s[4:7], s61 offen offset:0 sc1
ds_read_b64_tr_b16 v[106:107], v234 offset:36864
ds_read_b64_tr_b16 v[108:109], v234 offset:38912
v_mfma_f32_16x16x32_bf16 v[222:225], v[110:113], v[62:65], v[222:225]
ds_read_b64_tr_b16 v[110:111], v235 offset:36864
ds_read_b64_tr_b16 v[112:113], v235 offset:38912
v_mfma_f32_16x16x32_bf16 v[226:229], v[114:117], v[62:65], v[226:229]
ds_read_b64_tr_b16 v[114:115], v236 offset:36864
ds_read_b64_tr_b16 v[116:117], v236 offset:38912
v_mfma_f32_16x16x32_bf16 v[230:233], v[118:121], v[62:65], v[230:233]
ds_read_b64_tr_b16 v[118:119], v237 offset:36864
ds_read_b64_tr_b16 v[120:121], v237 offset:38912
s_waitcnt vmcnt(6) lgkmcnt(15)
v_mfma_f32_16x16x32_bf16 v[218:221], v[122:125], v[66:69], v[218:221]
s_add_u32 s48, s51, 0x1320000
buffer_load_dwordx4 v[238:241], v1, s[4:7], s48 offen sc1
buffer_load_dwordx4 v[62:65], v1, s[4:7], s61 offen offset:1024 sc1
ds_read_b64_tr_b16 v[122:123], v234 offset:40960
ds_read_b64_tr_b16 v[124:125], v234 offset:43008
v_mfma_f32_16x16x32_bf16 v[222:225], v[126:129], v[66:69], v[222:225]
ds_read_b64_tr_b16 v[126:127], v235 offset:40960
ds_read_b64_tr_b16 v[128:129], v235 offset:43008
v_mfma_f32_16x16x32_bf16 v[226:229], v[130:133], v[66:69], v[226:229]
ds_read_b64_tr_b16 v[130:131], v236 offset:40960
ds_read_b64_tr_b16 v[132:133], v236 offset:43008
v_mfma_f32_16x16x32_bf16 v[230:233], v[134:137], v[66:69], v[230:233]
ds_read_b64_tr_b16 v[134:135], v237 offset:40960
ds_read_b64_tr_b16 v[136:137], v237 offset:43008
s_waitcnt vmcnt(7) lgkmcnt(15)
v_mfma_f32_16x16x32_bf16 v[218:221], v[138:141], v[70:73], v[218:221]
buffer_load_dwordx4 v[66:69], v1, s[4:7], s61 offen offset:2048 sc1
ds_read_b64_tr_b16 v[138:139], v234 offset:45056
ds_read_b64_tr_b16 v[140:141], v234 offset:47104
v_mfma_f32_16x16x32_bf16 v[222:225], v[142:145], v[70:73], v[222:225]
ds_read_b64_tr_b16 v[142:143], v235 offset:45056
ds_read_b64_tr_b16 v[144:145], v235 offset:47104
v_mfma_f32_16x16x32_bf16 v[226:229], v[146:149], v[70:73], v[226:229]
ds_read_b64_tr_b16 v[146:147], v236 offset:45056
ds_read_b64_tr_b16 v[148:149], v236 offset:47104
v_mfma_f32_16x16x32_bf16 v[230:233], v[150:153], v[70:73], v[230:233]
ds_read_b64_tr_b16 v[150:151], v237 offset:45056
ds_read_b64_tr_b16 v[152:153], v237 offset:47104
s_waitcnt vmcnt(7) lgkmcnt(15)
v_mfma_f32_16x16x32_bf16 v[218:221], v[154:157], v[74:77], v[218:221]
buffer_load_dwordx4 v[70:73], v1, s[4:7], s61 offen offset:3072 sc1
ds_read_b64_tr_b16 v[154:155], v234 offset:49152
ds_read_b64_tr_b16 v[156:157], v234 offset:51200
v_mfma_f32_16x16x32_bf16 v[222:225], v[158:161], v[74:77], v[222:225]
ds_read_b64_tr_b16 v[158:159], v235 offset:49152
ds_read_b64_tr_b16 v[160:161], v235 offset:51200
v_mfma_f32_16x16x32_bf16 v[226:229], v[162:165], v[74:77], v[226:229]
ds_read_b64_tr_b16 v[162:163], v236 offset:49152
ds_read_b64_tr_b16 v[164:165], v236 offset:51200
v_mfma_f32_16x16x32_bf16 v[230:233], v[166:169], v[74:77], v[230:233]
ds_read_b64_tr_b16 v[166:167], v237 offset:49152
ds_read_b64_tr_b16 v[168:169], v237 offset:51200
s_waitcnt vmcnt(7) lgkmcnt(15)
v_mfma_f32_16x16x32_bf16 v[218:221], v[170:173], v[78:81], v[218:221]
s_add_u32 s61, s50, 0xa03000
buffer_load_dwordx4 v[74:77], v1, s[4:7], s61 offen offset:0 sc1
ds_read_b64_tr_b16 v[170:171], v234 offset:53248
ds_read_b64_tr_b16 v[172:173], v234 offset:55296
v_mfma_f32_16x16x32_bf16 v[222:225], v[174:177], v[78:81], v[222:225]
ds_read_b64_tr_b16 v[174:175], v235 offset:53248
ds_read_b64_tr_b16 v[176:177], v235 offset:55296
v_mfma_f32_16x16x32_bf16 v[226:229], v[178:181], v[78:81], v[226:229]
ds_read_b64_tr_b16 v[178:179], v236 offset:53248
ds_read_b64_tr_b16 v[180:181], v236 offset:55296
v_mfma_f32_16x16x32_bf16 v[230:233], v[182:185], v[78:81], v[230:233]
ds_read_b64_tr_b16 v[182:183], v237 offset:53248
ds_read_b64_tr_b16 v[184:185], v237 offset:55296
s_waitcnt vmcnt(7) lgkmcnt(15)
v_mfma_f32_16x16x32_bf16 v[218:221], v[186:189], v[82:85], v[218:221]
buffer_load_dwordx4 v[78:81], v1, s[4:7], s61 offen offset:1024 sc1
ds_read_b64_tr_b16 v[186:187], v234 offset:57344
ds_read_b64_tr_b16 v[188:189], v234 offset:59392
v_mfma_f32_16x16x32_bf16 v[222:225], v[190:193], v[82:85], v[222:225]
ds_read_b64_tr_b16 v[190:191], v235 offset:57344
ds_read_b64_tr_b16 v[192:193], v235 offset:59392
v_mfma_f32_16x16x32_bf16 v[226:229], v[194:197], v[82:85], v[226:229]
ds_read_b64_tr_b16 v[194:195], v236 offset:57344
ds_read_b64_tr_b16 v[196:197], v236 offset:59392
v_mfma_f32_16x16x32_bf16 v[230:233], v[198:201], v[82:85], v[230:233]
ds_read_b64_tr_b16 v[198:199], v237 offset:57344
ds_read_b64_tr_b16 v[200:201], v237 offset:59392
s_waitcnt vmcnt(7) lgkmcnt(15)
v_mfma_f32_16x16x32_bf16 v[218:221], v[202:205], v[86:89], v[218:221]
buffer_load_dwordx4 v[82:85], v1, s[4:7], s61 offen offset:2048 sc1
ds_read_b64_tr_b16 v[202:203], v234 offset:61440
ds_read_b64_tr_b16 v[204:205], v234 offset:63488
v_mfma_f32_16x16x32_bf16 v[222:225], v[206:209], v[86:89], v[222:225]
ds_read_b64_tr_b16 v[206:207], v235 offset:61440
ds_read_b64_tr_b16 v[208:209], v235 offset:63488
v_mfma_f32_16x16x32_bf16 v[226:229], v[210:213], v[86:89], v[226:229]
ds_read_b64_tr_b16 v[210:211], v236 offset:61440
ds_read_b64_tr_b16 v[212:213], v236 offset:63488
v_mfma_f32_16x16x32_bf16 v[230:233], v[214:217], v[86:89], v[230:233]
ds_read_b64_tr_b16 v[214:215], v237 offset:61440
ds_read_b64_tr_b16 v[216:217], v237 offset:63488
s_waitcnt vmcnt(7) lgkmcnt(15)
v_mfma_f32_16x16x32_bf16 v[218:221], v[90:93], v[58:61], v[218:221]
ds_read_b128 v[90:93], v252 offset:0
buffer_load_dwordx4 v[86:89], v1, s[4:7], s61 offen offset:3072 sc1
v_mfma_f32_16x16x32_bf16 v[222:225], v[94:97], v[58:61], v[222:225]
ds_read_b128 v[94:97], v252 offset:64
v_mfma_f32_16x16x32_bf16 v[226:229], v[98:101], v[58:61], v[226:229]
ds_read_b128 v[98:101], v252 offset:128
v_mfma_f32_16x16x32_bf16 v[230:233], v[102:105], v[58:61], v[230:233]
ds_read_b128 v[102:105], v252 offset:192
s_waitcnt vmcnt(6) lgkmcnt(15)
v_mfma_f32_16x16x32_bf16 v[218:221], v[106:109], v[62:65], v[218:221]
v_add_f32 v238, v238, v240
s_add_u32 m0, s73, 20480
s_add_u32 s48, s75, 393216
v_mfma_f32_16x16x32_bf16 v[222:225], v[110:113], v[62:65], v[222:225]
v_add_f32 v239, v239, v241
s_nop 1
v_permlane32_swap_b32 v238, v239
v_mfma_f32_16x16x32_bf16 v[226:229], v[114:117], v[62:65], v[226:229]
v_add_f32 v238, v238, v239
v_mov_b32 v239, v238
v_mfma_f32_16x16x32_bf16 v[230:233], v[118:121], v[62:65], v[230:233]
s_nop 0
v_permlane16_swap_b32 v238, v239
v_add_f32 v238, v238, v239
s_waitcnt vmcnt(5) lgkmcnt(15)
v_mfma_f32_16x16x32_bf16 v[218:221], v[122:125], v[66:69], v[218:221]
v_mov_b32 v239, v238
buffer_load_dwordx4 v45, s[16:19], s48 offen lds
v_mfma_f32_16x16x32_bf16 v[222:225], v[126:129], v[66:69], v[222:225]
v_permlane32_swap_b32 v238, v239
v_mul_f32 v247, 0x3b000000, v238
v_mfma_f32_16x16x32_bf16 v[226:229], v[130:133], v[66:69], v[226:229]
v_mul_f32 v239, 0x3b000000, v239
v_fma_f32 v243, -v247, v247, v239
v_mfma_f32_16x16x32_bf16 v[230:233], v[134:137], v[66:69], v[230:233]
v_max_f32 v243, 0, v243
v_add_f32 v242, 0x3727c5ac, v243
s_waitcnt vmcnt(5) lgkmcnt(15)
v_mfma_f32_16x16x32_bf16 v[218:221], v[138:141], v[70:73], v[218:221]
s_waitcnt lgkmcnt(0)
v_rsq_f32 v248, v242
s_add_u32 m0, s73, 24576
s_add_u32 s48, s75, 425984
v_mfma_f32_16x16x32_bf16 v[222:225], v[142:145], v[70:73], v[222:225]
v_mul_f32 v90, v90, -v247
v_mul_f32 v91, v91, -v247
v_mfma_f32_16x16x32_bf16 v[226:229], v[146:149], v[70:73], v[226:229]
v_mul_f32 v92, v92, -v247
v_mul_f32 v93, v93, -v247
v_mfma_f32_16x16x32_bf16 v[230:233], v[150:153], v[70:73], v[230:233]
v_mul_f32 v94, v94, -v247
v_mul_f32 v95, v95, -v247
s_waitcnt vmcnt(4)
v_mfma_f32_16x16x32_bf16 v[218:221], v[154:157], v[74:77], v[218:221]
v_mul_f32 v96, v96, -v247
buffer_load_dwordx4 v45, s[16:19], s48 offen lds
v_mfma_f32_16x16x32_bf16 v[222:225], v[158:161], v[74:77], v[222:225]
v_mul_f32 v97, v97, -v247
v_mul_f32 v98, v98, -v247
v_mfma_f32_16x16x32_bf16 v[226:229], v[162:165], v[74:77], v[226:229]
v_mul_f32 v99, v99, -v247
v_mul_f32 v100, v100, -v247
v_mfma_f32_16x16x32_bf16 v[230:233], v[166:169], v[74:77], v[230:233]
v_mul_f32 v101, v101, -v247
v_mul_f32 v102, v102, -v247
s_waitcnt vmcnt(4)
v_mfma_f32_16x16x32_bf16 v[218:221], v[170:173], v[78:81], v[218:221]
v_mul_f32 v103, v103, -v247
s_add_u32 m0, s73, 28672
s_add_u32 s48, s75, 458752
v_mfma_f32_16x16x32_bf16 v[222:225], v[174:177], v[78:81], v[222:225]
v_mul_f32 v104, v104, -v247
v_mul_f32 v105, v105, -v247
v_mfma_f32_16x16x32_bf16 v[226:229], v[178:181], v[78:81], v[226:229]
v_mul_f32 v242, v248, v248
v_mul_f32 v242, v242, v243
v_mfma_f32_16x16x32_bf16 v[230:233], v[182:185], v[78:81], v[230:233]
v_add_f32 v242, 0x3727c5ac, v242
v_rsq_f32 v242, v242
s_waitcnt vmcnt(3)
v_mfma_f32_16x16x32_bf16 v[218:221], v[186:189], v[82:85], v[218:221]
v_mul_f32 v242, v242, v248
buffer_load_dwordx4 v45, s[16:19], s48 offen lds
v_mfma_f32_16x16x32_bf16 v[222:225], v[190:193], v[82:85], v[222:225]
v_rcp_f32 v246, v242
v_mul_f32 v244, 0xc0135761, v242
v_mfma_f32_16x16x32_bf16 v[226:229], v[194:197], v[82:85], v[226:229]
v_mul_f32 v242, v242, v242
v_mul_f32 v245, 0x3d372713, v242
v_mfma_f32_16x16x32_bf16 v[230:233], v[198:201], v[82:85], v[230:233]
v_mul_f32 v245, v245, v244
s_waitcnt vmcnt(3)
v_mfma_f32_16x16x32_bf16 v[218:221], v[202:205], v[86:89], v[218:221]
s_add_u32 m0, s73, 32768
s_add_u32 s48, s75, 491520
v_mfma_f32_16x16x32_bf16 v[222:225], v[206:209], v[86:89], v[222:225]
v_mfma_f32_16x16x32_bf16 v[226:229], v[210:213], v[86:89], v[226:229]
v_mfma_f32_16x16x32_bf16 v[230:233], v[214:217], v[86:89], v[230:233]
s_nop 2
v_pk_add_f32 v[218:219], v[218:219], v[90:91]
buffer_load_dwordx4 v45, s[16:19], s48 offen lds
v_pk_add_f32 v[220:221], v[220:221], v[92:93]
v_pk_add_f32 v[222:223], v[222:223], v[94:95]
v_pk_add_f32 v[224:225], v[224:225], v[96:97]
v_pk_add_f32 v[226:227], v[226:227], v[98:99]
v_pk_add_f32 v[228:229], v[228:229], v[100:101]
v_pk_add_f32 v[230:231], v[230:231], v[102:103]
v_pk_add_f32 v[232:233], v[232:233], v[104:105]
v_pk_mul_f32 v[114:115], v[218:219], v[218:219]
v_pk_mul_f32 v[116:117], v[220:221], v[220:221]
v_pk_mul_f32 v[118:119], v[222:223], v[222:223]
v_pk_mul_f32 v[120:121], v[224:225], v[224:225]
v_pk_mul_f32 v[122:123], v[226:227], v[226:227]
v_pk_mul_f32 v[124:125], v[228:229], v[228:229]
s_add_u32 s60, s47, 12288
buffer_load_dwordx4 a[240:243], v50, s[4:7], s60 offen offset:0
v_pk_mul_f32 v[126:127], v[230:231], v[230:231]
v_pk_mul_f32 v[128:129], v[232:233], v[232:233]
v_pk_fma_f32 v[114:115], v[114:115], v[244:245], v[244:245] op_sel:[0,1,0] op_sel_hi:[1,1,0]
v_pk_fma_f32 v[116:117], v[116:117], v[244:245], v[244:245] op_sel:[0,1,0] op_sel_hi:[1,1,0]
v_pk_fma_f32 v[118:119], v[118:119], v[244:245], v[244:245] op_sel:[0,1,0] op_sel_hi:[1,1,0]
v_pk_fma_f32 v[120:121], v[120:121], v[244:245], v[244:245] op_sel:[0,1,0] op_sel_hi:[1,1,0]
v_pk_fma_f32 v[122:123], v[122:123], v[244:245], v[244:245] op_sel:[0,1,0] op_sel_hi:[1,1,0]
v_pk_fma_f32 v[124:125], v[124:125], v[244:245], v[244:245] op_sel:[0,1,0] op_sel_hi:[1,1,0]
v_pk_fma_f32 v[126:127], v[126:127], v[244:245], v[244:245] op_sel:[0,1,0] op_sel_hi:[1,1,0]
v_pk_fma_f32 v[128:129], v[128:129], v[244:245], v[244:245] op_sel:[0,1,0] op_sel_hi:[1,1,0]
v_pk_mul_f32 v[114:115], v[114:115], v[218:219]
v_pk_mul_f32 v[116:117], v[116:117], v[220:221]
v_pk_mul_f32 v[118:119], v[118:119], v[222:223]
buffer_load_dwordx4 a[244:247], v50, s[4:7], s60 offen offset:1024
v_pk_mul_f32 v[120:121], v[120:121], v[224:225]
v_pk_mul_f32 v[122:123], v[122:123], v[226:227]
v_pk_mul_f32 v[124:125], v[124:125], v[228:229]
v_pk_mul_f32 v[126:127], v[126:127], v[230:231]
v_pk_mul_f32 v[128:129], v[128:129], v[232:233]
v_exp_f32 v114, v114
v_exp_f32 v115, v115
v_exp_f32 v116, v116
v_exp_f32 v117, v117
buffer_load_dwordx4 a[248:251], v50, s[4:7], s60 offen offset:2048
v_exp_f32 v118, v118
v_exp_f32 v119, v119
v_exp_f32 v120, v120
v_exp_f32 v121, v121
v_exp_f32 v122, v122
v_exp_f32 v123, v123
v_exp_f32 v124, v124
buffer_load_dwordx4 a[252:255], v50, s[4:7], s60 offen offset:3072
v_exp_f32 v125, v125
v_exp_f32 v126, v126
v_exp_f32 v127, v127
v_exp_f32 v128, v128
v_exp_f32 v129, v129
v_pk_fma_f32 v[114:115], v[114:115], v[246:247], v[246:247] op_sel_hi:[1,0,0]
v_pk_fma_f32 v[116:117], v[116:117], v[246:247], v[246:247] op_sel_hi:[1,0,0]
v_pk_fma_f32 v[118:119], v[118:119], v[246:247], v[246:247] op_sel_hi:[1,0,0]
v_pk_fma_f32 v[120:121], v[120:121], v[246:247], v[246:247] op_sel_hi:[1,0,0]
v_pk_fma_f32 v[122:123], v[122:123], v[246:247], v[246:247] op_sel_hi:[1,0,0]
v_pk_fma_f32 v[124:125], v[124:125], v[246:247], v[246:247] op_sel_hi:[1,0,0]
v_pk_fma_f32 v[126:127], v[126:127], v[246:247], v[246:247] op_sel_hi:[1,0,0]
v_pk_fma_f32 v[128:129], v[128:129], v[246:247], v[246:247] op_sel_hi:[1,0,0]
v_rcp_f32 v114, v114
v_rcp_f32 v115, v115
v_rcp_f32 v116, v116
v_rcp_f32 v117, v117
v_rcp_f32 v118, v118
v_rcp_f32 v119, v119
v_rcp_f32 v120, v120
v_rcp_f32 v121, v121
v_rcp_f32 v122, v122
v_rcp_f32 v123, v123
v_rcp_f32 v124, v124
v_rcp_f32 v125, v125
v_rcp_f32 v126, v126
v_rcp_f32 v127, v127
v_rcp_f32 v128, v128
v_rcp_f32 v129, v129
v_pk_mul_f32 v[218:219], v[218:219], v[114:115]
v_pk_mul_f32 v[220:221], v[220:221], v[116:117]
v_pk_mul_f32 v[222:223], v[222:223], v[118:119]
v_pk_mul_f32 v[224:225], v[224:225], v[120:121]
v_pk_mul_f32 v[226:227], v[226:227], v[122:123]
v_pk_mul_f32 v[228:229], v[228:229], v[124:125]
v_pk_mul_f32 v[230:231], v[230:231], v[126:127]
v_pk_mul_f32 v[232:233], v[232:233], v[128:129]
s_add_u32 s58, s50, s52
s_add_u32 s58, s58, 0x800000
v_cvt_pk_bf16_f32 v106, v218, v219
v_cvt_pk_bf16_f32 v107, v220, v221
v_cvt_pk_bf16_f32 v108, v222, v223
v_cvt_pk_bf16_f32 v109, v224, v225
v_cvt_pk_bf16_f32 v110, v226, v227
v_cvt_pk_bf16_f32 v111, v228, v229
v_cvt_pk_bf16_f32 v112, v230, v231
v_cvt_pk_bf16_f32 v113, v232, v233
s_cmp_lg_u32 s36, 0
s_cbranch_scc1 ALT_36
buffer_store_dwordx4 v[106:109], v1, s[4:7], s58 offen
buffer_store_dwordx4 v[110:113], v1, s[4:7], s58 offen offset:1024
ALTE_37:
s_lshl_b32 s58, s32, 15
s_add_u32 s58, s58, s52
s_cmp_eq_u32 s34, 0
s_cselect_b32 s59, 0x4000, 0
s_add_u32 s58, s58, s59
s_add_u32 s61, s58, 0x1500000
s_cmp_lg_u32 s36, 0
s_cbranch_scc1 ALT_38
v_mov_b32 v11, 3
s_cmp_eq_u32 s38, 0
s_cbranch_scc1 EXP_42
buffer_store_dwordx4 v[106:109], v1, s[4:7], s61 offen sc1
buffer_store_dwordx4 v[110:113], v1, s[4:7], s61 offen offset:1024 sc1
s_waitcnt vmcnt(2)
s_branch EXW_43
EXP_42:
s_waitcnt vmcnt(0)
EXW_43:
s_mov_b64 exec, 1
buffer_store_dword v11, off, s[4:7], s42
s_mov_b64 exec, -1
ALTE_39:
v_mul_f32 v242, v248, -v247
v_pk_fma_f32 v[28:29], v[12:13], v[248:249], v[242:243] op_sel_hi:[1,0,0]
v_pk_fma_f32 v[30:31], v[14:15], v[248:249], v[242:243] op_sel_hi:[1,0,0]
v_pk_fma_f32 v[32:33], v[16:17], v[248:249], v[242:243] op_sel_hi:[1,0,0]
v_pk_fma_f32 v[34:35], v[18:19], v[248:249], v[242:243] op_sel_hi:[1,0,0]
v_pk_fma_f32 v[36:37], v[20:21], v[248:249], v[242:243] op_sel_hi:[1,0,0]
v_pk_fma_f32 v[38:39], v[22:23], v[248:249], v[242:243] op_sel_hi:[1,0,0]
v_pk_fma_f32 v[40:41], v[24:25], v[248:249], v[242:243] op_sel_hi:[1,0,0]
v_pk_fma_f32 v[42:43], v[26:27], v[248:249], v[242:243] op_sel_hi:[1,0,0]
s_barrier
PH4:
v_add_u32 v234, 131072, v2
v_add_u32 v235, 131072, v3
v_add_u32 v236, 131072, v4
v_add_u32 v237, 131072, v5
ds_read_b64_tr_b16 v[90:91], v234 offset:0
ds_read_b64_tr_b16 v[92:93], v234 offset:2048
ds_read_b64_tr_b16 v[94:95], v235 offset:0
ds_read_b64_tr_b16 v[96:97], v235 offset:2048
ds_read_b64_tr_b16 v[98:99], v236 offset:0
ds_read_b64_tr_b16 v[100:101], v236 offset:2048
ds_read_b64_tr_b16 v[102:103], v237 offset:0
ds_read_b64_tr_b16 v[104:105], v237 offset:2048
ds_read_b64_tr_b16 v[106:107], v234 offset:4096
ds_read_b64_tr_b16 v[108:109], v234 offset:6144
ds_read_b64_tr_b16 v[110:111], v235 offset:4096
ds_read_b64_tr_b16 v[112:113], v235 offset:6144
ds_read_b64_tr_b16 v[114:115], v236 offset:4096
ds_read_b64_tr_b16 v[116:117], v236 offset:6144
ds_read_b64_tr_b16 v[118:119], v237 offset:4096
ds_read_b64_tr_b16 v[120:121], v237 offset:6144
ds_read_b64_tr_b16 v[122:123], v234 offset:8192
ds_read_b64_tr_b16 v[124:125], v234 offset:10240
ds_read_b64_tr_b16 v[126:127], v235 offset:8192
ds_read_b64_tr_b16 v[128:129], v235 offset:10240
ds_read_b64_tr_b16 v[130:131], v236 offset:8192
ds_read_b64_tr_b16 v[132:133], v236 offset:10240
ds_read_b64_tr_b16 v[134:135], v237 offset:8192
ds_read_b64_tr_b16 v[136:137], v237 offset:10240
ds_read_b64_tr_b16 v[138:139], v234 offset:12288
ds_read_b64_tr_b16 v[140:141], v234 offset:14336
ds_read_b64_tr_b16 v[142:143], v235 offset:12288
ds_read_b64_tr_b16 v[144:145], v235 offset:14336
ds_read_b64_tr_b16 v[146:147], v236 offset:12288
ds_read_b64_tr_b16 v[148:149], v236 offset:14336
ds_read_b64_tr_b16 v[150:151], v237 offset:12288
ds_read_b64_tr_b16 v[152:153], v237 offset:14336
s_cmp_eq_u32 s38, 0
s_cbranch_scc1 EXF_44
v_mov_b32 v11, 3
s_waitcnt vmcnt(1)
s_mov_b64 exec, 1
buffer_store_dword v11, off, s[4:7], s43 sc1
s_mov_b64 exec, -1
EXF_44:
POLL_45:
buffer_load_dword v11, v9, s[4:7], 0 offen sc1
s_waitcnt vmcnt(0)
v_cmp_gt_u32 vcc, 3, v11
s_cbranch_vccz POLLD_46
s_sub_u32 s39, s39, 1
s_cbranch_scc0 POLL_45
s_branch BAIL
POLLD_46:
s_mov_b32 s61, 0x800000
buffer_load_dwordx4 v[58:61], v46, s[4:7], s61 offen offset:0 sc1
buffer_load_dwordx4 v[62:65], v46, s[4:7], s61 offen offset:1024 sc1
buffer_load_dwordx4 v[66:69], v46, s[4:7], s61 offen offset:2048 sc1
ds_read_b64_tr_b16 v[154:155], v234 offset:20480
ds_read_b64_tr_b16 v[156:157], v234 offset:22528
ds_read_b64_tr_b16 v[158:159], v235 offset:20480
ds_read_b64_tr_b16 v[160:161], v235 offset:22528
ds_read_b64_tr_b16 v[162:163], v236 offset:20480
ds_read_b64_tr_b16 v[164:165], v236 offset:22528
ds_read_b64_tr_b16 v[166:167], v237 offset:20480
ds_read_b64_tr_b16 v[168:169], v237 offset:22528
buffer_load_dwordx4 v[70:73], v46, s[4:7], s61 offen offset:3072 sc1
s_mov_b32 s61, 0x801000
buffer_load_dwordx4 v[74:77], v47, s[4:7], s61 offen offset:0 sc1
ds_read_b64_tr_b16 v[170:171], v234 offset:24576
ds_read_b64_tr_b16 v[172:173], v234 offset:26624
ds_read_b64_tr_b16 v[174:175], v235 offset:24576
ds_read_b64_tr_b16 v[176:177], v235 offset:26624
ds_read_b64_tr_b16 v[178:179], v236 offset:24576
ds_read_b64_tr_b16 v[180:181], v236 offset:26624
ds_read_b64_tr_b16 v[182:183], v237 offset:24576
ds_read_b64_tr_b16 v[184:185], v237 offset:26624
buffer_load_dwordx4 v[78:81], v47, s[4:7], s61 offen offset:1024 sc1
buffer_load_dwordx4 v[82:85], v47, s[4:7], s61 offen offset:2048 sc1
ds_read_b64_tr_b16 v[186:187], v234 offset:28672
ds_read_b64_tr_b16 v[188:189], v234 offset:30720
ds_read_b64_tr_b16 v[190:191], v235 offset:28672
ds_read_b64_tr_b16 v[192:193], v235 offset:30720
ds_read_b64_tr_b16 v[194:195], v236 offset:28672
ds_read_b64_tr_b16 v[196:197], v236 offset:30720
ds_read_b64_tr_b16 v[198:199], v237 offset:28672
ds_read_b64_tr_b16 v[200:201], v237 offset:30720
ds_read_b64_tr_b16 v[202:203], v2 offset:0
ds_read_b64_tr_b16 v[204:205], v2 offset:2048
ds_read_b64_tr_b16 v[206:207], v3 offset:0
ds_read_b64_tr_b16 v[208:209], v3 offset:2048
ds_read_b64_tr_b16 v[210:211], v4 offset:0
ds_read_b64_tr_b16 v[212:213], v4 offset:2048
ds_read_b64_tr_b16 v[214:215], v5 offset:0
ds_read_b64_tr_b16 v[216:217], v5 offset:2048
s_waitcnt vmcnt(6) lgkmcnt(15)
v_mfma_f32_16x16x32_bf16 v[28:31], v[90:93], v[58:61], v[28:31]
buffer_load_dwordx4 v[86:89], v47, s[4:7], s61 offen offset:3072 sc1
ds_read_b64_tr_b16 v[90:91], v2 offset:4096
ds_read_b64_tr_b16 v[92:93], v2 offset:6144
v_mfma_f32_16x16x32_bf16 v[32:35], v[94:97], v[58:61], v[32:35]
ds_read_b64_tr_b16 v[94:95], v3 offset:4096
ds_read_b64_tr_b16 v[96:97], v3 offset:6144
v_mfma_f32_16x16x32_bf16 v[36:39], v[98:101], v[58:61], v[36:39]
v_mfma_f32_16x16x32_bf16 v[40:43], v[102:105], v[58:61], v[40:43]
ds_read_b64_tr_b16 v[98:99], v4 offset:4096
ds_read_b64_tr_b16 v[100:101], v4 offset:6144
s_waitcnt vmcnt(6) lgkmcnt(15)
v_mfma_f32_16x16x32_bf16 v[28:31], v[106:109], v[62:65], v[28:31]
s_mov_b32 s61, 0x802000
buffer_load_dwordx4 v[58:61], v48, s[4:7], s61 offen offset:0 sc1
ds_read_b64_tr_b16 v[102:103], v5 offset:4096
ds_read_b64_tr_b16 v[104:105], v5 offset:6144
v_mfma_f32_16x16x32_bf16 v[32:35], v[110:113], v[62:65], v[32:35]
v_mfma_f32_16x16x32_bf16 v[36:39], v[114:117], v[62:65], v[36:39]
ds_read_b64_tr_b16 v[106:107], v2 offset:8192
ds_read_b64_tr_b16 v[108:109], v2 offset:10240
v_mfma_f32_16x16x32_bf16 v[40:43], v[118:121], v[62:65], v[40:43]
s_waitcnt vmcnt(6) lgkmcnt(15)
v_mfma_f32_16x16x32_bf16 v[28:31], v[122:125], v[66:69], v[28:31]
buffer_load_dwordx4 v[62:65], v48, s[4:7], s61 offen offset:1024 sc1
ds_read_b64_tr_b16 v[110:111], v3 offset:8192
ds_read_b64_tr_b16 v[112:113], v3 offset:10240
v_mfma_f32_16x16x32_bf16 v[32:35], v[126:129], v[66:69], v[32:35]
ds_read_b64_tr_b16 v[114:115], v4 offset:8192
ds_read_b64_tr_b16 v[116:117], v4 offset:10240
v_mfma_f32_16x16x32_bf16 v[36:39], v[130:133], v[66:69], v[36:39]
v_mfma_f32_16x16x32_bf16 v[40:43], v[134:137], v[66:69], v[40:43]
ds_read_b64_tr_b16 v[118:119], v5 offset:8192
ds_read_b64_tr_b16 v[120:121], v5 offset:10240
s_waitcnt vmcnt(6) lgkmcnt(15)
v_mfma_f32_16x16x32_bf16 v[28:31], v[138:141], v[70:73], v[28:31]
buffer_load_dwordx4 v[66:69], v48, s[4:7], s61 offen offset:2048 sc1
v_mfma_f32_16x16x32_bf16 v[32:35], v[142:145], v[70:73], v[32:35]
ds_read_b64_tr_b16 v[122:123], v2 offset:12288
ds_read_b64_tr_b16 v[124:125], v2 offset:14336
v_mfma_f32_16x16x32_bf16 v[36:39], v[146:149], v[70:73], v[36:39]
ds_read_b64_tr_b16 v[126:127], v3 offset:12288
ds_read_b64_tr_b16 v[128:129], v3 offset:14336
v_mfma_f32_16x16x32_bf16 v[40:43], v[150:153], v[70:73], v[40:43]
s_waitcnt vmcnt(6) lgkmcnt(15)
v_mfma_f32_16x16x32_bf16 v[28:31], v[154:157], v[74:77], v[28:31]
buffer_load_dwordx4 v[70:73], v48, s[4:7], s61 offen offset:3072 sc1
ds_read_b64_tr_b16 v[130:131], v4 offset:12288
ds_read_b64_tr_b16 v[132:133], v4 offset:14336
v_mfma_f32_16x16x32_bf16 v[32:35], v[158:161], v[74:77], v[32:35]
ds_read_b64_tr_b16 v[134:135], v5 offset:12288
ds_read_b64_tr_b16 v[136:137], v5 offset:14336
v_mfma_f32_16x16x32_bf16 v[36:39], v[162:165], v[74:77], v[36:39]
v_mfma_f32_16x16x32_bf16 v[40:43], v[166:169], v[74:77], v[40:43]
ds_read_b64_tr_b16 v[138:139], v2 offset:16384
ds_read_b64_tr_b16 v[140:141], v2 offset:18432
s_waitcnt vmcnt(6) lgkmcnt(15)
v_mfma_f32_16x16x32_bf16 v[28:31], v[170:173], v[78:81], v[28:31]
s_mov_b32 s61, 0x803000
buffer_load_dwordx4 v[74:77], v49, s[4:7], s61 offen offset:0 sc1
v_mfma_f32_16x16x32_bf16 v[32:35], v[174:177], v[78:81], v[32:35]
ds_read_b64_tr_b16 v[142:143], v3 offset:16384
ds_read_b64_tr_b16 v[144:145], v3 offset:18432
v_mfma_f32_16x16x32_bf16 v[36:39], v[178:181], v[78:81], v[36:39]
ds_read_b64_tr_b16 v[146:147], v4 offset:16384
ds_read_b64_tr_b16 v[148:149], v4 offset:18432
v_mfma_f32_16x16x32_bf16 v[40:43], v[182:185], v[78:81], v[40:43]
s_waitcnt vmcnt(6) lgkmcnt(15)
v_mfma_f32_16x16x32_bf16 v[28:31], v[186:189], v[82:85], v[28:31]
buffer_load_dwordx4 v[78:81], v49, s[4:7], s61 offen offset:1024 sc1
ds_read_b64_tr_b16 v[150:151], v5 offset:16384
ds_read_b64_tr_b16 v[152:153], v5 offset:18432
v_mfma_f32_16x16x32_bf16 v[32:35], v[190:193], v[82:85], v[32:35]
v_mfma_f32_16x16x32_bf16 v[36:39], v[194:197], v[82:85], v[36:39]
ds_read_b64_tr_b16 v[154:155], v2 offset:20480
ds_read_b64_tr_b16 v[156:157], v2 offset:22528
v_mfma_f32_16x16x32_bf16 v[40:43], v[198:201], v[82:85], v[40:43]
ds_read_b64_tr_b16 v[158:159], v3 offset:20480
ds_read_b64_tr_b16 v[160:161], v3 offset:22528
s_waitcnt vmcnt(6) lgkmcnt(15)
v_mfma_f32_16x16x32_bf16 v[28:31], v[202:205], v[86:89], v[28:31]
buffer_load_dwordx4 v[82:85], v49, s[4:7], s61 offen offset:2048 sc1
v_mfma_f32_16x16x32_bf16 v[32:35], v[206:209], v[86:89], v[32:35]
ds_read_b64_tr_b16 v[162:163], v4 offset:20480
ds_read_b64_tr_b16 v[164:165], v4 offset:22528
v_mfma_f32_16x16x32_bf16 v[36:39], v[210:213], v[86:89], v[36:39]
ds_read_b64_tr_b16 v[166:167], v5 offset:20480
ds_read_b64_tr_b16 v[168:169], v5 offset:22528
v_mfma_f32_16x16x32_bf16 v[40:43], v[214:217], v[86:89], v[40:43]
s_waitcnt vmcnt(6) lgkmcnt(15)
v_mfma_f32_16x16x32_bf16 v[28:31], v[90:93], v[58:61], v[28:31]
buffer_load_dwordx4 v[86:89], v49, s[4:7], s61 offen offset:3072 sc1
ds_read_b64_tr_b16 v[170:171], v2 offset:24576
ds_read_b64_tr_b16 v[172:173], v2 offset:26624
v_mfma_f32_16x16x32_bf16 v[32:35], v[94:97], v[58:61], v[32:35]
v_mfma_f32_16x16x32_bf16 v[36:39], v[98:101], v[58:61], v[36:39]
ds_read_b64_tr_b16 v[174:175], v3 offset:24576
ds_read_b64_tr_b16 v[176:177], v3 offset:26624
v_mfma_f32_16x16x32_bf16 v[40:43], v[102:105], v[58:61], v[40:43]
ds_read_b64_tr_b16 v[178:179], v4 offset:24576
ds_read_b64_tr_b16 v[180:181], v4 offset:26624
s_waitcnt vmcnt(6) lgkmcnt(15)
v_mfma_f32_16x16x32_bf16 v[28:31], v[106:109], v[62:65], v[28:31]
v_mfma_f32_16x16x32_bf16 v[32:35], v[110:113], v[62:65], v[32:35]
ds_read_b64_tr_b16 v[182:183], v5 offset:24576
ds_read_b64_tr_b16 v[184:185], v5 offset:26624
v_mfma_f32_16x16x32_bf16 v[36:39], v[114:117], v[62:65], v[36:39]
v_mfma_f32_16x16x32_bf16 v[40:43], v[118:121], v[62:65], v[40:43]
ds_read_b64_tr_b16 v[186:187], v2 offset:28672
ds_read_b64_tr_b16 v[188:189], v2 offset:30720
s_waitcnt vmcnt(5) lgkmcnt(15)
v_mfma_f32_16x16x32_bf16 v[28:31], v[122:125], v[66:69], v[28:31]
ds_read_b64_tr_b16 v[190:191], v3 offset:28672
ds_read_b64_tr_b16 v[192:193], v3 offset:30720
v_mfma_f32_16x16x32_bf16 v[32:35], v[126:129], v[66:69], v[32:35]
v_mfma_f32_16x16x32_bf16 v[36:39], v[130:133], v[66:69], v[36:39]
ds_read_b64_tr_b16 v[194:195], v4 offset:28672
ds_read_b64_tr_b16 v[196:197], v4 offset:30720
v_mfma_f32_16x16x32_bf16 v[40:43], v[134:137], v[66:69], v[40:43]
ds_read_b64_tr_b16 v[198:199], v5 offset:28672
ds_read_b64_tr_b16 v[200:201], v5 offset:30720
s_waitcnt vmcnt(4) lgkmcnt(15)
v_mfma_f32_16x16x32_bf16 v[28:31], v[138:141], v[70:73], v[28:31]
v_mfma_f32_16x16x32_bf16 v[32:35], v[142:145], v[70:73], v[32:35]
ds_read_b64_tr_b16 v[202:203], v2 offset:32768
ds_read_b64_tr_b16 v[204:205], v2 offset:34816
v_mfma_f32_16x16x32_bf16 v[36:39], v[146:149], v[70:73], v[36:39]
v_mfma_f32_16x16x32_bf16 v[40:43], v[150:153], v[70:73], v[40:43]
ds_read_b64_tr_b16 v[206:207], v3 offset:32768
ds_read_b64_tr_b16 v[208:209], v3 offset:34816
s_waitcnt vmcnt(3) lgkmcnt(15)
v_mfma_f32_16x16x32_bf16 v[28:31], v[154:157], v[74:77], v[28:31]
ds_read_b64_tr_b16 v[210:211], v4 offset:32768
ds_read_b64_tr_b16 v[212:213], v4 offset:34816
v_mfma_f32_16x16x32_bf16 v[32:35], v[158:161], v[74:77], v[32:35]
v_mfma_f32_16x16x32_bf16 v[36:39], v[162:165], v[74:77], v[36:39]
ds_read_b64_tr_b16 v[214:215], v5 offset:32768
ds_read_b64_tr_b16 v[216:217], v5 offset:34816
v_mfma_f32_16x16x32_bf16 v[40:43], v[166:169], v[74:77], v[40:43]
s_waitcnt vmcnt(2) lgkmcnt(15)
v_mfma_f32_16x16x32_bf16 v[28:31], v[170:173], v[78:81], v[28:31]
v_mfma_f32_16x16x32_bf16 v[32:35], v[174:177], v[78:81], v[32:35]
v_mfma_f32_16x16x32_bf16 v[36:39], v[178:181], v[78:81], v[36:39]
v_mfma_f32_16x16x32_bf16 v[40:43], v[182:185], v[78:81], v[40:43]
s_waitcnt vmcnt(1) lgkmcnt(8)
v_mfma_f32_16x16x32_bf16 v[28:31], v[186:189], v[82:85], v[28:31]
v_mfma_f32_16x16x32_bf16 v[32:35], v[190:193], v[82:85], v[32:35]
v_mfma_f32_16x16x32_bf16 v[36:39], v[194:197], v[82:85], v[36:39]
v_mfma_f32_16x16x32_bf16 v[40:43], v[198:201], v[82:85], v[40:43]
s_waitcnt vmcnt(0) lgkmcnt(0)
v_mfma_f32_16x16x32_bf16 v[28:31], v[202:205], v[86:89], v[28:31]
v_mfma_f32_16x16x32_bf16 v[32:35], v[206:209], v[86:89], v[32:35]
v_mfma_f32_16x16x32_bf16 v[36:39], v[210:213], v[86:89], v[36:39]
v_mfma_f32_16x16x32_bf16 v[40:43], v[214:217], v[86:89], v[40:43]
s_add_u32 s58, s50, s52
s_add_u32 s58, s58, 0xa00000
s_nop 2
v_cvt_pk_bf16_f32 v106, v28, v29
v_cvt_pk_bf16_f32 v107, v30, v31
v_cvt_pk_bf16_f32 v108, v32, v33
v_cvt_pk_bf16_f32 v109, v34, v35
v_cvt_pk_bf16_f32 v110, v36, v37
v_cvt_pk_bf16_f32 v111, v38, v39
v_cvt_pk_bf16_f32 v112, v40, v41
v_cvt_pk_bf16_f32 v113, v42, v43
s_cmp_lg_u32 s36, 0
s_cbranch_scc1 ALT_47
buffer_store_dwordx4 v[106:109], v1, s[4:7], s58 offen
buffer_store_dwordx4 v[110:113], v1, s[4:7], s58 offen offset:1024
ALTE_48:
v_pk_add_f32 v[242:243], v[28:29], v[30:31]
v_pk_mul_f32 v[244:245], v[28:29], v[28:29]
v_pk_fma_f32 v[244:245], v[30:31], v[30:31], v[244:245]
v_pk_add_f32 v[242:243], v[242:243], v[32:33]
v_pk_fma_f32 v[244:245], v[32:33], v[32:33], v[244:245]
v_pk_add_f32 v[242:243], v[242:243], v[34:35]
v_pk_fma_f32 v[244:245], v[34:35], v[34:35], v[244:245]
v_pk_add_f32 v[242:243], v[242:243], v[36:37]
v_pk_fma_f32 v[244:245], v[36:37], v[36:37], v[244:245]
v_pk_add_f32 v[242:243], v[242:243], v[38:39]
v_pk_fma_f32 v[244:245], v[38:39], v[38:39], v[244:245]
v_pk_add_f32 v[242:243], v[242:243], v[40:41]
v_pk_fma_f32 v[244:245], v[40:41], v[40:41], v[244:245]
v_pk_add_f32 v[242:243], v[242:243], v[42:43]
v_pk_fma_f32 v[244:245], v[42:43], v[42:43], v[244:245]
v_add_f32 v242, v242, v243
v_add_f32 v244, v244, v245
s_nop 1
v_permlane32_swap_b32 v242, v244
v_add_f32 v242, v242, v244
v_mov_b32 v243, v242
s_nop 1
v_permlane16_swap_b32 v242, v243
v_add_f32 v242, v242, v243
s_add_u32 s58, s51, 0x1320000
s_cmp_lg_u32 s36, 0
s_cbranch_scc1 ALT_49
buffer_store_dword v242, v44, s[4:7], s58 offen
v_mov_b32 v11, 4
s_waitcnt vmcnt(0)
s_mov_b64 exec, 1
buffer_store_dword v11, off, s[4:7], s42
s_mov_b64 exec, -1
ALTE_50:
v_pk_add_f32 v[12:13], v[12:13], v[28:29]
v_pk_add_f32 v[14:15], v[14:15], v[30:31]
v_pk_add_f32 v[16:17], v[16:17], v[32:33]
v_pk_add_f32 v[18:19], v[18:19], v[34:35]
v_pk_add_f32 v[20:21], v[20:21], v[36:37]
v_pk_add_f32 v[22:23], v[22:23], v[38:39]
v_pk_add_f32 v[24:25], v[24:25], v[40:41]
v_pk_add_f32 v[26:27], v[26:27], v[42:43]
PH5:
v_lshrrev_b32 v244, 5, v0
v_lshlrev_b32 v245, 4, v244
s_lshl_b32 s58, s34, 8
s_add_u32 s58, s58, 149504
v_add_u32 v245, s58, v245
ds_read_b128 v[154:157], v245 offset:0
ds_read_b128 v[158:161], v245 offset:32
ds_read_b128 v[162:165], v245 offset:64
ds_read_b128 v[166:169], v245 offset:96
ds_read_b128 v[170:173], v245 offset:128
ds_read_b128 v[174:177], v245 offset:160
ds_read_b128 v[178:181], v245 offset:192
ds_read_b128 v[182:185], v245 offset:224
v_and_b32 v245, 16, v0
v_lshlrev_b32 v245, 8, v245
v_lshl_add_u32 v245, v244, 8, v245
v_and_b32 v244, 15, v0
v_lshl_add_u32 v242, v244, 4, v245
v_add_u32 v242, 65536, v242
s_mul_i32 s58, s32, 224
s_add_u32 s61, s58, s71
s_lshl_b32 s61, s61, 10
s_add_u32 s61, s61, 0xc00000
s_lshl_b32 s58, s32, 16
s_lshl_b32 s59, s33, 11
s_add_u32 s58, s58, s59
s_add_u32 s58, s58, s73
s_add_u32 s58, s58, 0x800000
s_bitcmp1_b32 s33, 0
s_cselect_b32 s95, s61, s58
s_cselect_b32 s58, 114688, 0
s_cselect_b32 s59, 0, 32768
s_add_u32 s94, s95, s58
s_add_u32 s94, s94, s59
s_lshr_b32 s58, s59, 10
s_mul_i32 s58, s58, 80
v_and_b32 v243, 16, v0
v_mul_u32_u24 v243, s58, v243
v_sub_u32 v243, v53, v243
s_lshl_b32 s58, s32, 7
s_add_u32 s58, s58, 0x548000
s_cmp_eq_u32 s32, 0
s_cselect_b32 s59, 0, s44
s_lshl_b32 s59, s59, 5
s_sub_u32 s92, s58, s59
s_cmp_eq_u32 s32, 31
s_cselect_b32 s59, 0, s45
s_lshl_b32 s59, s59, 7
s_add_u32 s93, s58, s59
s_sub_u32 s93, s93, s92
v_bfe_u32 v248, v0, 3, 1
v_mul_u32_u24 v248, s93, v248
v_and_b32 v245, 7, v0
v_lshl_add_u32 v248, v245, 2, v248
v_add_u32 v248, s92, v248
s_lshl_b32 s58, s34, 6
s_add_u32 s58, s58, 147456
v_lshlrev_b32 v246, 2, v244
v_add_u32 v246, s58, v246
v_and_b32 v247, 31, v0
v_lshlrev_b32 v247, 2, v247
v_add_u32 v247, 147456, v247
s_waitcnt lgkmcnt(0)
POLL_51:
buffer_load_dword v11, v6, s[4:7], 0 offen sc1
s_waitcnt vmcnt(0)
v_cmp_gt_u32 vcc, 4, v11
s_cbranch_vccz POLLD_52
s_sub_u32 s39, s39, 1
s_cbranch_scc0 POLL_51
s_branch BAIL
POLLD_52:
s_cmp_eq_u32 s34, 3
s_cbranch_scc1 P5W3_53
s_add_u32 s59, s51, 0x1320000
buffer_load_dwordx4 v[226:229], v1, s[4:7], s59 offen sc1
s_add_u32 m0, s74, 65536
s_add_u32 s48, s50, 0xa00000
buffer_load_dwordx4 v1, s[4:7], s48 offen offset:0 sc1 lds
buffer_load_dwordx4 v1, s[4:7], s48 offen offset:1024 sc1 lds
buffer_load_dwordx4 v1, s[4:7], s48 offen offset:2048 sc1 lds
buffer_load_dwordx4 v1, s[4:7], s48 offen offset:3072 sc1 lds
s_add_u32 m0, s74, 81920
s_add_u32 s48, s50, 0xa01000
buffer_load_dwordx4 v1, s[4:7], s48 offen offset:0 sc1 lds
buffer_load_dwordx4 v1, s[4:7], s48 offen offset:1024 sc1 lds
s_waitcnt vmcnt(2)
s_barrier
ds_read_b128 v[122:125], v242 offset:0
ds_read_b128 v[126:129], v242 offset:8192
ds_read_b128 v[130:133], v242 offset:512
ds_read_b128 v[134:137], v242 offset:8704
ds_read_b128 v[138:141], v242 offset:1024
ds_read_b128 v[142:145], v242 offset:9216
s_waitcnt lgkmcnt(4)
v_mfma_f32_32x32x16_bf16 v[58:73], a[192:195], v[122:125], 0
ds_read_b128 v[146:149], v242 offset:1536
buffer_load_dwordx4 v1, s[4:7], s48 offen offset:2048 sc1 lds
v_mfma_f32_32x32x16_bf16 v[74:89], a[192:195], v[126:129], 0
v_add_f32 v226, v226, v228
v_add_f32 v227, v227, v229
s_nop 1
v_permlane32_swap_b32 v226, v227
ds_read_b128 v[150:153], v242 offset:9728
s_waitcnt lgkmcnt(4)
v_mfma_f32_32x32x16_bf16 v[58:73], a[196:199], v[130:133], v[58:73]
v_add_f32 v226, v226, v227
v_mov_b32 v227, v226
s_nop 1
v_permlane16_swap_b32 v226, v227
ds_read_b128 v[122:125], v242 offset:2048
buffer_load_dwordx4 v1, s[4:7], s48 offen offset:3072 sc1 lds
v_mfma_f32_32x32x16_bf16 v[74:89], a[196:199], v[134:137], v[74:89]
v_add_f32 v226, v226, v227
v_mov_b32 v227, v226
s_nop 1
v_permlane32_swap_b32 v226, v227
ds_read_b128 v[126:129], v242 offset:10240
s_add_u32 m0, s74, 98304
s_add_u32 s48, s50, 0xa02000
buffer_load_dwordx4 v1, s[4:7], s48 offen offset:0 sc1 lds
buffer_load_dwordx4 v1, s[4:7], s48 offen offset:1024 sc1 lds
buffer_load_dwordx4 v1, s[4:7], s48 offen offset:2048 sc1 lds
buffer_load_dwordx4 v1, s[4:7], s48 offen offset:3072 sc1 lds
s_add_u32 m0, s74, 114688
s_add_u32 s48, s50, 0xa03000
buffer_load_dwordx4 v1, s[4:7], s48 offen offset:0 sc1 lds
buffer_load_dwordx4 v1, s[4:7], s48 offen offset:1024 sc1 lds
buffer_load_dwordx4 v1, s[4:7], s48 offen offset:2048 sc1 lds
buffer_load_dwordx4 v1, s[4:7], s48 offen offset:3072 sc1 lds
s_add_u32 s60, s47, 16384
buffer_load_dwordx4 a[192:195], v50, s[4:7], s60 offen offset:0
s_waitcnt lgkmcnt(4)
v_mfma_f32_32x32x16_bf16 v[58:73], a[200:203], v[138:141], v[58:73]
v_mul_f32 v244, 0x3b000000, v226
v_mul_f32 v227, 0x3b000000, v227
v_fma_f32 v245, -v244, v244, v227
ds_read_b128 v[130:133], v242 offset:2560
v_mfma_f32_32x32x16_bf16 v[74:89], a[200:203], v[142:145], v[74:89]
v_max_f32 v245, 0, v245
v_add_f32 v245, 0x3727c5ac, v245
v_rsq_f32 v245, v245
ds_read_b128 v[134:137], v242 offset:10752
buffer_load_dwordx4 a[196:199], v50, s[4:7], s60 offen offset:1024
s_waitcnt lgkmcnt(4)
v_mfma_f32_32x32x16_bf16 v[58:73], a[204:207], v[146:149], v[58:73]
v_sub_f32 v244, 0, v244
ds_write2_b32 v246, v245, v244 offset0:0 offset1:128
ds_read_b128 v[138:141], v242 offset:3072
v_mfma_f32_32x32x16_bf16 v[74:89], a[204:207], v[150:153], v[74:89]
ds_read_b128 v[142:145], v242 offset:11264
buffer_load_dwordx4 a[200:203], v50, s[4:7], s60 offen offset:2048
s_waitcnt lgkmcnt(5)
v_mfma_f32_32x32x16_bf16 v[58:73], a[208:211], v[122:125], v[58:73]
ds_read_b128 v[146:149], v242 offset:3584
v_mfma_f32_32x32x16_bf16 v[74:89], a[208:211], v[126:129], v[74:89]
ds_read_b128 v[150:153], v242 offset:11776
buffer_load_dwordx4 a[204:207], v50, s[4:7], s60 offen offset:3072
s_waitcnt lgkmcnt(5)
v_mfma_f32_32x32x16_bf16 v[58:73], a[212:215], v[130:133], v[58:73]
s_waitcnt vmcnt(12)
s_waitcnt lgkmcnt(4)
s_barrier
ds_read2_b32 v[230:231], v247 offset0:0 offset1:128
ds_read2_b32 v[236:237], v247 offset0:32 offset1:160
ds_read_b128 v[122:125], v242 offset:16384
v_mfma_f32_32x32x16_bf16 v[74:89], a[212:215], v[134:137], v[74:89]
ds_read_b128 v[126:129], v242 offset:24576
s_add_u32 s60, s47, 20480
buffer_load_dwordx4 a[208:211], v50, s[4:7], s60 offen offset:0
s_waitcnt lgkmcnt(6)
v_mfma_f32_32x32x16_bf16 v[58:73], a[216:219], v[138:141], v[58:73]
ds_read_b128 v[130:133], v242 offset:16896
v_mfma_f32_32x32x16_bf16 v[74:89], a[216:219], v[142:145], v[74:89]
ds_read_b128 v[134:137], v242 offset:25088
buffer_load_dwordx4 a[212:215], v50, s[4:7], s60 offen offset:1024
s_waitcnt lgkmcnt(6)
v_mfma_f32_32x32x16_bf16 v[58:73], a[220:223], v[146:149], v[58:73]
ds_read_b128 v[138:141], v242 offset:17408
v_mfma_f32_32x32x16_bf16 v[74:89], a[220:223], v[150:153], v[74:89]
ds_read_b128 v[142:145], v242 offset:25600
buffer_load_dwordx4 a[216:219], v50, s[4:7], s60 offen offset:2048
s_waitcnt lgkmcnt(4)
v_mfma_f32_32x32x16_bf16 v[58:73], a[224:227], v[122:125], v[58:73]
ds_read_b128 v[146:149], v242 offset:17920
v_rcp_f32 v234, v230
v_mfma_f32_32x32x16_bf16 v[74:89], a[224:227], v[126:129], v[74:89]
ds_read_b128 v[150:153], v242 offset:26112
buffer_load_dwordx4 a[220:223], v50, s[4:7], s60 offen offset:3072
s_waitcnt lgkmcnt(4)
v_mfma_f32_32x32x16_bf16 v[58:73], a[228:231], v[130:133], v[58:73]
ds_read_b128 v[122:125], v242 offset:18432
v_mul_f32 v232, 0xc0135761, v230
v_mfma_f32_32x32x16_bf16 v[74:89], a[228:231], v[134:137], v[74:89]
ds_read_b128 v[126:129], v242 offset:26624
s_add_u32 s60, s47, 24576
buffer_load_dwordx4 a[224:227], v50, s[4:7], s60 offen offset:0
v_mul_f32 v230, v230, v230
s_waitcnt lgkmcnt(4)
v_mfma_f32_32x32x16_bf16 v[58:73], a[232:235], v[138:141], v[58:73]
ds_read_b128 v[130:133], v242 offset:18944
v_mul_f32 v233, 0x3d372713, v230
v_mfma_f32_32x32x16_bf16 v[74:89], a[232:235], v[142:145], v[74:89]
ds_read_b128 v[134:137], v242 offset:27136
buffer_load_dwordx4 a[228:231], v50, s[4:7], s60 offen offset:1024
v_mul_f32 v233, v233, v232
s_waitcnt lgkmcnt(4)
v_mfma_f32_32x32x16_bf16 v[58:73], a[236:239], v[146:149], v[58:73]
ds_read_b128 v[138:141], v242 offset:19456
v_rcp_f32 v240, v236
v_mfma_f32_32x32x16_bf16 v[74:89], a[236:239], v[150:153], v[74:89]
ds_read_b128 v[142:145], v242 offset:27648
buffer_load_dwordx4 a[232:235], v50, s[4:7], s60 offen offset:2048
s_waitcnt lgkmcnt(4)
v_mfma_f32_32x32x16_bf16 v[58:73], a[240:243], v[122:125], v[58:73]
ds_read_b128 v[146:149], v242 offset:19968
v_mul_f32 v238, 0xc0135761, v236
v_mfma_f32_32x32x16_bf16 v[74:89], a[240:243], v[126:129], v[74:89]
ds_read_b128 v[150:153], v242 offset:28160
buffer_load_dwordx4 a[236:239], v50, s[4:7], s60 offen offset:3072
v_mul_f32 v236, v236, v236
s_waitcnt lgkmcnt(4)
v_mfma_f32_32x32x16_bf16 v[58:73], a[244:247], v[130:133], v[58:73]
s_waitcnt vmcnt(16)
s_barrier
ds_read_b128 v[122:125], v242 offset:32768
v_mul_f32 v239, 0x3d372713, v236
v_mfma_f32_32x32x16_bf16 v[74:89], a[244:247], v[134:137], v[74:89]
ds_read_b128 v[126:129], v242 offset:40960
buffer_load_dword v255, v248, s[4:7], 0 offen sc1
v_mul_f32 v239, v239, v238
s_add_u32 s60, s47, 28672
buffer_load_dwordx4 a[240:243], v50, s[4:7], s60 offen offset:0
s_waitcnt lgkmcnt(4)
v_mfma_f32_32x32x16_bf16 v[58:73], a[248:251], v[138:141], v[58:73]
ds_read_b128 v[130:133], v242 offset:33280
v_mul_f32 v90, v170, v231
v_mfma_f32_32x32x16_bf16 v[74:89], a[248:251], v[142:145], v[74:89]
ds_read_b128 v[134:137], v242 offset:41472
buffer_load_dwordx4 a[244:247], v50, s[4:7], s60 offen offset:1024
v_mul_f32 v91, v171, v231
s_waitcnt lgkmcnt(4)
v_mfma_f32_32x32x16_bf16 v[58:73], a[252:255], v[146:149], v[58:73]
ds_read_b128 v[138:141], v242 offset:33792
v_mul_f32 v92, v172, v231
v_mfma_f32_32x32x16_bf16 v[74:89], a[252:255], v[150:153], v[74:89]
ds_read_b128 v[142:145], v242 offset:41984
buffer_load_dwordx4 a[248:251], v50, s[4:7], s60 offen offset:2048
v_mul_f32 v93, v173, v231
s_waitcnt vmcnt(15)
s_waitcnt lgkmcnt(4)
v_mfma_f32_32x32x16_bf16 v[58:73], a[192:195], v[122:125], v[58:73]
ds_read_b128 v[146:149], v242 offset:34304
v_mul_f32 v94, v174, v231
v_mfma_f32_32x32x16_bf16 v[74:89], a[192:195], v[126:129], v[74:89]
ds_read_b128 v[150:153], v242 offset:42496
buffer_load_dwordx4 a[252:255], v50, s[4:7], s60 offen offset:3072
v_mul_f32 v95, v175, v231
s_waitcnt vmcnt(15)
s_waitcnt lgkmcnt(4)
v_mfma_f32_32x32x16_bf16 v[58:73], a[196:199], v[130:133], v[58:73]
ds_read_b128 v[122:125], v242 offset:34816
v_mul_f32 v96, v176, v231
v_mfma_f32_32x32x16_bf16 v[74:89], a[196:199], v[134:137], v[74:89]
ds_read_b128 v[126:129], v242 offset:43008
s_add_u32 s60, s55, 32768
buffer_load_dwordx4 a[192:195], v50, s[4:7], s60 offen offset:0
v_mul_f32 v97, v177, v231
s_waitcnt vmcnt(15)
s_waitcnt lgkmcnt(4)
v_mfma_f32_32x32x16_bf16 v[58:73], a[200:203], v[138:141], v[58:73]
ds_read_b128 v[130:133], v242 offset:35328
v_mul_f32 v98, v178, v231
v_mfma_f32_32x32x16_bf16 v[74:89], a[200:203], v[142:145], v[74:89]
ds_read_b128 v[134:137], v242 offset:43520
buffer_load_dwordx4 a[196:199], v50, s[4:7], s60 offen offset:1024
v_mul_f32 v99, v179, v231
s_waitcnt vmcnt(15)
s_waitcnt lgkmcnt(4)
v_mfma_f32_32x32x16_bf16 v[58:73], a[204:207], v[146:149], v[58:73]
ds_read_b128 v[138:141], v242 offset:35840
v_mul_f32 v100, v180, v231
v_mfma_f32_32x32x16_bf16 v[74:89], a[204:207], v[150:153], v[74:89]
ds_read_b128 v[142:145], v242 offset:44032
buffer_load_dwordx4 a[200:203], v50, s[4:7], s60 offen offset:2048
v_mul_f32 v101, v181, v231
s_waitcnt vmcnt(15)
s_waitcnt lgkmcnt(4)
v_mfma_f32_32x32x16_bf16 v[58:73], a[208:211], v[122:125], v[58:73]
ds_read_b128 v[146:149], v242 offset:36352
v_mul_f32 v102, v182, v231
v_mfma_f32_32x32x16_bf16 v[74:89], a[208:211], v[126:129], v[74:89]
ds_read_b128 v[150:153], v242 offset:44544
buffer_load_dwordx4 a[204:207], v50, s[4:7], s60 offen offset:3072
v_mul_f32 v103, v183, v231
s_waitcnt vmcnt(15)
s_waitcnt lgkmcnt(4)
v_mfma_f32_32x32x16_bf16 v[58:73], a[212:215], v[130:133], v[58:73]
s_barrier
ds_read_b128 v[122:125], v242 offset:49152
v_mul_f32 v104, v184, v231
v_mfma_f32_32x32x16_bf16 v[74:89], a[212:215], v[134:137], v[74:89]
ds_read_b128 v[126:129], v242 offset:57344
s_add_u32 s60, s55, 36864
buffer_load_dwordx4 a[208:211], v50, s[4:7], s60 offen offset:0
v_mul_f32 v105, v185, v231
s_waitcnt vmcnt(15)
s_waitcnt lgkmcnt(4)
v_mfma_f32_32x32x16_bf16 v[58:73], a[216:219], v[138:141], v[58:73]
ds_read_b128 v[130:133], v242 offset:49664
v_mul_f32 v106, v170, v237
v_mfma_f32_32x32x16_bf16 v[74:89], a[216:219], v[142:145], v[74:89]
ds_read_b128 v[134:137], v242 offset:57856
buffer_load_dwordx4 a[212:215], v50, s[4:7], s60 offen offset:1024
v_mul_f32 v107, v171, v237
s_waitcnt vmcnt(15)
s_waitcnt lgkmcnt(4)
v_mfma_f32_32x32x16_bf16 v[58:73], a[220:223], v[146:149], v[58:73]
ds_read_b128 v[138:141], v242 offset:50176
v_mul_f32 v108, v172, v237
v_mfma_f32_32x32x16_bf16 v[74:89], a[220:223], v[150:153], v[74:89]
ds_read_b128 v[142:145], v242 offset:58368
buffer_load_dwordx4 a[216:219], v50, s[4:7], s60 offen offset:2048
v_mul_f32 v109, v173, v237
s_waitcnt vmcnt(15)
s_waitcnt lgkmcnt(4)
v_mfma_f32_32x32x16_bf16 v[58:73], a[224:227], v[122:125], v[58:73]
ds_read_b128 v[146:149], v242 offset:50688
v_mul_f32 v110, v174, v237
v_mfma_f32_32x32x16_bf16 v[74:89], a[224:227], v[126:129], v[74:89]
ds_read_b128 v[150:153], v242 offset:58880
buffer_load_dwordx4 a[220:223], v50, s[4:7], s60 offen offset:3072
v_mul_f32 v111, v175, v237
s_waitcnt vmcnt(15)
s_waitcnt lgkmcnt(4)
v_mfma_f32_32x32x16_bf16 v[58:73], a[228:231], v[130:133], v[58:73]
ds_read_b128 v[122:125], v242 offset:51200
v_mul_f32 v112, v176, v237
v_mfma_f32_32x32x16_bf16 v[74:89], a[228:231], v[134:137], v[74:89]
ds_read_b128 v[126:129], v242 offset:59392
s_add_u32 s60, s55, 40960
buffer_load_dwordx4 a[224:227], v50, s[4:7], s60 offen offset:0
v_mul_f32 v113, v177, v237
s_waitcnt vmcnt(15)
s_waitcnt lgkmcnt(4)
v_mfma_f32_32x32x16_bf16 v[58:73], a[232:235], v[138:141], v[58:73]
ds_read_b128 v[130:133], v242 offset:51712
v_mul_f32 v114, v178, v237
v_mfma_f32_32x32x16_bf16 v[74:89], a[232:235], v[142:145], v[74:89]
ds_read_b128 v[134:137], v242 offset:59904
buffer_load_dwordx4 a[228:231], v50, s[4:7], s60 offen offset:1024
v_mul_f32 v115, v179, v237
s_waitcnt vmcnt(15)
s_waitcnt lgkmcnt(4)
v_mfma_f32_32x32x16_bf16 v[58:73], a[236:239], v[146:149], v[58:73]
ds_read_b128 v[138:141], v242 offset:52224
v_mul_f32 v116, v180, v237
v_mfma_f32_32x32x16_bf16 v[74:89], a[236:239], v[150:153], v[74:89]
ds_read_b128 v[142:145], v242 offset:60416
buffer_load_dwordx4 a[232:235], v50, s[4:7], s60 offen offset:2048
v_mul_f32 v117, v181, v237
s_waitcnt vmcnt(14)
s_waitcnt lgkmcnt(4)
v_mfma_f32_32x32x16_bf16 v[58:73], a[240:243], v[122:125], v[58:73]
ds_read_b128 v[146:149], v242 offset:52736
v_mul_f32 v118, v182, v237
v_mfma_f32_32x32x16_bf16 v[74:89], a[240:243], v[126:129], v[74:89]
ds_read_b128 v[150:153], v242 offset:60928
buffer_load_dwordx4 a[236:239], v50, s[4:7], s60 offen offset:3072
v_mul_f32 v119, v183, v237
s_waitcnt vmcnt(14)
s_waitcnt lgkmcnt(4)
v_mfma_f32_32x32x16_bf16 v[58:73], a[244:247], v[130:133], v[58:73]
ds_read_b128 v[122:125], v242 offset:0
v_mul_f32 v120, v184, v237
v_mfma_f32_32x32x16_bf16 v[74:89], a[244:247], v[134:137], v[74:89]
ds_read_b128 v[126:129], v242 offset:8192
s_add_u32 s60, s55, 45056
buffer_load_dwordx4 a[240:243], v50, s[4:7], s60 offen offset:0
v_mul_f32 v121, v185, v237
s_waitcnt vmcnt(14)
s_waitcnt lgkmcnt(4)
v_mfma_f32_32x32x16_bf16 v[58:73], a[248:251], v[138:141], v[58:73]
ds_read_b128 v[130:133], v242 offset:512
v_mfma_f32_32x32x16_bf16 v[74:89], a[248:251], v[142:145], v[74:89]
ds_read_b128 v[134:137], v242 offset:1024
buffer_load_dwordx4 a[244:247], v50, s[4:7], s60 offen offset:1024
s_waitcnt vmcnt(14)
s_waitcnt lgkmcnt(4)
v_mfma_f32_32x32x16_bf16 v[58:73], a[252:255], v[146:149], v[58:73]
ds_read_b128 v[138:141], v242 offset:8704
v_mfma_f32_32x32x16_bf16 v[74:89], a[252:255], v[150:153], v[74:89]
ds_read_b128 v[142:145], v242 offset:1536
buffer_load_dwordx4 a[248:251], v50, s[4:7], s60 offen offset:2048
ACK_55:
v_cmp_gt_u32 vcc, 4, v255
s_cbranch_vccz ACKD_56
buffer_load_dword v255, v248, s[4:7], 0 offen sc1
s_waitcnt vmcnt(0)
s_sub_u32 s39, s39, 1
s_cbranch_scc0 ACK_55
s_branch BAIL
ACKD_56:
s_waitcnt vmcnt(14)
s_waitcnt lgkmcnt(4)
v_mfma_f32_32x32x16_bf16 v[90:105], a[192:195], v[122:125], v[90:105]
ds_read_b128 v[146:149], v242 offset:9216
v_mfma_f32_32x32x16_bf16 v[106:121], a[192:195], v[126:129], v[106:121]
ds_read_b128 v[150:153], v242 offset:2048
buffer_load_dwordx4 a[252:255], v50, s[4:7], s60 offen offset:3072
s_waitcnt vmcnt(14)
s_waitcnt lgkmcnt(4)
v_mfma_f32_32x32x16_bf16 v[90:105], a[196:199], v[130:133], v[90:105]
ds_read_b128 v[122:125], v242 offset:2560
s_add_u32 s60, s55, 49152
buffer_load_dwordx4 a[192:195], v50, s[4:7], s60 offen offset:0
s_waitcnt vmcnt(14)
v_mfma_f32_32x32x16_bf16 v[90:105], a[200:203], v[134:137], v[90:105]
ds_read_b128 v[126:129], v242 offset:9728
v_fma_f32 v202, v154, v231, v58
v_fma_f32 v203, v155, v231, v59
v_fma_f32 v204, v156, v231, v60
v_fma_f32 v205, v157, v231, v61
v_fma_f32 v206, v158, v231, v62
v_fma_f32 v207, v159, v231, v63
v_fma_f32 v208, v160, v231, v64
v_fma_f32 v209, v161, v231, v65
v_mul_f32 v186, v202, v202
v_mul_f32 v187, v203, v203
s_waitcnt lgkmcnt(4)
v_mfma_f32_32x32x16_bf16 v[106:121], a[196:199], v[138:141], v[106:121]
ds_read_b128 v[130:133], v242 offset:3072
buffer_load_dwordx4 a[196:199], v50, s[4:7], s60 offen offset:1024
v_mul_f32 v188, v204, v204
v_mul_f32 v189, v205, v205
v_mul_f32 v190, v206, v206
v_mul_f32 v191, v207, v207
v_mul_f32 v192, v208, v208
v_mul_f32 v193, v209, v209
v_fma_f32 v186, v186, v233, v232
v_fma_f32 v187, v187, v233, v232
v_fma_f32 v188, v188, v233, v232
s_waitcnt vmcnt(14)
v_mfma_f32_32x32x16_bf16 v[90:105], a[204:207], v[142:145], v[90:105]
ds_read_b128 v[134:137], v242 offset:10240
v_fma_f32 v189, v189, v233, v232
v_fma_f32 v190, v190, v233, v232
v_fma_f32 v191, v191, v233, v232
v_fma_f32 v192, v192, v233, v232
v_fma_f32 v193, v193, v233, v232
v_mul_f32 v186, v186, v202
v_mul_f32 v187, v187, v203
v_mul_f32 v188, v188, v204
v_mul_f32 v189, v189, v205
v_mul_f32 v190, v190, v206
s_waitcnt lgkmcnt(4)
v_mfma_f32_32x32x16_bf16 v[106:121], a[200:203], v[146:149], v[106:121]
ds_read_b128 v[138:141], v242 offset:3584
buffer_load_dwordx4 a[200:203], v50, s[4:7], s60 offen offset:2048
v_mul_f32 v191, v191, v207
v_mul_f32 v192, v192, v208
v_mul_f32 v193, v193, v209
v_exp_f32 v186, v186
v_exp_f32 v187, v187
v_exp_f32 v188, v188
s_waitcnt vmcnt(14)
v_mfma_f32_32x32x16_bf16 v[90:105], a[208:211], v[150:153], v[90:105]
ds_read_b128 v[142:145], v242 offset:16384
v_exp_f32 v189, v189
v_exp_f32 v190, v190
v_exp_f32 v191, v191
v_exp_f32 v192, v192
v_exp_f32 v193, v193
s_waitcnt vmcnt(13)
s_waitcnt lgkmcnt(4)
v_mfma_f32_32x32x16_bf16 v[90:105], a[212:215], v[122:125], v[90:105]
ds_read_b128 v[146:149], v242 offset:10752
v_fma_f32 v186, v186, v234, v234
v_fma_f32 v187, v187, v234, v234
v_fma_f32 v188, v188, v234, v234
v_fma_f32 v189, v189, v234, v234
v_fma_f32 v190, v190, v234, v234
v_fma_f32 v191, v191, v234, v234
v_fma_f32 v192, v192, v234, v234
v_fma_f32 v193, v193, v234, v234
v_rcp_f32 v186, v186
v_mfma_f32_32x32x16_bf16 v[106:121], a[204:207], v[126:129], v[106:121]
ds_read_b128 v[150:153], v242 offset:16896
buffer_load_dwordx4 a[204:207], v50, s[4:7], s60 offen offset:3072
v_rcp_f32 v187, v187
v_rcp_f32 v188, v188
v_rcp_f32 v189, v189
v_rcp_f32 v190, v190
v_rcp_f32 v191, v191
s_waitcnt vmcnt(13)
s_waitcnt lgkmcnt(4)
v_mfma_f32_32x32x16_bf16 v[90:105], a[216:219], v[130:133], v[90:105]
ds_read_b128 v[122:125], v242 offset:17408
v_rcp_f32 v192, v192
v_rcp_f32 v193, v193
v_mul_f32 v186, v202, v186
v_mul_f32 v187, v203, v187
v_mul_f32 v188, v204, v188
v_mul_f32 v189, v205, v189
v_mul_f32 v190, v206, v190
v_mfma_f32_32x32x16_bf16 v[106:121], a[208:211], v[134:137], v[106:121]
ds_read_b128 v[126:129], v242 offset:11264
s_add_u32 s60, s55, 53248
buffer_load_dwordx4 a[208:211], v50, s[4:7], s60 offen offset:0
v_mul_f32 v191, v207, v191
v_mul_f32 v192, v208, v192
v_mul_f32 v193, v209, v193
v_cvt_pk_bf16_f32 v218, v186, v187
v_cvt_pk_bf16_f32 v219, v188, v189
v_cvt_pk_bf16_f32 v220, v190, v191
v_cvt_pk_bf16_f32 v221, v192, v193
s_cmp_lg_u32 s36, 0
s_cbranch_scc1 ALT_57
buffer_store_dwordx4 v[218:221], v243, s[4:7], s95 offen offset:0
ALTE_58:
s_waitcnt vmcnt(14)
s_waitcnt lgkmcnt(4)
v_mfma_f32_32x32x16_bf16 v[90:105], a[220:223], v[138:141], v[90:105]
ds_read_b128 v[130:133], v242 offset:17920
v_fma_f32 v210, v162, v231, v66
v_fma_f32 v211, v163, v231, v67
v_fma_f32 v212, v164, v231, v68
v_fma_f32 v213, v165, v231, v69
v_fma_f32 v214, v166, v231, v70
v_fma_f32 v215, v167, v231, v71
v_fma_f32 v216, v168, v231, v72
v_fma_f32 v217, v169, v231, v73
v_mul_f32 v194, v210, v210
v_mul_f32 v195, v211, v211
s_waitcnt vmcnt(13)
v_mfma_f32_32x32x16_bf16 v[90:105], a[224:227], v[142:145], v[90:105]
ds_read_b128 v[134:137], v242 offset:11776
v_mul_f32 v196, v212, v212
v_mul_f32 v197, v213, v213
v_mul_f32 v198, v214, v214
v_mul_f32 v199, v215, v215
v_mul_f32 v200, v216, v216
v_mul_f32 v201, v217, v217
v_fma_f32 v194, v194, v233, v232
v_fma_f32 v195, v195, v233, v232
v_fma_f32 v196, v196, v233, v232
s_waitcnt lgkmcnt(4)
v_mfma_f32_32x32x16_bf16 v[106:121], a[212:215], v[146:149], v[106:121]
ds_read_b128 v[138:141], v242 offset:18432
buffer_load_dwordx4 a[212:215], v50, s[4:7], s60 offen offset:1024
v_fma_f32 v197, v197, v233, v232
v_fma_f32 v198, v198, v233, v232
v_fma_f32 v199, v199, v233, v232
v_fma_f32 v200, v200, v233, v232
v_fma_f32 v201, v201, v233, v232
v_mul_f32 v194, v194, v210
v_mul_f32 v195, v195, v211
v_mul_f32 v196, v196, v212
v_mul_f32 v197, v197, v213
v_mul_f32 v198, v198, v214
s_waitcnt vmcnt(13)
v_mfma_f32_32x32x16_bf16 v[90:105], a[228:231], v[150:153], v[90:105]
ds_read_b128 v[142:145], v242 offset:18944
v_mul_f32 v199, v199, v215
v_mul_f32 v200, v200, v216
v_mul_f32 v201, v201, v217
v_exp_f32 v194, v194
v_exp_f32 v195, v195
v_exp_f32 v196, v196
s_waitcnt vmcnt(12)
s_waitcnt lgkmcnt(4)
v_mfma_f32_32x32x16_bf16 v[90:105], a[232:235], v[122:125], v[90:105]
ds_read_b128 v[146:149], v242 offset:24576
v_exp_f32 v197, v197
v_exp_f32 v198, v198
v_exp_f32 v199, v199
v_exp_f32 v200, v200
v_exp_f32 v201, v201
v_mfma_f32_32x32x16_bf16 v[106:121], a[216:219], v[126:129], v[106:121]
ds_read_b128 v[150:153], v242 offset:19456
buffer_load_dwordx4 a[216:219], v50, s[4:7], s60 offen offset:2048
v_fma_f32 v194, v194, v234, v234
v_fma_f32 v195, v195, v234, v234
v_fma_f32 v196, v196, v234, v234
v_fma_f32 v197, v197, v234, v234
v_fma_f32 v198, v198, v234, v234
v_fma_f32 v199, v199, v234, v234
v_fma_f32 v200, v200, v234, v234
v_fma_f32 v201, v201, v234, v234
v_rcp_f32 v194, v194
s_waitcnt vmcnt(12)
s_waitcnt lgkmcnt(4)
v_mfma_f32_32x32x16_bf16 v[90:105], a[236:239], v[130:133], v[90:105]
ds_read_b128 v[122:125], v242 offset:25088
v_rcp_f32 v195, v195
v_rcp_f32 v196, v196
v_rcp_f32 v197, v197
v_rcp_f32 v198, v198
v_rcp_f32 v199, v199
v_mfma_f32_32x32x16_bf16 v[106:121], a[220:223], v[134:137], v[106:121]
ds_read_b128 v[126:129], v242 offset:19968
buffer_load_dwordx4 a[220:223], v50, s[4:7], s60 offen offset:3072
v_rcp_f32 v200, v200
v_rcp_f32 v201, v201
v_mul_f32 v194, v210, v194
v_mul_f32 v195, v211, v195
v_mul_f32 v196, v212, v196
v_mul_f32 v197, v213, v197
v_mul_f32 v198, v214, v198
s_waitcnt vmcnt(12)
s_waitcnt lgkmcnt(4)
v_mfma_f32_32x32x16_bf16 v[90:105], a[240:243], v[138:141], v[90:105]
ds_read_b128 v[130:133], v242 offset:32768
v_mul_f32 v199, v215, v199
v_mul_f32 v200, v216, v200
v_mul_f32 v201, v217, v201
v_cvt_pk_bf16_f32 v222, v194, v195
v_cvt_pk_bf16_f32 v223, v196, v197
v_cvt_pk_bf16_f32 v224, v198, v199
v_cvt_pk_bf16_f32 v225, v200, v201
s_cmp_lg_u32 s36, 0
s_cbranch_scc1 ALT_59
buffer_store_dwordx4 v[222:225], v243, s[4:7], s95 offen offset:512
ALTE_60:
s_waitcnt vmcnt(12)
v_mfma_f32_32x32x16_bf16 v[90:105], a[244:247], v[142:145], v[90:105]
ds_read_b128 v[134:137], v242 offset:25600
v_fma_f32 v202, v154, v237, v74
v_fma_f32 v203, v155, v237, v75
v_fma_f32 v204, v156, v237, v76
v_fma_f32 v205, v157, v237, v77
v_fma_f32 v206, v158, v237, v78
v_fma_f32 v207, v159, v237, v79
v_fma_f32 v208, v160, v237, v80
v_fma_f32 v209, v161, v237, v81
v_mul_f32 v186, v202, v202
v_mul_f32 v187, v203, v203
s_waitcnt lgkmcnt(4)
v_mfma_f32_32x32x16_bf16 v[106:121], a[224:227], v[146:149], v[106:121]
ds_read_b128 v[138:141], v242 offset:33280
s_add_u32 s60, s55, 57344
buffer_load_dwordx4 a[224:227], v50, s[4:7], s60 offen offset:0
v_mul_f32 v188, v204, v204
v_mul_f32 v189, v205, v205
v_mul_f32 v190, v206, v206
v_mul_f32 v191, v207, v207
v_mul_f32 v192, v208, v208
v_mul_f32 v193, v209, v209
v_fma_f32 v186, v186, v239, v238
v_fma_f32 v187, v187, v239, v238
v_fma_f32 v188, v188, v239, v238
s_waitcnt vmcnt(12)
v_mfma_f32_32x32x16_bf16 v[90:105], a[248:251], v[150:153], v[90:105]
ds_read_b128 v[142:145], v242 offset:33792
v_fma_f32 v189, v189, v239, v238
v_fma_f32 v190, v190, v239, v238
v_fma_f32 v191, v191, v239, v238
v_fma_f32 v192, v192, v239, v238
v_fma_f32 v193, v193, v239, v238
v_mul_f32 v186, v186, v202
v_mul_f32 v187, v187, v203
v_mul_f32 v188, v188, v204
v_mul_f32 v189, v189, v205
v_mul_f32 v190, v190, v206
s_waitcnt lgkmcnt(4)
v_mfma_f32_32x32x16_bf16 v[106:121], a[228:231], v[122:125], v[106:121]
ds_read_b128 v[146:149], v242 offset:26112
buffer_load_dwordx4 a[228:231], v50, s[4:7], s60 offen offset:1024
v_mul_f32 v191, v191, v207
v_mul_f32 v192, v192, v208
v_mul_f32 v193, v193, v209
v_exp_f32 v186, v186
v_exp_f32 v187, v187
v_exp_f32 v188, v188
s_waitcnt vmcnt(12)
v_mfma_f32_32x32x16_bf16 v[90:105], a[252:255], v[126:129], v[90:105]
ds_read_b128 v[150:153], v242 offset:34304
v_exp_f32 v189, v189
v_exp_f32 v190, v190
v_exp_f32 v191, v191
v_exp_f32 v192, v192
v_exp_f32 v193, v193
s_waitcnt vmcnt(11)
s_waitcnt lgkmcnt(4)
v_mfma_f32_32x32x16_bf16 v[90:105], a[192:195], v[130:133], v[90:105]
ds_read_b128 v[122:125], v242 offset:26624
v_fma_f32 v186, v186, v240, v240
v_fma_f32 v187, v187, v240, v240
v_fma_f32 v188, v188, v240, v240
v_fma_f32 v189, v189, v240, v240
v_fma_f32 v190, v190, v240, v240
v_fma_f32 v191, v191, v240, v240
v_fma_f32 v192, v192, v240, v240
v_fma_f32 v193, v193, v240, v240
v_rcp_f32 v186, v186
v_mfma_f32_32x32x16_bf16 v[106:121], a[232:235], v[134:137], v[106:121]
ds_read_b128 v[126:129], v242 offset:34816
buffer_load_dwordx4 a[232:235], v50, s[4:7], s60 offen offset:2048
v_rcp_f32 v187, v187
v_rcp_f32 v188, v188
v_rcp_f32 v189, v189
v_rcp_f32 v190, v190
v_rcp_f32 v191, v191
s_waitcnt vmcnt(11)
s_waitcnt lgkmcnt(4)
v_mfma_f32_32x32x16_bf16 v[90:105], a[196:199], v[138:141], v[90:105]
ds_read_b128 v[130:133], v242 offset:35328
v_rcp_f32 v192, v192
v_rcp_f32 v193, v193
v_mul_f32 v186, v202, v186
v_mul_f32 v187, v203, v187
v_mul_f32 v188, v204, v188
v_mul_f32 v189, v205, v189
v_mul_f32 v190, v206, v190
s_waitcnt vmcnt(10)
v_mfma_f32_32x32x16_bf16 v[90:105], a[200:203], v[142:145], v[90:105]
ds_read_b128 v[134:137], v242 offset:27136
v_mul_f32 v191, v207, v191
v_mul_f32 v192, v208, v192
v_mul_f32 v193, v209, v193
v_cvt_pk_bf16_f32 v218, v186, v187
v_cvt_pk_bf16_f32 v219, v188, v189
v_cvt_pk_bf16_f32 v220, v190, v191
v_cvt_pk_bf16_f32 v221, v192, v193
s_cmp_lg_u32 s36, 0
s_cbranch_scc1 ALT_61
buffer_store_dwordx4 v[218:221], v243, s[4:7], s94 offen offset:0
ALTE_62:
s_waitcnt lgkmcnt(4)
v_mfma_f32_32x32x16_bf16 v[106:121], a[236:239], v[146:149], v[106:121]
ds_read_b128 v[138:141], v242 offset:35840
v_fma_f32 v210, v162, v237, v82
v_fma_f32 v211, v163, v237, v83
v_fma_f32 v212, v164, v237, v84
v_fma_f32 v213, v165, v237, v85
v_fma_f32 v214, v166, v237, v86
v_fma_f32 v215, v167, v237, v87
v_fma_f32 v216, v168, v237, v88
v_fma_f32 v217, v169, v237, v89
v_mul_f32 v194, v210, v210
v_mul_f32 v195, v211, v211
buffer_load_dwordx4 a[236:239], v50, s[4:7], s60 offen offset:3072
s_waitcnt vmcnt(11)
v_mfma_f32_32x32x16_bf16 v[90:105], a[204:207], v[150:153], v[90:105]
ds_read_b128 v[142:145], v242 offset:27648
v_mul_f32 v196, v212, v212
v_mul_f32 v197, v213, v213
v_mul_f32 v198, v214, v214
v_mul_f32 v199, v215, v215
v_mul_f32 v200, v216, v216
v_mul_f32 v201, v217, v217
v_fma_f32 v194, v194, v239, v238
v_fma_f32 v195, v195, v239, v238
v_fma_f32 v196, v196, v239, v238
s_waitcnt lgkmcnt(4)
v_mfma_f32_32x32x16_bf16 v[106:121], a[240:243], v[122:125], v[106:121]
ds_read_b128 v[146:149], v242 offset:36352
s_add_u32 s60, s55, 61440
buffer_load_dwordx4 a[240:243], v50, s[4:7], s60 offen offset:0
v_fma_f32 v197, v197, v239, v238
v_fma_f32 v198, v198, v239, v238
v_fma_f32 v199, v199, v239, v238
v_fma_f32 v200, v200, v239, v238
v_fma_f32 v201, v201, v239, v238
v_mul_f32 v194, v194, v210
v_mul_f32 v195, v195, v211
v_mul_f32 v196, v196, v212
v_mul_f32 v197, v197, v213
v_mul_f32 v198, v198, v214
s_waitcnt vmcnt(11)
v_mfma_f32_32x32x16_bf16 v[90:105], a[208:211], v[126:129], v[90:105]
ds_read_b128 v[150:153], v242 offset:49152
v_mul_f32 v199, v199, v215
v_mul_f32 v200, v200, v216
v_mul_f32 v201, v201, v217
v_exp_f32 v194, v194
v_exp_f32 v195, v195
v_exp_f32 v196, v196
s_waitcnt vmcnt(9)
s_waitcnt lgkmcnt(4)
v_mfma_f32_32x32x16_bf16 v[90:105], a[212:215], v[130:133], v[90:105]
ds_read_b128 v[122:125], v242 offset:28160
v_exp_f32 v197, v197
v_exp_f32 v198, v198
v_exp_f32 v199, v199
v_exp_f32 v200, v200
v_exp_f32 v201, v201
v_mfma_f32_32x32x16_bf16 v[106:121], a[244:247], v[134:137], v[106:121]
ds_read_b128 v[126:129], v242 offset:49664
buffer_load_dwordx4 a[244:247], v50, s[4:7], s60 offen offset:1024
v_fma_f32 v194, v194, v240, v240
v_fma_f32 v195, v195, v240, v240
v_fma_f32 v196, v196, v240, v240
v_fma_f32 v197, v197, v240, v240
v_fma_f32 v198, v198, v240, v240
v_fma_f32 v199, v199, v240, v240
v_fma_f32 v200, v200, v240, v240
v_fma_f32 v201, v201, v240, v240
v_rcp_f32 v194, v194
s_waitcnt vmcnt(9)
s_waitcnt lgkmcnt(4)
v_mfma_f32_32x32x16_bf16 v[90:105], a[216:219], v[138:141], v[90:105]
ds_read_b128 v[130:133], v242 offset:50176
v_rcp_f32 v195, v195
v_rcp_f32 v196, v196
v_rcp_f32 v197, v197
v_rcp_f32 v198, v198
v_rcp_f32 v199, v199
v_mfma_f32_32x32x16_bf16 v[106:121], a[248:251], v[142:145], v[106:121]
ds_read_b128 v[134:137], v242 offset:40960
buffer_load_dwordx4 a[248:251], v50, s[4:7], s60 offen offset:2048
v_rcp_f32 v200, v200
v_rcp_f32 v201, v201
v_mul_f32 v194, v210, v194
v_mul_f32 v195, v211, v195
v_mul_f32 v196, v212, v196
v_mul_f32 v197, v213, v197
v_mul_f32 v198, v214, v198
s_waitcnt vmcnt(9)
s_waitcnt lgkmcnt(4)
v_mfma_f32_32x32x16_bf16 v[90:105], a[220:223], v[146:149], v[90:105]
ds_read_b128 v[138:141], v242 offset:50688
v_mul_f32 v199, v215, v199
v_mul_f32 v200, v216, v200
v_mul_f32 v201, v217, v201
v_cvt_pk_bf16_f32 v222, v194, v195
v_cvt_pk_bf16_f32 v223, v196, v197
v_cvt_pk_bf16_f32 v224, v198, v199
v_cvt_pk_bf16_f32 v225, v200, v201
s_cmp_lg_u32 s36, 0
s_cbranch_scc1 ALT_63
buffer_store_dwordx4 v[222:225], v243, s[4:7], s94 offen offset:512
ALTE_64:
s_waitcnt vmcnt(8)
v_mfma_f32_32x32x16_bf16 v[90:105], a[224:227], v[150:153], v[90:105]
ds_read_b128 v[142:145], v242 offset:41472
s_waitcnt lgkmcnt(4)
v_mfma_f32_32x32x16_bf16 v[106:121], a[252:255], v[122:125], v[106:121]
ds_read_b128 v[146:149], v242 offset:51200
buffer_load_dwordx4 a[252:255], v50, s[4:7], s60 offen offset:3072
s_waitcnt vmcnt(8)
v_mfma_f32_32x32x16_bf16 v[90:105], a[228:231], v[126:129], v[90:105]
ds_read_b128 v[150:153], v242 offset:51712
s_waitcnt vmcnt(7)
s_waitcnt lgkmcnt(4)
v_mfma_f32_32x32x16_bf16 v[90:105], a[232:235], v[130:133], v[90:105]
ds_read_b128 v[122:125], v242 offset:41984
s_mov_b32 s48, 0xc00000
buffer_load_dword v54, v57, s[4:7], s48 offen sc1
v_mfma_f32_32x32x16_bf16 v[106:121], a[192:195], v[134:137], v[106:121]
ds_read_b128 v[126:129], v242 offset:52224
s_waitcnt vmcnt(6)
s_waitcnt lgkmcnt(4)
v_mfma_f32_32x32x16_bf16 v[90:105], a[236:239], v[138:141], v[90:105]
ds_read_b128 v[130:133], v242 offset:42496
s_getpc_b64 s[76:77]
PC_65:
s_add_u32 s76, s76, PH7-PC_65
s_addc_u32 s77, s77, 0
v_min_u32 v11, PH11-PH7-4, v56
s_mov_b64 exec, 3
global_load_dword v54, v11, s[76:77]
s_mov_b64 exec, -1
v_mfma_f32_32x32x16_bf16 v[106:121], a[196:199], v[142:145], v[106:121]
ds_read_b128 v[134:137], v242 offset:52736
s_waitcnt vmcnt(6)
s_waitcnt lgkmcnt(4)
v_mfma_f32_32x32x16_bf16 v[90:105], a[240:243], v[146:149], v[90:105]
ds_read_b128 v[138:141], v242 offset:43008
s_add_u32 s60, s49, 0
buffer_load_dwordx4 a[192:195], v50, s[4:7], s60 offen offset:0
s_waitcnt vmcnt(6)
v_mfma_f32_32x32x16_bf16 v[90:105], a[244:247], v[150:153], v[90:105]
ds_read_b128 v[142:145], v242 offset:43520
s_waitcnt lgkmcnt(4)
v_mfma_f32_32x32x16_bf16 v[106:121], a[200:203], v[122:125], v[106:121]
ds_read_b128 v[146:149], v242 offset:44032
buffer_load_dwordx4 a[196:199], v50, s[4:7], s60 offen offset:1024
s_waitcnt vmcnt(6)
v_mfma_f32_32x32x16_bf16 v[90:105], a[248:251], v[126:129], v[90:105]
ds_read_b128 v[150:153], v242 offset:44544
s_waitcnt lgkmcnt(4)
v_mfma_f32_32x32x16_bf16 v[106:121], a[204:207], v[130:133], v[106:121]
ds_read_b128 v[122:125], v242 offset:57344
buffer_load_dwordx4 a[200:203], v50, s[4:7], s60 offen offset:2048
s_waitcnt vmcnt(5)
v_mfma_f32_32x32x16_bf16 v[90:105], a[252:255], v[134:137], v[90:105]
s_cmp_lg_u32 s36, 0
s_cbranch_scc1 ALT_66
v_mov_b32 v11, 5
s_mov_b64 exec, 1
buffer_store_dword v11, off, s[4:7], s42
s_mov_b64 exec, -1
ALTE_67:
ds_read_b128 v[126:129], v242 offset:57856
s_waitcnt lgkmcnt(4)
v_mfma_f32_32x32x16_bf16 v[106:121], a[208:211], v[138:141], v[106:121]
ds_read_b128 v[130:133], v242 offset:58368
v_mfma_f32_32x32x16_bf16 v[106:121], a[212:215], v[142:145], v[106:121]
ds_read_b128 v[134:137], v242 offset:58880
buffer_load_dwordx4 a[204:207], v50, s[4:7], s60 offen offset:3072
v_mul_f32 v186, v90, v90
v_mul_f32 v187, v91, v91
v_mul_f32 v188, v92, v92
v_mul_f32 v189, v93, v93
v_mul_f32 v190, v94, v94
v_mul_f32 v191, v95, v95
v_mul_f32 v192, v96, v96
v_mul_f32 v193, v97, v97
v_fma_f32 v186, v186, v233, v232
v_fma_f32 v187, v187, v233, v232
v_fma_f32 v188, v188, v233, v232
v_fma_f32 v189, v189, v233, v232
v_fma_f32 v190, v190, v233, v232
v_fma_f32 v191, v191, v233, v232
v_fma_f32 v192, v192, v233, v232
v_fma_f32 v193, v193, v233, v232
s_waitcnt lgkmcnt(4)
v_mfma_f32_32x32x16_bf16 v[106:121], a[216:219], v[146:149], v[106:121]
ds_read_b128 v[138:141], v242 offset:59392
s_add_u32 s60, s49, 4096
buffer_load_dwordx4 a[208:211], v50, s[4:7], s60 offen offset:0
v_mul_f32 v186, v186, v90
v_mul_f32 v187, v187, v91
v_mul_f32 v188, v188, v92
v_mul_f32 v189, v189, v93
v_mul_f32 v190, v190, v94
v_mul_f32 v191, v191, v95
v_mul_f32 v192, v192, v96
v_mul_f32 v193, v193, v97
v_exp_f32 v186, v186
v_exp_f32 v187, v187
v_exp_f32 v188, v188
v_exp_f32 v189, v189
v_mfma_f32_32x32x16_bf16 v[106:121], a[220:223], v[150:153], v[106:121]
ds_read_b128 v[142:145], v242 offset:59904
buffer_load_dwordx4 a[212:215], v50, s[4:7], s60 offen offset:1024
v_exp_f32 v190, v190
v_exp_f32 v191, v191
v_exp_f32 v192, v192
v_exp_f32 v193, v193
v_fma_f32 v186, v186, v234, v234
v_fma_f32 v187, v187, v234, v234
v_fma_f32 v188, v188, v234, v234
v_fma_f32 v189, v189, v234, v234
v_fma_f32 v190, v190, v234, v234
v_fma_f32 v191, v191, v234, v234
v_fma_f32 v192, v192, v234, v234
s_waitcnt lgkmcnt(4)
v_mfma_f32_32x32x16_bf16 v[106:121], a[224:227], v[122:125], v[106:121]
ds_read_b128 v[146:149], v242 offset:60416
buffer_load_dwordx4 a[216:219], v50, s[4:7], s60 offen offset:2048
v_fma_f32 v193, v193, v234, v234
v_rcp_f32 v186, v186
v_rcp_f32 v187, v187
v_rcp_f32 v188, v188
v_rcp_f32 v189, v189
v_rcp_f32 v190, v190
v_rcp_f32 v191, v191
v_rcp_f32 v192, v192
v_rcp_f32 v193, v193
v_mfma_f32_32x32x16_bf16 v[106:121], a[228:231], v[126:129], v[106:121]
ds_read_b128 v[150:153], v242 offset:60928
buffer_load_dwordx4 a[220:223], v50, s[4:7], s60 offen offset:3072
v_mul_f32 v186, v90, v186
v_mul_f32 v187, v91, v187
v_mul_f32 v188, v92, v188
v_mul_f32 v189, v93, v189
v_mul_f32 v190, v94, v190
v_mul_f32 v191, v95, v191
v_mul_f32 v192, v96, v192
v_mul_f32 v193, v97, v193
v_cvt_pk_bf16_f32 v218, v186, v187
v_cvt_pk_bf16_f32 v219, v188, v189
v_cvt_pk_bf16_f32 v220, v190, v191
v_cvt_pk_bf16_f32 v221, v192, v193
s_add_u32 s58, s61, 1024
s_cmp_lg_u32 s36, 0
s_cbranch_scc1 ALT_68
buffer_store_dwordx4 v[218:221], v53, s[4:7], s58 offen offset:0
ALTE_69:
s_waitcnt lgkmcnt(4)
v_mfma_f32_32x32x16_bf16 v[106:121], a[232:235], v[130:133], v[106:121]
v_mul_f32 v194, v98, v98
v_mul_f32 v195, v99, v99
v_mul_f32 v196, v100, v100
v_mul_f32 v197, v101, v101
v_mul_f32 v198, v102, v102
v_mul_f32 v199, v103, v103
v_mul_f32 v200, v104, v104
v_mul_f32 v201, v105, v105
v_fma_f32 v194, v194, v233, v232
v_fma_f32 v195, v195, v233, v232
v_fma_f32 v196, v196, v233, v232
v_fma_f32 v197, v197, v233, v232
v_fma_f32 v198, v198, v233, v232
v_fma_f32 v199, v199, v233, v232
v_fma_f32 v200, v200, v233, v232
v_fma_f32 v201, v201, v233, v232
v_mfma_f32_32x32x16_bf16 v[106:121], a[236:239], v[134:137], v[106:121]
s_add_u32 s60, s49, 8192
buffer_load_dwordx4 a[224:227], v50, s[4:7], s60 offen offset:0
v_mul_f32 v194, v194, v98
v_mul_f32 v195, v195, v99
v_mul_f32 v196, v196, v100
v_mul_f32 v197, v197, v101
v_mul_f32 v198, v198, v102
v_mul_f32 v199, v199, v103
v_mul_f32 v200, v200, v104
v_mul_f32 v201, v201, v105
v_exp_f32 v194, v194
v_exp_f32 v195, v195
v_exp_f32 v196, v196
v_exp_f32 v197, v197
s_waitcnt lgkmcnt(2)
v_mfma_f32_32x32x16_bf16 v[106:121], a[240:243], v[138:141], v[106:121]
buffer_load_dwordx4 a[228:231], v50, s[4:7], s60 offen offset:1024
v_exp_f32 v198, v198
v_exp_f32 v199, v199
v_exp_f32 v200, v200
v_exp_f32 v201, v201
v_fma_f32 v194, v194, v234, v234
v_fma_f32 v195, v195, v234, v234
v_fma_f32 v196, v196, v234, v234
v_fma_f32 v197, v197, v234, v234
v_fma_f32 v198, v198, v234, v234
v_fma_f32 v199, v199, v234, v234
v_fma_f32 v200, v200, v234, v234
v_mfma_f32_32x32x16_bf16 v[106:121], a[244:247], v[142:145], v[106:121]
buffer_load_dwordx4 a[232:235], v50, s[4:7], s60 offen offset:2048
v_fma_f32 v201, v201, v234, v234
v_rcp_f32 v194, v194
v_rcp_f32 v195, v195
v_rcp_f32 v196, v196
v_rcp_f32 v197, v197
v_rcp_f32 v198, v198
v_rcp_f32 v199, v199
v_rcp_f32 v200, v200
v_rcp_f32 v201, v201
s_waitcnt lgkmcnt(0)
v_mfma_f32_32x32x16_bf16 v[106:121], a[248:251], v[146:149], v[106:121]
buffer_load_dwordx4 a[236:239], v50, s[4:7], s60 offen offset:3072
v_mul_f32 v194, v98, v194
v_mul_f32 v195, v99, v195
v_mul_f32 v196, v100, v196
v_mul_f32 v197, v101, v197
v_mul_f32 v198, v102, v198
v_mul_f32 v199, v103, v199
v_mul_f32 v200, v104, v200
v_mul_f32 v201, v105, v201
v_cvt_pk_bf16_f32 v222, v194, v195
v_cvt_pk_bf16_f32 v223, v196, v197
v_cvt_pk_bf16_f32 v224, v198, v199
v_cvt_pk_bf16_f32 v225, v200, v201
s_cmp_lg_u32 s36, 0
s_cbranch_scc1 ALT_70
buffer_store_dwordx4 v[222:225], v53, s[4:7], s58 offen offset:512
ALTE_71:
v_mfma_f32_32x32x16_bf16 v[106:121], a[252:255], v[150:153], v[106:121]
s_nop 11
v_pk_mul_f32 v[186:187], v[106:107], v[106:107]
v_pk_mul_f32 v[188:189], v[108:109], v[108:109]
v_pk_mul_f32 v[190:191], v[110:111], v[110:111]
v_pk_mul_f32 v[192:193], v[112:113], v[112:113]
v_pk_fma_f32 v[186:187], v[186:187], v[238:239], v[238:239] op_sel:[0,1,0] op_sel_hi:[1,1,0]
v_pk_fma_f32 v[188:189], v[188:189], v[238:239], v[238:239] op_sel:[0,1,0] op_sel_hi:[1,1,0]
v_pk_fma_f32 v[190:191], v[190:191], v[238:239], v[238:239] op_sel:[0,1,0] op_sel_hi:[1,1,0]
v_pk_fma_f32 v[192:193], v[192:193], v[238:239], v[238:239] op_sel:[0,1,0] op_sel_hi:[1,1,0]
v_pk_mul_f32 v[186:187], v[186:187], v[106:107]
v_pk_mul_f32 v[188:189], v[188:189], v[108:109]
v_pk_mul_f32 v[190:191], v[190:191], v[110:111]
s_add_u32 s60, s49, 12288
buffer_load_dwordx4 a[240:243], v50, s[4:7], s60 offen offset:0
v_pk_mul_f32 v[192:193], v[192:193], v[112:113]
v_exp_f32 v186, v186
v_exp_f32 v187, v187
v_exp_f32 v188, v188
v_exp_f32 v189, v189
v_exp_f32 v190, v190
v_exp_f32 v191, v191
v_exp_f32 v192, v192
buffer_load_dwordx4 a[244:247], v50, s[4:7], s60 offen offset:1024
v_exp_f32 v193, v193
v_pk_fma_f32 v[186:187], v[186:187], v[240:241], v[240:241] op_sel_hi:[1,0,0]
v_pk_fma_f32 v[188:189], v[188:189], v[240:241], v[240:241] op_sel_hi:[1,0,0]
v_pk_fma_f32 v[190:191], v[190:191], v[240:241], v[240:241] op_sel_hi:[1,0,0]
v_pk_fma_f32 v[192:193], v[192:193], v[240:241], v[240:241] op_sel_hi:[1,0,0]
v_rcp_f32 v186, v186
v_rcp_f32 v187, v187
v_rcp_f32 v188, v188
v_rcp_f32 v189, v189
buffer_load_dwordx4 a[248:251], v50, s[4:7], s60 offen offset:2048
v_rcp_f32 v190, v190
v_rcp_f32 v191, v191
v_rcp_f32 v192, v192
v_rcp_f32 v193, v193
v_pk_mul_f32 v[186:187], v[106:107], v[186:187]
v_pk_mul_f32 v[188:189], v[108:109], v[188:189]
v_pk_mul_f32 v[190:191], v[110:111], v[190:191]
v_pk_mul_f32 v[192:193], v[112:113], v[192:193]
v_cvt_pk_bf16_f32 v218, v186, v187
buffer_load_dwordx4 a[252:255], v50, s[4:7], s60 offen offset:3072
v_cvt_pk_bf16_f32 v219, v188, v189
v_cvt_pk_bf16_f32 v220, v190, v191
v_cvt_pk_bf16_f32 v221, v192, v193
s_add_u32 s58, s61, 115712
s_cmp_lg_u32 s36, 0
s_cbranch_scc1 ALT_72
buffer_store_dwordx4 v[218:221], v53, s[4:7], s58 offen offset:0
ALTE_73:
v_pk_mul_f32 v[194:195], v[114:115], v[114:115]
v_pk_mul_f32 v[196:197], v[116:117], v[116:117]
v_pk_mul_f32 v[198:199], v[118:119], v[118:119]
v_pk_mul_f32 v[200:201], v[120:121], v[120:121]
v_pk_fma_f32 v[194:195], v[194:195], v[238:239], v[238:239] op_sel:[0,1,0] op_sel_hi:[1,1,0]
v_pk_fma_f32 v[196:197], v[196:197], v[238:239], v[238:239] op_sel:[0,1,0] op_sel_hi:[1,1,0]
v_pk_fma_f32 v[198:199], v[198:199], v[238:239], v[238:239] op_sel:[0,1,0] op_sel_hi:[1,1,0]
v_pk_fma_f32 v[200:201], v[200:201], v[238:239], v[238:239] op_sel:[0,1,0] op_sel_hi:[1,1,0]
v_pk_mul_f32 v[194:195], v[194:195], v[114:115]
v_pk_mul_f32 v[196:197], v[196:197], v[116:117]
v_pk_mul_f32 v[198:199], v[198:199], v[118:119]
v_pk_mul_f32 v[200:201], v[200:201], v[120:121]
v_exp_f32 v194, v194
v_exp_f32 v195, v195
v_exp_f32 v196, v196
v_exp_f32 v197, v197
v_exp_f32 v198, v198
v_exp_f32 v199, v199
v_exp_f32 v200, v200
v_exp_f32 v201, v201
v_pk_fma_f32 v[194:195], v[194:195], v[240:241], v[240:241] op_sel_hi:[1,0,0]
v_pk_fma_f32 v[196:197], v[196:197], v[240:241], v[240:241] op_sel_hi:[1,0,0]
v_pk_fma_f32 v[198:199], v[198:199], v[240:241], v[240:241] op_sel_hi:[1,0,0]
v_pk_fma_f32 v[200:201], v[200:201], v[240:241], v[240:241] op_sel_hi:[1,0,0]
v_rcp_f32 v194, v194
v_rcp_f32 v195, v195
v_rcp_f32 v196, v196
buffer_load_dword v255, v10, s[4:7], 0 offen sc1
v_rcp_f32 v197, v197
v_rcp_f32 v198, v198
v_rcp_f32 v199, v199
v_rcp_f32 v200, v200
v_rcp_f32 v201, v201
v_pk_mul_f32 v[194:195], v[114:115], v[194:195]
v_pk_mul_f32 v[196:197], v[116:117], v[196:197]
v_pk_mul_f32 v[198:199], v[118:119], v[198:199]
v_pk_mul_f32 v[200:201], v[120:121], v[200:201]
v_cvt_pk_bf16_f32 v222, v194, v195
v_cvt_pk_bf16_f32 v223, v196, v197
v_cvt_pk_bf16_f32 v224, v198, v199
v_cvt_pk_bf16_f32 v225, v200, v201
s_cmp_lg_u32 s36, 0
s_cbranch_scc1 ALT_74
buffer_store_dwordx4 v[222:225], v53, s[4:7], s58 offen offset:512
ALTE_75:
s_waitcnt vmcnt(1)
ACK_76:
v_cmp_gt_u32 vcc, 5, v255
s_cbranch_vccz ACKD_77
buffer_load_dword v255, v10, s[4:7], 0 offen sc1
s_waitcnt vmcnt(0)
s_sub_u32 s39, s39, 1
s_cbranch_scc0 ACK_76
s_branch BAIL
ACKD_77:
s_branch P5END_54
P5W3_53:
s_add_u32 s59, s51, 0x1320000
buffer_load_dwordx4 v[226:229], v1, s[4:7], s59 offen sc1
s_add_u32 m0, s74, 65536
s_add_u32 s48, s50, 0xa00000
buffer_load_dwordx4 v1, s[4:7], s48 offen offset:0 sc1 lds
buffer_load_dwordx4 v1, s[4:7], s48 offen offset:1024 sc1 lds
buffer_load_dwordx4 v1, s[4:7], s48 offen offset:2048 sc1 lds
buffer_load_dwordx4 v1, s[4:7], s48 offen offset:3072 sc1 lds
s_add_u32 m0, s74, 81920
s_add_u32 s48, s50, 0xa01000
buffer_load_dwordx4 v1, s[4:7], s48 offen offset:0 sc1 lds
buffer_load_dwordx4 v1, s[4:7], s48 offen offset:1024 sc1 lds
s_waitcnt vmcnt(2)
s_barrier
ds_read_b128 v[122:125], v242 offset:0
ds_read_b128 v[126:129], v242 offset:8192
ds_read_b128 v[130:133], v242 offset:512
ds_read_b128 v[134:137], v242 offset:8704
ds_read_b128 v[138:141], v242 offset:1024
ds_read_b128 v[142:145], v242 offset:9216
s_waitcnt lgkmcnt(4)
v_mfma_f32_32x32x16_bf16 v[58:73], a[192:195], v[122:125], 0
ds_read_b128 v[146:149], v242 offset:1536
buffer_load_dwordx4 v1, s[4:7], s48 offen offset:2048 sc1 lds
v_mfma_f32_32x32x16_bf16 v[74:89], a[192:195], v[126:129], 0
v_add_f32 v226, v226, v228
v_add_f32 v227, v227, v229
s_nop 1
v_permlane32_swap_b32 v226, v227
ds_read_b128 v[150:153], v242 offset:9728
s_waitcnt lgkmcnt(4)
v_mfma_f32_32x32x16_bf16 v[58:73], a[196:199], v[130:133], v[58:73]
v_add_f32 v226, v226, v227
v_mov_b32 v227, v226
s_nop 1
v_permlane16_swap_b32 v226, v227
ds_read_b128 v[122:125], v242 offset:2048
buffer_load_dwordx4 v1, s[4:7], s48 offen offset:3072 sc1 lds
v_mfma_f32_32x32x16_bf16 v[74:89], a[196:199], v[134:137], v[74:89]
v_add_f32 v226, v226, v227
v_mov_b32 v227, v226
s_nop 1
v_permlane32_swap_b32 v226, v227
ds_read_b128 v[126:129], v242 offset:10240
s_add_u32 m0, s74, 98304
s_add_u32 s48, s50, 0xa02000
buffer_load_dwordx4 v1, s[4:7], s48 offen offset:0 sc1 lds
buffer_load_dwordx4 v1, s[4:7], s48 offen offset:1024 sc1 lds
buffer_load_dwordx4 v1, s[4:7], s48 offen offset:2048 sc1 lds
buffer_load_dwordx4 v1, s[4:7], s48 offen offset:3072 sc1 lds
s_add_u32 m0, s74, 114688
s_add_u32 s48, s50, 0xa03000
buffer_load_dwordx4 v1, s[4:7], s48 offen offset:0 sc1 lds
buffer_load_dwordx4 v1, s[4:7], s48 offen offset:1024 sc1 lds
buffer_load_dwordx4 v1, s[4:7], s48 offen offset:2048 sc1 lds
buffer_load_dwordx4 v1, s[4:7], s48 offen offset:3072 sc1 lds
s_add_u32 s60, s47, 16384
buffer_load_dwordx4 a[192:195], v50, s[4:7], s60 offen offset:0
s_waitcnt lgkmcnt(4)
v_mfma_f32_32x32x16_bf16 v[58:73], a[200:203], v[138:141], v[58:73]
v_mul_f32 v244, 0x3b000000, v226
v_mul_f32 v227, 0x3b000000, v227
v_fma_f32 v245, -v244, v244, v227
ds_read_b128 v[130:133], v242 offset:2560
v_mfma_f32_32x32x16_bf16 v[74:89], a[200:203], v[142:145], v[74:89]
v_max_f32 v245, 0, v245
v_add_f32 v245, 0x3727c5ac, v245
v_rsq_f32 v245, v245
ds_read_b128 v[134:137], v242 offset:10752
buffer_load_dwordx4 a[196:199], v50, s[4:7], s60 offen offset:1024
s_waitcnt lgkmcnt(4)
v_mfma_f32_32x32x16_bf16 v[58:73], a[204:207], v[146:149], v[58:73]
v_sub_f32 v244, 0, v244
ds_write2_b32 v246, v245, v244 offset0:0 offset1:128
ds_read_b128 v[138:141], v242 offset:3072
v_mfma_f32_32x32x16_bf16 v[74:89], a[204:207], v[150:153], v[74:89]
ds_read_b128 v[142:145], v242 offset:11264
buffer_load_dwordx4 a[200:203], v50, s[4:7], s60 offen offset:2048
s_waitcnt lgkmcnt(5)
v_mfma_f32_32x32x16_bf16 v[58:73], a[208:211], v[122:125], v[58:73]
ds_read_b128 v[146:149], v242 offset:3584
v_mfma_f32_32x32x16_bf16 v[74:89], a[208:211], v[126:129], v[74:89]
ds_read_b128 v[150:153], v242 offset:11776
buffer_load_dwordx4 a[204:207], v50, s[4:7], s60 offen offset:3072
s_waitcnt lgkmcnt(5)
v_mfma_f32_32x32x16_bf16 v[58:73], a[212:215], v[130:133], v[58:73]
s_waitcnt vmcnt(12)
s_waitcnt lgkmcnt(4)
s_barrier
ds_read2_b32 v[230:231], v247 offset0:0 offset1:128
ds_read2_b32 v[236:237], v247 offset0:32 offset1:160
ds_read_b128 v[122:125], v242 offset:16384
v_mfma_f32_32x32x16_bf16 v[74:89], a[212:215], v[134:137], v[74:89]
ds_read_b128 v[126:129], v242 offset:24576
s_add_u32 s60, s47, 20480
buffer_load_dwordx4 a[208:211], v50, s[4:7], s60 offen offset:0
s_waitcnt lgkmcnt(6)
v_mfma_f32_32x32x16_bf16 v[58:73], a[216:219], v[138:141], v[58:73]
ds_read_b128 v[130:133], v242 offset:16896
v_mfma_f32_32x32x16_bf16 v[74:89], a[216:219], v[142:145], v[74:89]
ds_read_b128 v[134:137], v242 offset:25088
buffer_load_dwordx4 a[212:215], v50, s[4:7], s60 offen offset:1024
s_waitcnt lgkmcnt(6)
v_mfma_f32_32x32x16_bf16 v[58:73], a[220:223], v[146:149], v[58:73]
ds_read_b128 v[138:141], v242 offset:17408
v_mfma_f32_32x32x16_bf16 v[74:89], a[220:223], v[150:153], v[74:89]
ds_read_b128 v[142:145], v242 offset:25600
buffer_load_dwordx4 a[216:219], v50, s[4:7], s60 offen offset:2048
s_waitcnt lgkmcnt(4)
v_mfma_f32_32x32x16_bf16 v[58:73], a[224:227], v[122:125], v[58:73]
ds_read_b128 v[146:149], v242 offset:17920
v_rcp_f32 v234, v230
v_mfma_f32_32x32x16_bf16 v[74:89], a[224:227], v[126:129], v[74:89]
ds_read_b128 v[150:153], v242 offset:26112
buffer_load_dwordx4 a[220:223], v50, s[4:7], s60 offen offset:3072
s_waitcnt lgkmcnt(4)
v_mfma_f32_32x32x16_bf16 v[58:73], a[228:231], v[130:133], v[58:73]
ds_read_b128 v[122:125], v242 offset:18432
v_mul_f32 v232, 0xc0135761, v230
v_mfma_f32_32x32x16_bf16 v[74:89], a[228:231], v[134:137], v[74:89]
ds_read_b128 v[126:129], v242 offset:26624
s_add_u32 s60, s47, 24576
buffer_load_dwordx4 a[224:227], v50, s[4:7], s60 offen offset:0
v_mul_f32 v230, v230, v230
s_waitcnt lgkmcnt(4)
v_mfma_f32_32x32x16_bf16 v[58:73], a[232:235], v[138:141], v[58:73]
ds_read_b128 v[130:133], v242 offset:18944
v_mul_f32 v233, 0x3d372713, v230
v_mfma_f32_32x32x16_bf16 v[74:89], a[232:235], v[142:145], v[74:89]
ds_read_b128 v[134:137], v242 offset:27136
buffer_load_dwordx4 a[228:231], v50, s[4:7], s60 offen offset:1024
v_mul_f32 v233, v233, v232
s_waitcnt lgkmcnt(4)
v_mfma_f32_32x32x16_bf16 v[58:73], a[236:239], v[146:149], v[58:73]
ds_read_b128 v[138:141], v242 offset:19456
v_rcp_f32 v240, v236
v_mfma_f32_32x32x16_bf16 v[74:89], a[236:239], v[150:153], v[74:89]
ds_read_b128 v[142:145], v242 offset:27648
buffer_load_dwordx4 a[232:235], v50, s[4:7], s60 offen offset:2048
s_waitcnt lgkmcnt(4)
v_mfma_f32_32x32x16_bf16 v[58:73], a[240:243], v[122:125], v[58:73]
ds_read_b128 v[146:149], v242 offset:19968
v_mul_f32 v238, 0xc0135761, v236
v_mfma_f32_32x32x16_bf16 v[74:89], a[240:243], v[126:129], v[74:89]
ds_read_b128 v[150:153], v242 offset:28160
buffer_load_dwordx4 a[236:239], v50, s[4:7], s60 offen offset:3072
v_mul_f32 v236, v236, v236
s_waitcnt lgkmcnt(4)
v_mfma_f32_32x32x16_bf16 v[58:73], a[244:247], v[130:133], v[58:73]
s_waitcnt vmcnt(16)
s_barrier
ds_read_b128 v[122:125], v242 offset:32768
v_mul_f32 v239, 0x3d372713, v236
v_mfma_f32_32x32x16_bf16 v[74:89], a[244:247], v[134:137], v[74:89]
ds_read_b128 v[126:129], v242 offset:40960
buffer_load_dword v255, v248, s[4:7], 0 offen sc1
v_mul_f32 v239, v239, v238
s_add_u32 s60, s47, 28672
buffer_load_dwordx4 a[240:243], v50, s[4:7], s60 offen offset:0
s_waitcnt lgkmcnt(4)
v_mfma_f32_32x32x16_bf16 v[58:73], a[248:251], v[138:141], v[58:73]
ds_read_b128 v[130:133], v242 offset:33280
v_mfma_f32_32x32x16_bf16 v[74:89], a[248:251], v[142:145], v[74:89]
ds_read_b128 v[134:137], v242 offset:41472
buffer_load_dwordx4 a[244:247], v50, s[4:7], s60 offen offset:1024
s_waitcnt lgkmcnt(4)
v_mfma_f32_32x32x16_bf16 v[58:73], a[252:255], v[146:149], v[58:73]
ds_read_b128 v[138:141], v242 offset:33792
v_mfma_f32_32x32x16_bf16 v[74:89], a[252:255], v[150:153], v[74:89]
ds_read_b128 v[142:145], v242 offset:41984
buffer_load_dwordx4 a[248:251], v50, s[4:7], s60 offen offset:2048
s_waitcnt vmcnt(15)
s_waitcnt lgkmcnt(4)
v_mfma_f32_32x32x16_bf16 v[58:73], a[192:195], v[122:125], v[58:73]
ds_read_b128 v[146:149], v242 offset:34304
v_mfma_f32_32x32x16_bf16 v[74:89], a[192:195], v[126:129], v[74:89]
ds_read_b128 v[150:153], v242 offset:42496
buffer_load_dwordx4 a[252:255], v50, s[4:7], s60 offen offset:3072
s_waitcnt vmcnt(15)
s_waitcnt lgkmcnt(4)
v_mfma_f32_32x32x16_bf16 v[58:73], a[196:199], v[130:133], v[58:73]
ds_read_b128 v[122:125], v242 offset:34816
v_mfma_f32_32x32x16_bf16 v[74:89], a[196:199], v[134:137], v[74:89]
ds_read_b128 v[126:129], v242 offset:43008
s_mov_b32 s48, 0xc00000
buffer_load_dword v54, v57, s[4:7], s48 offen sc1
s_waitcnt vmcnt(15)
s_waitcnt lgkmcnt(4)
v_mfma_f32_32x32x16_bf16 v[58:73], a[200:203], v[138:141], v[58:73]
ds_read_b128 v[130:133], v242 offset:35328
v_mfma_f32_32x32x16_bf16 v[74:89], a[200:203], v[142:145], v[74:89]
ds_read_b128 v[134:137], v242 offset:43520
s_getpc_b64 s[76:77]
PC_78:
s_add_u32 s76, s76, PH7-PC_78
s_addc_u32 s77, s77, 0
v_min_u32 v11, PH11-PH7-4, v56
s_mov_b64 exec, 3
global_load_dword v54, v11, s[76:77]
s_mov_b64 exec, -1
s_waitcnt vmcnt(15)
s_waitcnt lgkmcnt(4)
v_mfma_f32_32x32x16_bf16 v[58:73], a[204:207], v[146:149], v[58:73]
ds_read_b128 v[138:141], v242 offset:35840
v_mfma_f32_32x32x16_bf16 v[74:89], a[204:207], v[150:153], v[74:89]
ds_read_b128 v[142:145], v242 offset:44032
s_add_u32 s60, s49, 0
buffer_load_dwordx4 a[192:195], v50, s[4:7], s60 offen offset:0
s_waitcnt vmcnt(15)
s_waitcnt lgkmcnt(4)
v_mfma_f32_32x32x16_bf16 v[58:73], a[208:211], v[122:125], v[58:73]
ds_read_b128 v[146:149], v242 offset:36352
v_mfma_f32_32x32x16_bf16 v[74:89], a[208:211], v[126:129], v[74:89]
ds_read_b128 v[150:153], v242 offset:44544
buffer_load_dwordx4 a[196:199], v50, s[4:7], s60 offen offset:1024
s_waitcnt vmcnt(15)
s_waitcnt lgkmcnt(4)
v_mfma_f32_32x32x16_bf16 v[58:73], a[212:215], v[130:133], v[58:73]
s_barrier
ds_read_b128 v[122:125], v242 offset:49152
v_mfma_f32_32x32x16_bf16 v[74:89], a[212:215], v[134:137], v[74:89]
ds_read_b128 v[126:129], v242 offset:57344
buffer_load_dwordx4 a[200:203], v50, s[4:7], s60 offen offset:2048
s_waitcnt vmcnt(15)
s_waitcnt lgkmcnt(4)
v_mfma_f32_32x32x16_bf16 v[58:73], a[216:219], v[138:141], v[58:73]
ds_read_b128 v[130:133], v242 offset:49664
v_mfma_f32_32x32x16_bf16 v[74:89], a[216:219], v[142:145], v[74:89]
ds_read_b128 v[134:137], v242 offset:57856
buffer_load_dwordx4 a[204:207], v50, s[4:7], s60 offen offset:3072
s_waitcnt vmcnt(15)
s_waitcnt lgkmcnt(4)
v_mfma_f32_32x32x16_bf16 v[58:73], a[220:223], v[146:149], v[58:73]
ds_read_b128 v[138:141], v242 offset:50176
v_mfma_f32_32x32x16_bf16 v[74:89], a[220:223], v[150:153], v[74:89]
ds_read_b128 v[142:145], v242 offset:58368
s_add_u32 s60, s49, 4096
buffer_load_dwordx4 a[208:211], v50, s[4:7], s60 offen offset:0
s_waitcnt vmcnt(15)
s_waitcnt lgkmcnt(4)
v_mfma_f32_32x32x16_bf16 v[58:73], a[224:227], v[122:125], v[58:73]
ds_read_b128 v[146:149], v242 offset:50688
v_mfma_f32_32x32x16_bf16 v[74:89], a[224:227], v[126:129], v[74:89]
ds_read_b128 v[150:153], v242 offset:58880
buffer_load_dwordx4 a[212:215], v50, s[4:7], s60 offen offset:1024
s_waitcnt vmcnt(15)
s_waitcnt lgkmcnt(4)
v_mfma_f32_32x32x16_bf16 v[58:73], a[228:231], v[130:133], v[58:73]
ds_read_b128 v[122:125], v242 offset:51200
v_mfma_f32_32x32x16_bf16 v[74:89], a[228:231], v[134:137], v[74:89]
ds_read_b128 v[126:129], v242 offset:59392
buffer_load_dwordx4 a[216:219], v50, s[4:7], s60 offen offset:2048
s_waitcnt vmcnt(15)
s_waitcnt lgkmcnt(4)
v_mfma_f32_32x32x16_bf16 v[58:73], a[232:235], v[138:141], v[58:73]
ds_read_b128 v[130:133], v242 offset:51712
v_mfma_f32_32x32x16_bf16 v[74:89], a[232:235], v[142:145], v[74:89]
ds_read_b128 v[134:137], v242 offset:59904
buffer_load_dwordx4 a[220:223], v50, s[4:7], s60 offen offset:3072
s_waitcnt vmcnt(15)
s_waitcnt lgkmcnt(4)
v_mfma_f32_32x32x16_bf16 v[58:73], a[236:239], v[146:149], v[58:73]
ds_read_b128 v[138:141], v242 offset:52224
v_mfma_f32_32x32x16_bf16 v[74:89], a[236:239], v[150:153], v[74:89]
ds_read_b128 v[142:145], v242 offset:60416
s_add_u32 s60, s49, 8192
buffer_load_dwordx4 a[224:227], v50, s[4:7], s60 offen offset:0
s_waitcnt vmcnt(14)
s_waitcnt lgkmcnt(4)
v_mfma_f32_32x32x16_bf16 v[58:73], a[240:243], v[122:125], v[58:73]
ds_read_b128 v[146:149], v242 offset:52736
v_mfma_f32_32x32x16_bf16 v[74:89], a[240:243], v[126:129], v[74:89]
ds_read_b128 v[150:153], v242 offset:60928
buffer_load_dwordx4 a[228:231], v50, s[4:7], s60 offen offset:1024
s_waitcnt vmcnt(14)
s_waitcnt lgkmcnt(4)
v_mfma_f32_32x32x16_bf16 v[58:73], a[244:247], v[130:133], v[58:73]
v_mfma_f32_32x32x16_bf16 v[74:89], a[244:247], v[134:137], v[74:89]
buffer_load_dwordx4 a[232:235], v50, s[4:7], s60 offen offset:2048
s_waitcnt vmcnt(14)
s_waitcnt lgkmcnt(2)
v_mfma_f32_32x32x16_bf16 v[58:73], a[248:251], v[138:141], v[58:73]
v_mfma_f32_32x32x16_bf16 v[74:89], a[248:251], v[142:145], v[74:89]
buffer_load_dwordx4 a[236:239], v50, s[4:7], s60 offen offset:3072
s_waitcnt vmcnt(14)
s_waitcnt lgkmcnt(0)
v_mfma_f32_32x32x16_bf16 v[58:73], a[252:255], v[146:149], v[58:73]
v_mfma_f32_32x32x16_bf16 v[74:89], a[252:255], v[150:153], v[74:89]
s_add_u32 s60, s49, 12288
buffer_load_dwordx4 a[240:243], v50, s[4:7], s60 offen offset:0
ACK_79:
v_cmp_gt_u32 vcc, 4, v255
s_cbranch_vccz ACKD_80
buffer_load_dword v255, v248, s[4:7], 0 offen sc1
s_waitcnt vmcnt(0)
s_sub_u32 s39, s39, 1
s_cbranch_scc0 ACK_79
s_branch BAIL
ACKD_80:
s_nop 6
v_pk_fma_f32 v[202:203], v[154:155], v[230:231], v[58:59] op_sel:[0,1,0]
v_pk_fma_f32 v[204:205], v[156:157], v[230:231], v[60:61] op_sel:[0,1,0]
v_pk_fma_f32 v[206:207], v[158:159], v[230:231], v[62:63] op_sel:[0,1,0]
v_pk_fma_f32 v[208:209], v[160:161], v[230:231], v[64:65] op_sel:[0,1,0]
v_pk_mul_f32 v[186:187], v[202:203], v[202:203]
v_pk_mul_f32 v[188:189], v[204:205], v[204:205]
v_pk_mul_f32 v[190:191], v[206:207], v[206:207]
v_pk_mul_f32 v[192:193], v[208:209], v[208:209]
v_pk_fma_f32 v[186:187], v[186:187], v[232:233], v[232:233] op_sel:[0,1,0] op_sel_hi:[1,1,0]
v_pk_fma_f32 v[188:189], v[188:189], v[232:233], v[232:233] op_sel:[0,1,0] op_sel_hi:[1,1,0]
v_pk_fma_f32 v[190:191], v[190:191], v[232:233], v[232:233] op_sel:[0,1,0] op_sel_hi:[1,1,0]
v_pk_fma_f32 v[192:193], v[192:193], v[232:233], v[232:233] op_sel:[0,1,0] op_sel_hi:[1,1,0]
v_pk_mul_f32 v[186:187], v[186:187], v[202:203]
v_pk_mul_f32 v[188:189], v[188:189], v[204:205]
v_pk_mul_f32 v[190:191], v[190:191], v[206:207]
v_pk_mul_f32 v[192:193], v[192:193], v[208:209]
v_exp_f32 v186, v186
v_exp_f32 v187, v187
v_exp_f32 v188, v188
v_exp_f32 v189, v189
v_exp_f32 v190, v190
v_exp_f32 v191, v191
v_exp_f32 v192, v192
v_exp_f32 v193, v193
v_pk_fma_f32 v[186:187], v[186:187], v[234:235], v[234:235] op_sel_hi:[1,0,0]
v_pk_fma_f32 v[188:189], v[188:189], v[234:235], v[234:235] op_sel_hi:[1,0,0]
v_pk_fma_f32 v[190:191], v[190:191], v[234:235], v[234:235] op_sel_hi:[1,0,0]
v_pk_fma_f32 v[192:193], v[192:193], v[234:235], v[234:235] op_sel_hi:[1,0,0]
v_rcp_f32 v186, v186
v_rcp_f32 v187, v187
v_rcp_f32 v188, v188
v_rcp_f32 v189, v189
v_rcp_f32 v190, v190
v_rcp_f32 v191, v191
v_rcp_f32 v192, v192
v_rcp_f32 v193, v193
v_pk_mul_f32 v[186:187], v[202:203], v[186:187]
v_pk_mul_f32 v[188:189], v[204:205], v[188:189]
v_pk_mul_f32 v[190:191], v[206:207], v[190:191]
v_pk_mul_f32 v[192:193], v[208:209], v[192:193]
v_cvt_pk_bf16_f32 v218, v186, v187
v_cvt_pk_bf16_f32 v219, v188, v189
v_cvt_pk_bf16_f32 v220, v190, v191
v_cvt_pk_bf16_f32 v221, v192, v193
s_cmp_lg_u32 s36, 0
s_cbranch_scc1 ALT_81
buffer_store_dwordx4 v[218:221], v243, s[4:7], s95 offen offset:0
ALTE_82:
v_pk_fma_f32 v[210:211], v[162:163], v[230:231], v[66:67] op_sel:[0,1,0]
v_pk_fma_f32 v[212:213], v[164:165], v[230:231], v[68:69] op_sel:[0,1,0]
v_pk_fma_f32 v[214:215], v[166:167], v[230:231], v[70:71] op_sel:[0,1,0]
v_pk_fma_f32 v[216:217], v[168:169], v[230:231], v[72:73] op_sel:[0,1,0]
v_pk_mul_f32 v[194:195], v[210:211], v[210:211]
v_pk_mul_f32 v[196:197], v[212:213], v[212:213]
v_pk_mul_f32 v[198:199], v[214:215], v[214:215]
v_pk_mul_f32 v[200:201], v[216:217], v[216:217]
v_pk_fma_f32 v[194:195], v[194:195], v[232:233], v[232:233] op_sel:[0,1,0] op_sel_hi:[1,1,0]
v_pk_fma_f32 v[196:197], v[196:197], v[232:233], v[232:233] op_sel:[0,1,0] op_sel_hi:[1,1,0]
v_pk_fma_f32 v[198:199], v[198:199], v[232:233], v[232:233] op_sel:[0,1,0] op_sel_hi:[1,1,0]
v_pk_fma_f32 v[200:201], v[200:201], v[232:233], v[232:233] op_sel:[0,1,0] op_sel_hi:[1,1,0]
v_pk_mul_f32 v[194:195], v[194:195], v[210:211]
v_pk_mul_f32 v[196:197], v[196:197], v[212:213]
v_pk_mul_f32 v[198:199], v[198:199], v[214:215]
v_pk_mul_f32 v[200:201], v[200:201], v[216:217]
v_exp_f32 v194, v194
v_exp_f32 v195, v195
v_exp_f32 v196, v196
v_exp_f32 v197, v197
v_exp_f32 v198, v198
v_exp_f32 v199, v199
v_exp_f32 v200, v200
v_exp_f32 v201, v201
v_pk_fma_f32 v[194:195], v[194:195], v[234:235], v[234:235] op_sel_hi:[1,0,0]
v_pk_fma_f32 v[196:197], v[196:197], v[234:235], v[234:235] op_sel_hi:[1,0,0]
v_pk_fma_f32 v[198:199], v[198:199], v[234:235], v[234:235] op_sel_hi:[1,0,0]
v_pk_fma_f32 v[200:201], v[200:201], v[234:235], v[234:235] op_sel_hi:[1,0,0]
v_rcp_f32 v194, v194
v_rcp_f32 v195, v195
v_rcp_f32 v196, v196
v_rcp_f32 v197, v197
v_rcp_f32 v198, v198
v_rcp_f32 v199, v199
v_rcp_f32 v200, v200
v_rcp_f32 v201, v201
v_pk_mul_f32 v[194:195], v[210:211], v[194:195]
v_pk_mul_f32 v[196:197], v[212:213], v[196:197]
v_pk_mul_f32 v[198:199], v[214:215], v[198:199]
v_pk_mul_f32 v[200:201], v[216:217], v[200:201]
v_cvt_pk_bf16_f32 v222, v194, v195
v_cvt_pk_bf16_f32 v223, v196, v197
v_cvt_pk_bf16_f32 v224, v198, v199
v_cvt_pk_bf16_f32 v225, v200, v201
s_cmp_lg_u32 s36, 0
s_cbranch_scc1 ALT_83
buffer_store_dwordx4 v[222:225], v243, s[4:7], s95 offen offset:512
ALTE_84:
v_pk_fma_f32 v[202:203], v[154:155], v[236:237], v[74:75] op_sel:[0,1,0]
v_pk_fma_f32 v[204:205], v[156:157], v[236:237], v[76:77] op_sel:[0,1,0]
v_pk_fma_f32 v[206:207], v[158:159], v[236:237], v[78:79] op_sel:[0,1,0]
v_pk_fma_f32 v[208:209], v[160:161], v[236:237], v[80:81] op_sel:[0,1,0]
v_pk_mul_f32 v[186:187], v[202:203], v[202:203]
v_pk_mul_f32 v[188:189], v[204:205], v[204:205]
v_pk_mul_f32 v[190:191], v[206:207], v[206:207]
v_pk_mul_f32 v[192:193], v[208:209], v[208:209]
v_pk_fma_f32 v[186:187], v[186:187], v[238:239], v[238:239] op_sel:[0,1,0] op_sel_hi:[1,1,0]
v_pk_fma_f32 v[188:189], v[188:189], v[238:239], v[238:239] op_sel:[0,1,0] op_sel_hi:[1,1,0]
v_pk_fma_f32 v[190:191], v[190:191], v[238:239], v[238:239] op_sel:[0,1,0] op_sel_hi:[1,1,0]
v_pk_fma_f32 v[192:193], v[192:193], v[238:239], v[238:239] op_sel:[0,1,0] op_sel_hi:[1,1,0]
v_pk_mul_f32 v[186:187], v[186:187], v[202:203]
v_pk_mul_f32 v[188:189], v[188:189], v[204:205]
v_pk_mul_f32 v[190:191], v[190:191], v[206:207]
v_pk_mul_f32 v[192:193], v[192:193], v[208:209]
v_exp_f32 v186, v186
v_exp_f32 v187, v187
v_exp_f32 v188, v188
v_exp_f32 v189, v189
v_exp_f32 v190, v190
v_exp_f32 v191, v191
v_exp_f32 v192, v192
v_exp_f32 v193, v193
v_pk_fma_f32 v[186:187], v[186:187], v[240:241], v[240:241] op_sel_hi:[1,0,0]
v_pk_fma_f32 v[188:189], v[188:189], v[240:241], v[240:241] op_sel_hi:[1,0,0]
v_pk_fma_f32 v[190:191], v[190:191], v[240:241], v[240:241] op_sel_hi:[1,0,0]
v_pk_fma_f32 v[192:193], v[192:193], v[240:241], v[240:241] op_sel_hi:[1,0,0]
v_rcp_f32 v186, v186
v_rcp_f32 v187, v187
v_rcp_f32 v188, v188
v_rcp_f32 v189, v189
v_rcp_f32 v190, v190
v_rcp_f32 v191, v191
v_rcp_f32 v192, v192
v_rcp_f32 v193, v193
v_pk_mul_f32 v[186:187], v[202:203], v[186:187]
v_pk_mul_f32 v[188:189], v[204:205], v[188:189]
v_pk_mul_f32 v[190:191], v[206:207], v[190:191]
v_pk_mul_f32 v[192:193], v[208:209], v[192:193]
v_cvt_pk_bf16_f32 v218, v186, v187
v_cvt_pk_bf16_f32 v219, v188, v189
v_cvt_pk_bf16_f32 v220, v190, v191
v_cvt_pk_bf16_f32 v221, v192, v193
s_cmp_lg_u32 s36, 0
s_cbranch_scc1 ALT_85
buffer_store_dwordx4 v[218:221], v243, s[4:7], s94 offen offset:0
ALTE_86:
v_pk_fma_f32 v[210:211], v[162:163], v[236:237], v[82:83] op_sel:[0,1,0]
v_pk_fma_f32 v[212:213], v[164:165], v[236:237], v[84:85] op_sel:[0,1,0]
v_pk_fma_f32 v[214:215], v[166:167], v[236:237], v[86:87] op_sel:[0,1,0]
v_pk_fma_f32 v[216:217], v[168:169], v[236:237], v[88:89] op_sel:[0,1,0]
v_pk_mul_f32 v[194:195], v[210:211], v[210:211]
v_pk_mul_f32 v[196:197], v[212:213], v[212:213]
v_pk_mul_f32 v[198:199], v[214:215], v[214:215]
v_pk_mul_f32 v[200:201], v[216:217], v[216:217]
v_pk_fma_f32 v[194:195], v[194:195], v[238:239], v[238:239] op_sel:[0,1,0] op_sel_hi:[1,1,0]
v_pk_fma_f32 v[196:197], v[196:197], v[238:239], v[238:239] op_sel:[0,1,0] op_sel_hi:[1,1,0]
v_pk_fma_f32 v[198:199], v[198:199], v[238:239], v[238:239] op_sel:[0,1,0] op_sel_hi:[1,1,0]
v_pk_fma_f32 v[200:201], v[200:201], v[238:239], v[238:239] op_sel:[0,1,0] op_sel_hi:[1,1,0]
v_pk_mul_f32 v[194:195], v[194:195], v[210:211]
v_pk_mul_f32 v[196:197], v[196:197], v[212:213]
v_pk_mul_f32 v[198:199], v[198:199], v[214:215]
v_pk_mul_f32 v[200:201], v[200:201], v[216:217]
v_exp_f32 v194, v194
v_exp_f32 v195, v195
v_exp_f32 v196, v196
v_exp_f32 v197, v197
v_exp_f32 v198, v198
v_exp_f32 v199, v199
v_exp_f32 v200, v200
v_exp_f32 v201, v201
v_pk_fma_f32 v[194:195], v[194:195], v[240:241], v[240:241] op_sel_hi:[1,0,0]
v_pk_fma_f32 v[196:197], v[196:197], v[240:241], v[240:241] op_sel_hi:[1,0,0]
v_pk_fma_f32 v[198:199], v[198:199], v[240:241], v[240:241] op_sel_hi:[1,0,0]
v_pk_fma_f32 v[200:201], v[200:201], v[240:241], v[240:241] op_sel_hi:[1,0,0]
v_rcp_f32 v194, v194
v_rcp_f32 v195, v195
v_rcp_f32 v196, v196
v_rcp_f32 v197, v197
v_rcp_f32 v198, v198
v_rcp_f32 v199, v199
v_rcp_f32 v200, v200
v_rcp_f32 v201, v201
v_pk_mul_f32 v[194:195], v[210:211], v[194:195]
v_pk_mul_f32 v[196:197], v[212:213], v[196:197]
v_pk_mul_f32 v[198:199], v[214:215], v[198:199]
v_pk_mul_f32 v[200:201], v[216:217], v[200:201]
v_cvt_pk_bf16_f32 v222, v194, v195
v_cvt_pk_bf16_f32 v223, v196, v197
v_cvt_pk_bf16_f32 v224, v198, v199
v_cvt_pk_bf16_f32 v225, v200, v201
s_cmp_lg_u32 s36, 0
s_cbranch_scc1 ALT_87
buffer_store_dwordx4 v[222:225], v243, s[4:7], s94 offen offset:512
ALTE_88:
s_cmp_lg_u32 s36, 0
s_cbranch_scc1 ALT_89
v_mov_b32 v11, 6
s_waitcnt vmcnt(0)
s_mov_b64 exec, 1
buffer_store_dword v11, off, s[4:7], s42
s_mov_b64 exec, -1
ALTE_90:
buffer_load_dwordx4 a[244:247], v50, s[4:7], s60 offen offset:1024
buffer_load_dwordx4 a[248:251], v50, s[4:7], s60 offen offset:2048
buffer_load_dwordx4 a[252:255], v50, s[4:7], s60 offen offset:3072
buffer_load_dword v255, v10, s[4:7], 0 offen sc1
s_waitcnt vmcnt(0)
ACK_91:
v_cmp_gt_u32 vcc, 5, v255
s_cbranch_vccz ACKD_92
buffer_load_dword v255, v10, s[4:7], 0 offen sc1
s_waitcnt vmcnt(0)
s_sub_u32 s39, s39, 1
s_cbranch_scc0 ACK_91
s_branch BAIL
ACKD_92:
P5END_54:
PH6:
buffer_load_dwordx4 v[106:109], v1, s[4:7], s81 offen offset:0 sc1
buffer_load_dwordx4 v[110:113], v1, s[4:7], s82 offen offset:0 sc1
buffer_load_dwordx4 v[114:117], v1, s[4:7], s83 offen offset:0 sc1
buffer_load_dwordx4 v[118:121], v1, s[4:7], s80 offen offset:0 sc1
buffer_load_dwordx4 v[122:125], v1, s[4:7], s81 offen offset:1024 sc1
s_cmp_lg_u32 s36, 0
s_cbranch_scc1 ALT_93
v_mov_b32 v11, 6
s_waitcnt vmcnt(5)
s_mov_b64 exec, 1
buffer_store_dword v11, off, s[4:7], s42
s_mov_b64 exec, -1
ALTE_94:
buffer_load_dwordx4 v[126:129], v1, s[4:7], s82 offen offset:1024 sc1
buffer_load_dwordx4 v[130:133], v1, s[4:7], s83 offen offset:1024 sc1
buffer_load_dwordx4 v[134:137], v1, s[4:7], s80 offen offset:1024 sc1
s_waitcnt vmcnt(8)
v_mfma_f32_16x16x32_bf16 v[58:61], a[192:195], v[106:109], 0
buffer_load_dwordx4 v[138:141], v1, s[4:7], s81 offen offset:2048 sc1
v_mfma_f32_16x16x32_bf16 v[62:65], a[196:199], v[106:109], 0
v_add_u32 v239, s68, v1
v_mfma_f32_16x16x32_bf16 v[66:69], a[200:203], v[106:109], 0
v_add_u32 v240, s69, v1
v_mfma_f32_16x16x32_bf16 v[70:73], a[204:207], v[106:109], 0
s_waitcnt vmcnt(8)
v_mfma_f32_16x16x32_bf16 v[74:77], a[192:195], v[110:113], 0
buffer_load_dwordx4 v[142:145], v1, s[4:7], s82 offen offset:2048 sc1
v_mfma_f32_16x16x32_bf16 v[78:81], a[196:199], v[110:113], 0
v_add_u32 v241, s70, v1
v_mfma_f32_16x16x32_bf16 v[82:85], a[200:203], v[110:113], 0
s_mul_i32 s58, s34, 12288
v_mfma_f32_16x16x32_bf16 v[86:89], a[204:207], v[110:113], 0
s_waitcnt vmcnt(8)
v_mfma_f32_16x16x32_bf16 v[90:93], a[192:195], v[114:117], 0
buffer_load_dwordx4 v[146:149], v1, s[4:7], s83 offen offset:2048 sc1
v_mfma_f32_16x16x32_bf16 v[94:97], a[196:199], v[114:117], 0
s_add_u32 s58, s58, 0
v_mfma_f32_16x16x32_bf16 v[98:101], a[200:203], v[114:117], 0
v_add_u32 v238, s58, v1
v_mfma_f32_16x16x32_bf16 v[102:105], a[204:207], v[114:117], 0
s_waitcnt vmcnt(8)
v_mfma_f32_16x16x32_bf16 v[12:15], a[192:195], v[118:121], v[12:15]
buffer_load_dwordx4 v[150:153], v1, s[4:7], s80 offen offset:2048 sc1
v_mfma_f32_16x16x32_bf16 v[16:19], a[196:199], v[118:121], v[16:19]
v_and_b32 v246, 15, v0
v_mfma_f32_16x16x32_bf16 v[20:23], a[200:203], v[118:121], v[20:23]
v_lshlrev_b32 v246, 4, v246
v_mfma_f32_16x16x32_bf16 v[24:27], a[204:207], v[118:121], v[24:27]
s_waitcnt vmcnt(8)
v_mfma_f32_16x16x32_bf16 v[58:61], a[208:211], v[122:125], v[58:61]
buffer_load_dwordx4 v[154:157], v1, s[4:7], s81 offen offset:3072 sc1
v_mfma_f32_16x16x32_bf16 v[62:65], a[212:215], v[122:125], v[62:65]
v_lshrrev_b32 v248, 4, v0
v_mfma_f32_16x16x32_bf16 v[66:69], a[216:219], v[122:125], v[66:69]
v_and_b32 v247, 1, v248
v_mfma_f32_16x16x32_bf16 v[70:73], a[220:223], v[122:125], v[70:73]
s_waitcnt vmcnt(7)
v_mfma_f32_16x16x32_bf16 v[74:77], a[208:211], v[126:129], v[74:77]
buffer_load_dwordx4 v[158:161], v1, s[4:7], s82 offen offset:3072 sc1
v_mfma_f32_16x16x32_bf16 v[78:81], a[212:215], v[126:129], v[78:81]
v_lshl_add_u32 v246, v247, 9, v246
v_mfma_f32_16x16x32_bf16 v[82:85], a[216:219], v[126:129], v[82:85]
v_lshrrev_b32 v247, 1, v248
v_mfma_f32_16x16x32_bf16 v[86:89], a[220:223], v[126:129], v[86:89]
s_waitcnt vmcnt(7)
v_mfma_f32_16x16x32_bf16 v[90:93], a[208:211], v[130:133], v[90:93]
buffer_load_dwordx4 v[162:165], v1, s[4:7], s83 offen offset:3072 sc1
v_mfma_f32_16x16x32_bf16 v[94:97], a[212:215], v[130:133], v[94:97]
v_lshl_add_u32 v246, v247, 8, v246
v_mfma_f32_16x16x32_bf16 v[98:101], a[216:219], v[130:133], v[98:101]
v_mfma_f32_16x16x32_bf16 v[102:105], a[220:223], v[130:133], v[102:105]
s_waitcnt vmcnt(7)
v_mfma_f32_16x16x32_bf16 v[12:15], a[208:211], v[134:137], v[12:15]
buffer_load_dwordx4 v[166:169], v1, s[4:7], s80 offen offset:3072 sc1
v_mfma_f32_16x16x32_bf16 v[16:19], a[212:215], v[134:137], v[16:19]
v_mfma_f32_16x16x32_bf16 v[20:23], a[216:219], v[134:137], v[20:23]
v_mfma_f32_16x16x32_bf16 v[24:27], a[220:223], v[134:137], v[24:27]
s_waitcnt vmcnt(7)
v_mfma_f32_16x16x32_bf16 v[58:61], a[224:227], v[138:141], v[58:61]
s_add_u32 s60, s49, 16384
buffer_load_dwordx4 a[192:195], v50, s[4:7], s60 offen offset:0
buffer_load_dwordx4 a[196:199], v50, s[4:7], s60 offen offset:1024
buffer_load_dwordx4 a[200:203], v50, s[4:7], s60 offen offset:2048
buffer_load_dwordx4 a[204:207], v50, s[4:7], s60 offen offset:3072
s_add_u32 s60, s49, 20480
buffer_load_dwordx4 a[208:211], v50, s[4:7], s60 offen offset:0
buffer_load_dwordx4 a[212:215], v50, s[4:7], s60 offen offset:1024
buffer_load_dwordx4 a[216:219], v50, s[4:7], s60 offen offset:2048
buffer_load_dwordx4 a[220:223], v50, s[4:7], s60 offen offset:3072
s_add_u32 s91, s65, 0xc01000
buffer_load_dwordx4 v[170:173], v1, s[4:7], s91 offen offset:3072 sc1
v_mfma_f32_16x16x32_bf16 v[62:65], a[228:231], v[138:141], v[62:65]
v_mfma_f32_16x16x32_bf16 v[66:69], a[232:235], v[138:141], v[66:69]
v_mfma_f32_16x16x32_bf16 v[70:73], a[236:239], v[138:141], v[70:73]
s_waitcnt vmcnt(15)
v_mfma_f32_16x16x32_bf16 v[74:77], a[224:227], v[142:145], v[74:77]
s_add_u32 s92, s66, 0xc01000
buffer_load_dwordx4 v[174:177], v1, s[4:7], s92 offen offset:3072 sc1
v_mfma_f32_16x16x32_bf16 v[78:81], a[228:231], v[142:145], v[78:81]
v_mfma_f32_16x16x32_bf16 v[82:85], a[232:235], v[142:145], v[82:85]
v_mfma_f32_16x16x32_bf16 v[86:89], a[236:239], v[142:145], v[86:89]
s_waitcnt vmcnt(15)
v_mfma_f32_16x16x32_bf16 v[90:93], a[224:227], v[146:149], v[90:93]
s_add_u32 s93, s67, 0xc01000
buffer_load_dwordx4 v[178:181], v1, s[4:7], s93 offen offset:3072 sc1
v_mfma_f32_16x16x32_bf16 v[94:97], a[228:231], v[146:149], v[94:97]
v_mfma_f32_16x16x32_bf16 v[98:101], a[232:235], v[146:149], v[98:101]
v_mfma_f32_16x16x32_bf16 v[102:105], a[236:239], v[146:149], v[102:105]
s_waitcnt vmcnt(15)
v_mfma_f32_16x16x32_bf16 v[12:15], a[224:227], v[150:153], v[12:15]
s_add_u32 s90, s64, 0xc01000
buffer_load_dwordx4 v[182:185], v1, s[4:7], s90 offen offset:3072 sc1
v_mfma_f32_16x16x32_bf16 v[16:19], a[228:231], v[150:153], v[16:19]
v_mfma_f32_16x16x32_bf16 v[20:23], a[232:235], v[150:153], v[20:23]
v_mfma_f32_16x16x32_bf16 v[24:27], a[236:239], v[150:153], v[24:27]
s_waitcnt vmcnt(15)
v_mfma_f32_16x16x32_bf16 v[58:61], a[240:243], v[154:157], v[58:61]
s_add_u32 s91, s65, 0xc02000
buffer_load_dwordx4 v[186:189], v1, s[4:7], s91 offen offset:1024 sc1
v_mfma_f32_16x16x32_bf16 v[62:65], a[244:247], v[154:157], v[62:65]
v_mfma_f32_16x16x32_bf16 v[66:69], a[248:251], v[154:157], v[66:69]
v_mfma_f32_16x16x32_bf16 v[70:73], a[252:255], v[154:157], v[70:73]
s_waitcnt vmcnt(15)
v_mfma_f32_16x16x32_bf16 v[74:77], a[240:243], v[158:161], v[74:77]
s_mov_b32 exec_lo, 0xffff0000
s_mov_b32 exec_hi, 1
buffer_load_dword v54, v55, s[4:7], 0 offen sc1
s_mov_b64 exec, -1
s_add_u32 s92, s66, 0xc02000
buffer_load_dwordx4 v[190:193], v1, s[4:7], s92 offen offset:1024 sc1
v_mfma_f32_16x16x32_bf16 v[78:81], a[244:247], v[158:161], v[78:81]
v_mfma_f32_16x16x32_bf16 v[82:85], a[248:251], v[158:161], v[82:85]
v_mfma_f32_16x16x32_bf16 v[86:89], a[252:255], v[158:161], v[86:89]
s_waitcnt vmcnt(16)
v_mfma_f32_16x16x32_bf16 v[90:93], a[240:243], v[162:165], v[90:93]
s_add_u32 s93, s67, 0xc02000
buffer_load_dwordx4 v[194:197], v1, s[4:7], s93 offen offset:1024 sc1
v_mfma_f32_16x16x32_bf16 v[94:97], a[244:247], v[162:165], v[94:97]
v_mfma_f32_16x16x32_bf16 v[98:101], a[248:251], v[162:165], v[98:101]
v_mfma_f32_16x16x32_bf16 v[102:105], a[252:255], v[162:165], v[102:105]
s_waitcnt vmcnt(16)
v_mfma_f32_16x16x32_bf16 v[12:15], a[240:243], v[166:169], v[12:15]
s_add_u32 s90, s64, 0xc02000
buffer_load_dwordx4 v[198:201], v1, s[4:7], s90 offen offset:1024 sc1
v_mfma_f32_16x16x32_bf16 v[16:19], a[244:247], v[166:169], v[16:19]
v_mfma_f32_16x16x32_bf16 v[20:23], a[248:251], v[166:169], v[20:23]
v_mfma_f32_16x16x32_bf16 v[24:27], a[252:255], v[166:169], v[24:27]
s_waitcnt vmcnt(13)
s_waitcnt vmcnt(8)
v_mfma_f32_16x16x32_bf16 v[58:61], a[192:195], v[170:173], v[58:61]
s_add_u32 s60, s49, 24576
buffer_load_dwordx4 a[224:227], v50, s[4:7], s60 offen offset:0
buffer_load_dwordx4 a[228:231], v50, s[4:7], s60 offen offset:1024
buffer_load_dwordx4 a[232:235], v50, s[4:7], s60 offen offset:2048
buffer_load_dwordx4 a[236:239], v50, s[4:7], s60 offen offset:3072
s_add_u32 s60, s49, 28672
buffer_load_dwordx4 a[240:243], v50, s[4:7], s60 offen offset:0
buffer_load_dwordx4 a[244:247], v50, s[4:7], s60 offen offset:1024
buffer_load_dwordx4 a[248:251], v50, s[4:7], s60 offen offset:2048
buffer_load_dwordx4 a[252:255], v50, s[4:7], s60 offen offset:3072
buffer_load_dwordx4 v[202:205], v1, s[4:7], s91 offen offset:3072 sc1
v_mfma_f32_16x16x32_bf16 v[62:65], a[196:199], v[170:173], v[62:65]
v_mfma_f32_16x16x32_bf16 v[66:69], a[200:203], v[170:173], v[66:69]
v_mfma_f32_16x16x32_bf16 v[70:73], a[204:207], v[170:173], v[70:73]
s_waitcnt vmcnt(16)
v_mfma_f32_16x16x32_bf16 v[74:77], a[192:195], v[174:177], v[74:77]
buffer_load_dword v255, v10, s[4:7], 0 offen sc1
buffer_load_dwordx4 v[206:209], v1, s[4:7], s92 offen offset:3072 sc1
v_mfma_f32_16x16x32_bf16 v[78:81], a[196:199], v[174:177], v[78:81]
v_mfma_f32_16x16x32_bf16 v[82:85], a[200:203], v[174:177], v[82:85]
v_mfma_f32_16x16x32_bf16 v[86:89], a[204:207], v[174:177], v[86:89]
s_waitcnt vmcnt(17)
v_mfma_f32_16x16x32_bf16 v[90:93], a[192:195], v[178:181], v[90:93]
buffer_load_dwordx4 v[210:213], v1, s[4:7], s93 offen offset:3072 sc1
v_mfma_f32_16x16x32_bf16 v[94:97], a[196:199], v[178:181], v[94:97]
v_mfma_f32_16x16x32_bf16 v[98:101], a[200:203], v[178:181], v[98:101]
v_mfma_f32_16x16x32_bf16 v[102:105], a[204:207], v[178:181], v[102:105]
s_waitcnt vmcnt(17)
v_mfma_f32_16x16x32_bf16 v[12:15], a[192:195], v[182:185], v[12:15]
buffer_load_dwordx4 v[214:217], v1, s[4:7], s90 offen offset:3072 sc1
v_mfma_f32_16x16x32_bf16 v[16:19], a[196:199], v[182:185], v[16:19]
v_mfma_f32_16x16x32_bf16 v[20:23], a[200:203], v[182:185], v[20:23]
v_mfma_f32_16x16x32_bf16 v[24:27], a[204:207], v[182:185], v[24:27]
s_waitcnt vmcnt(17)
v_mfma_f32_16x16x32_bf16 v[58:61], a[208:211], v[186:189], v[58:61]
s_add_u32 s91, s65, 0xc03000
buffer_load_dwordx4 v[106:109], v1, s[4:7], s91 offen offset:1024 sc1
v_mfma_f32_16x16x32_bf16 v[62:65], a[212:215], v[186:189], v[62:65]
v_mfma_f32_16x16x32_bf16 v[66:69], a[216:219], v[186:189], v[66:69]
v_mfma_f32_16x16x32_bf16 v[70:73], a[220:223], v[186:189], v[70:73]
s_waitcnt vmcnt(16)
v_mfma_f32_16x16x32_bf16 v[74:77], a[208:211], v[190:193], v[74:77]
s_add_u32 s92, s66, 0xc03000
buffer_load_dwordx4 v[110:113], v1, s[4:7], s92 offen offset:1024 sc1
v_mfma_f32_16x16x32_bf16 v[78:81], a[212:215], v[190:193], v[78:81]
v_mfma_f32_16x16x32_bf16 v[82:85], a[216:219], v[190:193], v[82:85]
v_mfma_f32_16x16x32_bf16 v[86:89], a[220:223], v[190:193], v[86:89]
s_waitcnt vmcnt(16)
v_mfma_f32_16x16x32_bf16 v[90:93], a[208:211], v[194:197], v[90:93]
s_add_u32 s93, s67, 0xc03000
buffer_load_dwordx4 v[114:117], v1, s[4:7], s93 offen offset:1024 sc1
v_mfma_f32_16x16x32_bf16 v[94:97], a[212:215], v[194:197], v[94:97]
v_mfma_f32_16x16x32_bf16 v[98:101], a[216:219], v[194:197], v[98:101]
v_mfma_f32_16x16x32_bf16 v[102:105], a[220:223], v[194:197], v[102:105]
s_waitcnt vmcnt(16)
v_mfma_f32_16x16x32_bf16 v[12:15], a[208:211], v[198:201], v[12:15]
s_add_u32 s90, s64, 0xc03000
buffer_load_dwordx4 v[118:121], v1, s[4:7], s90 offen offset:1024 sc1
v_mfma_f32_16x16x32_bf16 v[16:19], a[212:215], v[198:201], v[16:19]
v_mfma_f32_16x16x32_bf16 v[20:23], a[216:219], v[198:201], v[20:23]
v_mfma_f32_16x16x32_bf16 v[24:27], a[220:223], v[198:201], v[24:27]
s_waitcnt vmcnt(13)
s_waitcnt vmcnt(8)
v_mfma_f32_16x16x32_bf16 v[58:61], a[224:227], v[202:205], v[58:61]
s_add_u32 s60, s49, 32768
buffer_load_dwordx4 a[192:195], v50, s[4:7], s60 offen offset:0
buffer_load_dwordx4 a[196:199], v50, s[4:7], s60 offen offset:1024
buffer_load_dwordx4 a[200:203], v50, s[4:7], s60 offen offset:2048
buffer_load_dwordx4 a[204:207], v50, s[4:7], s60 offen offset:3072
s_add_u32 s60, s49, 36864
buffer_load_dwordx4 a[208:211], v50, s[4:7], s60 offen offset:0
buffer_load_dwordx4 a[212:215], v50, s[4:7], s60 offen offset:1024
buffer_load_dwordx4 a[216:219], v50, s[4:7], s60 offen offset:2048
buffer_load_dwordx4 a[220:223], v50, s[4:7], s60 offen offset:3072
s_waitcnt vmcnt(15)
ACK_95:
v_cmp_gt_u32 vcc, 6, v255
s_cbranch_vccz ACKD_96
buffer_load_dword v255, v10, s[4:7], 0 offen sc1
s_waitcnt vmcnt(0)
s_sub_u32 s39, s39, 1
s_cbranch_scc0 ACK_95
s_branch BAIL
ACKD_96:
s_add_u32 s91, s65, 0xc00000
buffer_load_dwordx4 v[122:125], v1, s[4:7], s91 offen offset:1024 sc1
v_mfma_f32_16x16x32_bf16 v[62:65], a[228:231], v[202:205], v[62:65]
v_mfma_f32_16x16x32_bf16 v[66:69], a[232:235], v[202:205], v[66:69]
v_mfma_f32_16x16x32_bf16 v[70:73], a[236:239], v[202:205], v[70:73]
s_waitcnt vmcnt(15)
v_mfma_f32_16x16x32_bf16 v[74:77], a[224:227], v[206:209], v[74:77]
s_add_u32 s92, s66, 0xc00000
buffer_load_dwordx4 v[126:129], v1, s[4:7], s92 offen offset:1024 sc1
v_mfma_f32_16x16x32_bf16 v[78:81], a[228:231], v[206:209], v[78:81]
v_mfma_f32_16x16x32_bf16 v[82:85], a[232:235], v[206:209], v[82:85]
v_mfma_f32_16x16x32_bf16 v[86:89], a[236:239], v[206:209], v[86:89]
s_waitcnt vmcnt(15)
v_mfma_f32_16x16x32_bf16 v[90:93], a[224:227], v[210:213], v[90:93]
s_add_u32 s93, s67, 0xc00000
buffer_load_dwordx4 v[130:133], v1, s[4:7], s93 offen offset:1024 sc1
v_mfma_f32_16x16x32_bf16 v[94:97], a[228:231], v[210:213], v[94:97]
v_mfma_f32_16x16x32_bf16 v[98:101], a[232:235], v[210:213], v[98:101]
v_mfma_f32_16x16x32_bf16 v[102:105], a[236:239], v[210:213], v[102:105]
s_waitcnt vmcnt(15)
v_mfma_f32_16x16x32_bf16 v[12:15], a[224:227], v[214:217], v[12:15]
s_add_u32 s90, s64, 0xc00000
buffer_load_dwordx4 v[134:137], v1, s[4:7], s90 offen offset:1024 sc1
v_mfma_f32_16x16x32_bf16 v[16:19], a[228:231], v[214:217], v[16:19]
v_mfma_f32_16x16x32_bf16 v[20:23], a[232:235], v[214:217], v[20:23]
v_mfma_f32_16x16x32_bf16 v[24:27], a[236:239], v[214:217], v[24:27]
s_waitcnt vmcnt(15)
v_mfma_f32_16x16x32_bf16 v[58:61], a[240:243], v[106:109], v[58:61]
buffer_load_dwordx4 v[138:141], v1, s[4:7], s91 offen offset:3072 sc1
v_mfma_f32_16x16x32_bf16 v[62:65], a[244:247], v[106:109], v[62:65]
v_mfma_f32_16x16x32_bf16 v[66:69], a[248:251], v[106:109], v[66:69]
v_mfma_f32_16x16x32_bf16 v[70:73], a[252:255], v[106:109], v[70:73]
s_waitcnt vmcnt(15)
v_mfma_f32_16x16x32_bf16 v[74:77], a[240:243], v[110:113], v[74:77]
buffer_load_dwordx4 v[142:145], v1, s[4:7], s92 offen offset:3072 sc1
v_mfma_f32_16x16x32_bf16 v[78:81], a[244:247], v[110:113], v[78:81]
v_mfma_f32_16x16x32_bf16 v[82:85], a[248:251], v[110:113], v[82:85]
v_mfma_f32_16x16x32_bf16 v[86:89], a[252:255], v[110:113], v[86:89]
s_waitcnt vmcnt(15)
v_mfma_f32_16x16x32_bf16 v[90:93], a[240:243], v[114:117], v[90:93]
buffer_load_dwordx4 v[146:149], v1, s[4:7], s93 offen offset:3072 sc1
v_mfma_f32_16x16x32_bf16 v[94:97], a[244:247], v[114:117], v[94:97]
v_mfma_f32_16x16x32_bf16 v[98:101], a[248:251], v[114:117], v[98:101]
v_mfma_f32_16x16x32_bf16 v[102:105], a[252:255], v[114:117], v[102:105]
s_waitcnt vmcnt(15)
v_mfma_f32_16x16x32_bf16 v[12:15], a[240:243], v[118:121], v[12:15]
buffer_load_dwordx4 v[150:153], v1, s[4:7], s90 offen offset:3072 sc1
v_mfma_f32_16x16x32_bf16 v[16:19], a[244:247], v[118:121], v[16:19]
v_mfma_f32_16x16x32_bf16 v[20:23], a[248:251], v[118:121], v[20:23]
v_mfma_f32_16x16x32_bf16 v[24:27], a[252:255], v[118:121], v[24:27]
s_waitcnt vmcnt(12)
s_waitcnt vmcnt(7)
v_mfma_f32_16x16x32_bf16 v[58:61], a[192:195], v[122:125], v[58:61]
s_add_u32 s60, s49, 40960
buffer_load_dwordx4 a[224:227], v50, s[4:7], s60 offen offset:0
buffer_load_dwordx4 a[228:231], v50, s[4:7], s60 offen offset:1024
buffer_load_dwordx4 a[232:235], v50, s[4:7], s60 offen offset:2048
buffer_load_dwordx4 a[236:239], v50, s[4:7], s60 offen offset:3072
s_add_u32 s60, s49, 45056
buffer_load_dwordx4 a[240:243], v50, s[4:7], s60 offen offset:0
buffer_load_dwordx4 a[244:247], v50, s[4:7], s60 offen offset:1024
buffer_load_dwordx4 a[248:251], v50, s[4:7], s60 offen offset:2048
buffer_load_dwordx4 a[252:255], v50, s[4:7], s60 offen offset:3072
s_add_u32 s91, s65, 0xc01000
buffer_load_dwordx4 v[154:157], v1, s[4:7], s91 offen offset:1024 sc1
v_mfma_f32_16x16x32_bf16 v[62:65], a[196:199], v[122:125], v[62:65]
v_mfma_f32_16x16x32_bf16 v[66:69], a[200:203], v[122:125], v[66:69]
v_mfma_f32_16x16x32_bf16 v[70:73], a[204:207], v[122:125], v[70:73]
s_waitcnt vmcnt(15)
v_mfma_f32_16x16x32_bf16 v[74:77], a[192:195], v[126:129], v[74:77]
s_add_u32 s92, s66, 0xc01000
buffer_load_dwordx4 v[158:161], v1, s[4:7], s92 offen offset:1024 sc1
v_mfma_f32_16x16x32_bf16 v[78:81], a[196:199], v[126:129], v[78:81]
v_mfma_f32_16x16x32_bf16 v[82:85], a[200:203], v[126:129], v[82:85]
v_mfma_f32_16x16x32_bf16 v[86:89], a[204:207], v[126:129], v[86:89]
s_waitcnt vmcnt(15)
v_mfma_f32_16x16x32_bf16 v[90:93], a[192:195], v[130:133], v[90:93]
s_add_u32 s93, s67, 0xc01000
buffer_load_dwordx4 v[162:165], v1, s[4:7], s93 offen offset:1024 sc1
v_mfma_f32_16x16x32_bf16 v[94:97], a[196:199], v[130:133], v[94:97]
v_mfma_f32_16x16x32_bf16 v[98:101], a[200:203], v[130:133], v[98:101]
v_mfma_f32_16x16x32_bf16 v[102:105], a[204:207], v[130:133], v[102:105]
s_waitcnt vmcnt(15)
v_mfma_f32_16x16x32_bf16 v[12:15], a[192:195], v[134:137], v[12:15]
s_add_u32 s90, s64, 0xc01000
buffer_load_dwordx4 v[166:169], v1, s[4:7], s90 offen offset:1024 sc1
v_mfma_f32_16x16x32_bf16 v[16:19], a[196:199], v[134:137], v[16:19]
v_mfma_f32_16x16x32_bf16 v[20:23], a[200:203], v[134:137], v[20:23]
v_mfma_f32_16x16x32_bf16 v[24:27], a[204:207], v[134:137], v[24:27]
s_waitcnt vmcnt(15)
v_mfma_f32_16x16x32_bf16 v[58:61], a[208:211], v[138:141], v[58:61]
s_add_u32 s91, s65, 0xc02000
buffer_load_dwordx4 v[170:173], v1, s[4:7], s91 offen offset:0 sc1
v_mfma_f32_16x16x32_bf16 v[62:65], a[212:215], v[138:141], v[62:65]
v_mfma_f32_16x16x32_bf16 v[66:69], a[216:219], v[138:141], v[66:69]
v_mfma_f32_16x16x32_bf16 v[70:73], a[220:223], v[138:141], v[70:73]
s_waitcnt vmcnt(15)
v_mfma_f32_16x16x32_bf16 v[74:77], a[208:211], v[142:145], v[74:77]
s_add_u32 s92, s66, 0xc02000
buffer_load_dwordx4 v[174:177], v1, s[4:7], s92 offen offset:0 sc1
v_mfma_f32_16x16x32_bf16 v[78:81], a[212:215], v[142:145], v[78:81]
v_mfma_f32_16x16x32_bf16 v[82:85], a[216:219], v[142:145], v[82:85]
v_mfma_f32_16x16x32_bf16 v[86:89], a[220:223], v[142:145], v[86:89]
s_waitcnt vmcnt(15)
v_mfma_f32_16x16x32_bf16 v[90:93], a[208:211], v[146:149], v[90:93]
s_add_u32 s93, s67, 0xc02000
buffer_load_dwordx4 v[178:181], v1, s[4:7], s93 offen offset:0 sc1
v_mfma_f32_16x16x32_bf16 v[94:97], a[212:215], v[146:149], v[94:97]
v_mfma_f32_16x16x32_bf16 v[98:101], a[216:219], v[146:149], v[98:101]
v_mfma_f32_16x16x32_bf16 v[102:105], a[220:223], v[146:149], v[102:105]
s_waitcnt vmcnt(15)
v_mfma_f32_16x16x32_bf16 v[12:15], a[208:211], v[150:153], v[12:15]
s_add_u32 s90, s64, 0xc02000
buffer_load_dwordx4 v[182:185], v1, s[4:7], s90 offen offset:0 sc1
v_mfma_f32_16x16x32_bf16 v[16:19], a[212:215], v[150:153], v[16:19]
v_mfma_f32_16x16x32_bf16 v[20:23], a[216:219], v[150:153], v[20:23]
v_mfma_f32_16x16x32_bf16 v[24:27], a[220:223], v[150:153], v[24:27]
s_waitcnt vmcnt(12)
s_waitcnt vmcnt(7)
v_mfma_f32_16x16x32_bf16 v[58:61], a[224:227], v[154:157], v[58:61]
s_add_u32 s60, s49, 49152
buffer_load_dwordx4 a[192:195], v50, s[4:7], s60 offen offset:0
buffer_load_dwordx4 a[196:199], v50, s[4:7], s60 offen offset:1024
buffer_load_dwordx4 a[200:203], v50, s[4:7], s60 offen offset:2048
buffer_load_dwordx4 a[204:207], v50, s[4:7], s60 offen offset:3072
s_add_u32 s60, s49, 53248
buffer_load_dwordx4 a[208:211], v50, s[4:7], s60 offen offset:0
buffer_load_dwordx4 a[212:215], v50, s[4:7], s60 offen offset:1024
buffer_load_dwordx4 a[216:219], v50, s[4:7], s60 offen offset:2048
buffer_load_dwordx4 a[220:223], v50, s[4:7], s60 offen offset:3072
buffer_load_dwordx4 v[186:189], v1, s[4:7], s91 offen offset:2048 sc1
v_mfma_f32_16x16x32_bf16 v[62:65], a[228:231], v[154:157], v[62:65]
v_mfma_f32_16x16x32_bf16 v[66:69], a[232:235], v[154:157], v[66:69]
v_mfma_f32_16x16x32_bf16 v[70:73], a[236:239], v[154:157], v[70:73]
s_waitcnt vmcnt(15)
v_mfma_f32_16x16x32_bf16 v[74:77], a[224:227], v[158:161], v[74:77]
s_add_u32 s91, s65, 0xc03000
buffer_load_dwordx4 v[190:193], v1, s[4:7], s91 offen offset:0 sc1
v_mfma_f32_16x16x32_bf16 v[78:81], a[228:231], v[158:161], v[78:81]
v_mfma_f32_16x16x32_bf16 v[82:85], a[232:235], v[158:161], v[82:85]
v_mfma_f32_16x16x32_bf16 v[86:89], a[236:239], v[158:161], v[86:89]
s_waitcnt vmcnt(15)
v_mfma_f32_16x16x32_bf16 v[90:93], a[224:227], v[162:165], v[90:93]
buffer_load_dwordx4 v[194:197], v1, s[4:7], s92 offen offset:2048 sc1
v_mfma_f32_16x16x32_bf16 v[94:97], a[228:231], v[162:165], v[94:97]
v_mfma_f32_16x16x32_bf16 v[98:101], a[232:235], v[162:165], v[98:101]
v_mfma_f32_16x16x32_bf16 v[102:105], a[236:239], v[162:165], v[102:105]
s_waitcnt vmcnt(15)
v_mfma_f32_16x16x32_bf16 v[12:15], a[224:227], v[166:169], v[12:15]
s_add_u32 s92, s66, 0xc03000
buffer_load_dwordx4 v[198:201], v1, s[4:7], s92 offen offset:0 sc1
v_mfma_f32_16x16x32_bf16 v[16:19], a[228:231], v[166:169], v[16:19]
v_mfma_f32_16x16x32_bf16 v[20:23], a[232:235], v[166:169], v[20:23]
v_mfma_f32_16x16x32_bf16 v[24:27], a[236:239], v[166:169], v[24:27]
s_waitcnt vmcnt(15)
v_mfma_f32_16x16x32_bf16 v[58:61], a[240:243], v[170:173], v[58:61]
buffer_load_dwordx4 v[202:205], v1, s[4:7], s93 offen offset:2048 sc1
v_mfma_f32_16x16x32_bf16 v[62:65], a[244:247], v[170:173], v[62:65]
v_mfma_f32_16x16x32_bf16 v[66:69], a[248:251], v[170:173], v[66:69]
v_mfma_f32_16x16x32_bf16 v[70:73], a[252:255], v[170:173], v[70:73]
s_waitcnt vmcnt(15)
v_mfma_f32_16x16x32_bf16 v[74:77], a[240:243], v[174:177], v[74:77]
s_add_u32 s93, s67, 0xc03000
buffer_load_dwordx4 v[206:209], v1, s[4:7], s93 offen offset:0 sc1
v_mfma_f32_16x16x32_bf16 v[78:81], a[244:247], v[174:177], v[78:81]
v_mfma_f32_16x16x32_bf16 v[82:85], a[248:251], v[174:177], v[82:85]
v_mfma_f32_16x16x32_bf16 v[86:89], a[252:255], v[174:177], v[86:89]
s_waitcnt vmcnt(15)
v_mfma_f32_16x16x32_bf16 v[90:93], a[240:243], v[178:181], v[90:93]
buffer_load_dwordx4 v[210:213], v1, s[4:7], s90 offen offset:2048 sc1
v_mfma_f32_16x16x32_bf16 v[94:97], a[244:247], v[178:181], v[94:97]
v_mfma_f32_16x16x32_bf16 v[98:101], a[248:251], v[178:181], v[98:101]
v_mfma_f32_16x16x32_bf16 v[102:105], a[252:255], v[178:181], v[102:105]
s_waitcnt vmcnt(15)
v_mfma_f32_16x16x32_bf16 v[12:15], a[240:243], v[182:185], v[12:15]
s_add_u32 s90, s64, 0xc03000
buffer_load_dwordx4 v[214:217], v1, s[4:7], s90 offen offset:0 sc1
v_mfma_f32_16x16x32_bf16 v[16:19], a[244:247], v[182:185], v[16:19]
v_mfma_f32_16x16x32_bf16 v[20:23], a[248:251], v[182:185], v[20:23]
v_mfma_f32_16x16x32_bf16 v[24:27], a[252:255], v[182:185], v[24:27]
s_waitcnt vmcnt(12)
s_waitcnt vmcnt(7)
v_mfma_f32_16x16x32_bf16 v[58:61], a[192:195], v[186:189], v[58:61]
v_mfma_f32_16x16x32_bf16 v[62:65], a[196:199], v[186:189], v[62:65]
v_mfma_f32_16x16x32_bf16 v[66:69], a[200:203], v[186:189], v[66:69]
v_mfma_f32_16x16x32_bf16 v[70:73], a[204:207], v[186:189], v[70:73]
s_waitcnt vmcnt(6)
v_mfma_f32_16x16x32_bf16 v[58:61], a[208:211], v[190:193], v[58:61]
v_mfma_f32_16x16x32_bf16 v[62:65], a[212:215], v[190:193], v[62:65]
v_mfma_f32_16x16x32_bf16 v[66:69], a[216:219], v[190:193], v[66:69]
v_mfma_f32_16x16x32_bf16 v[70:73], a[220:223], v[190:193], v[70:73]
s_waitcnt vmcnt(5)
v_mfma_f32_16x16x32_bf16 v[74:77], a[192:195], v[194:197], v[74:77]
v_mfma_f32_16x16x32_bf16 v[78:81], a[196:199], v[194:197], v[78:81]
s_nop 1
ds_write_b128 v239, v[58:61] offset:0
v_mfma_f32_16x16x32_bf16 v[82:85], a[200:203], v[194:197], v[82:85]
v_mfma_f32_16x16x32_bf16 v[86:89], a[204:207], v[194:197], v[86:89]
ds_write_b128 v239, v[62:65] offset:1024
s_waitcnt vmcnt(4)
v_mfma_f32_16x16x32_bf16 v[74:77], a[208:211], v[198:201], v[74:77]
v_mfma_f32_16x16x32_bf16 v[78:81], a[212:215], v[198:201], v[78:81]
ds_write_b128 v239, v[66:69] offset:2048
v_mfma_f32_16x16x32_bf16 v[82:85], a[216:219], v[198:201], v[82:85]
v_mfma_f32_16x16x32_bf16 v[86:89], a[220:223], v[198:201], v[86:89]
ds_write_b128 v239, v[70:73] offset:3072
s_waitcnt vmcnt(3)
v_mfma_f32_16x16x32_bf16 v[90:93], a[192:195], v[202:205], v[90:93]
v_mfma_f32_16x16x32_bf16 v[94:97], a[196:199], v[202:205], v[94:97]
ds_write_b128 v240, v[74:77] offset:0
v_mfma_f32_16x16x32_bf16 v[98:101], a[200:203], v[202:205], v[98:101]
v_mfma_f32_16x16x32_bf16 v[102:105], a[204:207], v[202:205], v[102:105]
ds_write_b128 v240, v[78:81] offset:1024
s_waitcnt vmcnt(2)
v_mfma_f32_16x16x32_bf16 v[90:93], a[208:211], v[206:209], v[90:93]
v_mfma_f32_16x16x32_bf16 v[94:97], a[212:215], v[206:209], v[94:97]
ds_write_b128 v240, v[82:85] offset:2048
v_mfma_f32_16x16x32_bf16 v[98:101], a[216:219], v[206:209], v[98:101]
v_mfma_f32_16x16x32_bf16 v[102:105], a[220:223], v[206:209], v[102:105]
ds_write_b128 v240, v[86:89] offset:3072
s_waitcnt vmcnt(1)
v_mfma_f32_16x16x32_bf16 v[12:15], a[192:195], v[210:213], v[12:15]
v_mfma_f32_16x16x32_bf16 v[16:19], a[196:199], v[210:213], v[16:19]
ds_write_b128 v241, v[90:93] offset:0
v_mfma_f32_16x16x32_bf16 v[20:23], a[200:203], v[210:213], v[20:23]
v_mfma_f32_16x16x32_bf16 v[24:27], a[204:207], v[210:213], v[24:27]
ds_write_b128 v241, v[94:97] offset:1024
s_waitcnt vmcnt(0)
v_mfma_f32_16x16x32_bf16 v[12:15], a[208:211], v[214:217], v[12:15]
v_mfma_f32_16x16x32_bf16 v[16:19], a[212:215], v[214:217], v[16:19]
ds_write_b128 v241, v[98:101] offset:2048
v_mfma_f32_16x16x32_bf16 v[20:23], a[216:219], v[214:217], v[20:23]
v_mfma_f32_16x16x32_bf16 v[24:27], a[220:223], v[214:217], v[24:27]
ds_write_b128 v241, v[102:105] offset:3072
s_waitcnt lgkmcnt(0)
s_barrier
ds_read_b128 v[58:61], v238 offset:0
ds_read_b128 v[62:65], v238 offset:1024
ds_read_b128 v[66:69], v238 offset:2048
ds_read_b128 v[70:73], v238 offset:3072
ds_read_b128 v[74:77], v238 offset:4096
ds_read_b128 v[78:81], v238 offset:5120
ds_read_b128 v[82:85], v238 offset:6144
ds_read_b128 v[86:89], v238 offset:7168
ds_read_b128 v[90:93], v238 offset:8192
ds_read_b128 v[94:97], v238 offset:9216
ds_read_b128 v[98:101], v238 offset:10240
ds_read_b128 v[102:105], v238 offset:11264
s_waitcnt lgkmcnt(7)
v_pk_add_f32 v[58:59], v[58:59], v[74:75]
v_pk_add_f32 v[60:61], v[60:61], v[76:77]
s_waitcnt lgkmcnt(6)
v_pk_add_f32 v[62:63], v[62:63], v[78:79]
v_pk_add_f32 v[64:65], v[64:65], v[80:81]
s_waitcnt lgkmcnt(5)
v_pk_add_f32 v[66:67], v[66:67], v[82:83]
v_pk_add_f32 v[68:69], v[68:69], v[84:85]
s_waitcnt lgkmcnt(4)
v_pk_add_f32 v[70:71], v[70:71], v[86:87]
v_pk_add_f32 v[72:73], v[72:73], v[88:89]
s_waitcnt lgkmcnt(3)
v_pk_add_f32 v[58:59], v[58:59], v[90:91]
v_pk_add_f32 v[60:61], v[60:61], v[92:93]
s_waitcnt lgkmcnt(2)
v_pk_add_f32 v[62:63], v[62:63], v[94:95]
v_pk_add_f32 v[64:65], v[64:65], v[96:97]
s_waitcnt lgkmcnt(1)
v_pk_add_f32 v[66:67], v[66:67], v[98:99]
v_pk_add_f32 v[68:69], v[68:69], v[100:101]
s_waitcnt lgkmcnt(0)
v_pk_add_f32 v[70:71], v[70:71], v[102:103]
v_pk_add_f32 v[72:73], v[72:73], v[104:105]
v_pk_add_f32 v[12:13], v[12:13], v[58:59]
v_pk_add_f32 v[14:15], v[14:15], v[60:61]
v_pk_add_f32 v[16:17], v[16:17], v[62:63]
v_pk_add_f32 v[18:19], v[18:19], v[64:65]
v_pk_add_f32 v[20:21], v[20:21], v[66:67]
v_pk_add_f32 v[22:23], v[22:23], v[68:69]
v_pk_add_f32 v[24:25], v[24:25], v[70:71]
v_pk_add_f32 v[26:27], v[26:27], v[72:73]
v_cvt_pk_bf16_f32 v106, v12, v13
v_cvt_pk_bf16_f32 v107, v14, v15
v_cvt_pk_bf16_f32 v108, v16, v17
v_cvt_pk_bf16_f32 v109, v18, v19
v_cvt_pk_bf16_f32 v110, v20, v21
v_cvt_pk_bf16_f32 v111, v22, v23
v_cvt_pk_bf16_f32 v112, v24, v25
v_cvt_pk_bf16_f32 v113, v26, v27
v_permlane16_swap_b32 v106, v108
v_permlane16_swap_b32 v107, v109
v_permlane16_swap_b32 v110, v112
v_permlane16_swap_b32 v111, v113
s_add_u32 s58, s50, s52
s_add_u32 s58, s58, 0xa00000
s_cmp_lg_u32 s36, 0
s_cbranch_scc1 ALT_97
buffer_store_dwordx4 v[106:109], v246, s[4:7], s58 offen
buffer_store_dwordx4 v[110:113], v246, s[4:7], s58 offen offset:1024
ALTE_98:
v_pk_add_f32 v[242:243], v[12:13], v[14:15]
v_pk_mul_f32 v[244:245], v[12:13], v[12:13]
v_pk_fma_f32 v[244:245], v[14:15], v[14:15], v[244:245]
v_pk_add_f32 v[242:243], v[242:243], v[16:17]
v_pk_fma_f32 v[244:245], v[16:17], v[16:17], v[244:245]
v_pk_add_f32 v[242:243], v[242:243], v[18:19]
v_pk_fma_f32 v[244:245], v[18:19], v[18:19], v[244:245]
v_pk_add_f32 v[242:243], v[242:243], v[20:21]
v_pk_fma_f32 v[244:245], v[20:21], v[20:21], v[244:245]
v_pk_add_f32 v[242:243], v[242:243], v[22:23]
v_pk_fma_f32 v[244:245], v[22:23], v[22:23], v[244:245]
v_pk_add_f32 v[242:243], v[242:243], v[24:25]
v_pk_fma_f32 v[244:245], v[24:25], v[24:25], v[244:245]
v_pk_add_f32 v[242:243], v[242:243], v[26:27]
v_pk_fma_f32 v[244:245], v[26:27], v[26:27], v[244:245]
v_add_f32 v242, v242, v243
v_add_f32 v244, v244, v245
s_nop 1
v_permlane32_swap_b32 v242, v244
v_add_f32 v242, v242, v244
v_mov_b32 v243, v242
s_nop 1
v_permlane16_swap_b32 v242, v243
v_add_f32 v242, v242, v243
s_add_u32 s58, s51, 0x1320000
s_mov_b32 s94, s58
s_lshl_b32 s58, s32, 15
s_add_u32 s59, s58, 0x1404000
s_add_u32 s58, s58, s52
s_add_u32 s61, s58, 0x1400000
s_cmp_lg_u32 s36, 0
s_cbranch_scc1 ALT_99
buffer_store_dword v242, v44, s[4:7], s94 offen
v_mov_b32 v11, 7
s_cmp_eq_u32 s37, 0
s_cbranch_scc1 EXP_103
buffer_store_dwordx4 v[106:109], v246, s[4:7], s61 offen sc1
buffer_store_dwordx4 v[110:113], v246, s[4:7], s61 offen offset:1024 sc1
buffer_store_dword v242, v44, s[4:7], s59 offen sc1
s_waitcnt vmcnt(3)
s_branch EXW_104
EXP_103:
s_waitcnt vmcnt(0)
EXW_104:
s_mov_b64 exec, 1
buffer_store_dword v11, off, s[4:7], s42
s_mov_b64 exec, -1
ALTE_100:
PH7:
v_and_b32 v250, 15, v0
v_lshlrev_b32 v250, 2, v250
v_and_b32 v251, 48, v0
v_add_u32 v249, 65536, v1
v_add_u32 v250, 147456, v250
v_add_u32 v251, 147456, v251
v_and_b32 v166, 15, v0
v_lshrrev_b32 v167, 2, v0
v_and_b32 v167, 12, v167
v_sub_u32 v167, v166, v167
v_mov_b32 v186, 0xf149f2ca
s_cmp_eq_u32 s32, 0
s_cselect_b64 s[90:91], -1, 0
v_subrev_u32 v168, 0, v167
v_and_b32 v169, 0x80000001, v168
v_cmp_eq_u32 vcc, 0, v169
s_nop 1
v_cndmask_b32 v170, v186, 0, vcc
v_cmp_eq_u32 vcc, 0x80000000, v169
s_nop 1
v_cndmask_b32 v174, v186, 0, vcc
v_cndmask_b32 v178, v174, v186, s[90:91]
v_subrev_u32 v168, 1, v167
v_and_b32 v169, 0x80000001, v168
v_cmp_eq_u32 vcc, 0, v169
s_nop 1
v_cndmask_b32 v171, v186, 0, vcc
v_cmp_eq_u32 vcc, 0x80000000, v169
s_nop 1
v_cndmask_b32 v175, v186, 0, vcc
v_cndmask_b32 v179, v175, v186, s[90:91]
v_subrev_u32 v168, 2, v167
v_and_b32 v169, 0x80000001, v168
v_cmp_eq_u32 vcc, 0, v169
s_nop 1
v_cndmask_b32 v172, v186, 0, vcc
v_cmp_eq_u32 vcc, 0x80000000, v169
s_nop 1
v_cndmask_b32 v176, v186, 0, vcc
v_cndmask_b32 v180, v176, v186, s[90:91]
v_subrev_u32 v168, 3, v167
v_and_b32 v169, 0x80000001, v168
v_cmp_eq_u32 vcc, 0, v169
s_nop 1
v_cndmask_b32 v173, v186, 0, vcc
v_cmp_eq_u32 vcc, 0x80000000, v169
s_nop 1
v_cndmask_b32 v177, v186, 0, vcc
v_cndmask_b32 v181, v177, v186, s[90:91]
v_cmp_eq_u32 vcc, 0, v174
s_nop 1
v_cndmask_b32 v168, 0, -1, vcc
v_cmp_eq_u32 vcc, 0, v175
s_nop 1
v_cndmask_b32 v169, 0, -1, vcc
v_and_b32 v168, 0xffff, v168
v_and_b32 v169, 0xffff0000, v169
v_or_b32 v182, v168, v169
v_cmp_eq_u32 vcc, 0, v170
s_nop 1
v_cndmask_b32 v168, 0, -1, vcc
v_cmp_eq_u32 vcc, 0, v171
s_nop 1
v_cndmask_b32 v169, 0, -1, vcc
v_and_b32 v168, 0xffff, v168
v_and_b32 v169, 0xffff0000, v169
v_or_b32 v184, v168, v169
v_cmp_eq_u32 vcc, 0, v176
s_nop 1
v_cndmask_b32 v168, 0, -1, vcc
v_cmp_eq_u32 vcc, 0, v177
s_nop 1
v_cndmask_b32 v169, 0, -1, vcc
v_and_b32 v168, 0xffff, v168
v_and_b32 v169, 0xffff0000, v169
v_or_b32 v183, v168, v169
v_cmp_eq_u32 vcc, 0, v172
s_nop 1
v_cndmask_b32 v168, 0, -1, vcc
v_cmp_eq_u32 vcc, 0, v173
s_nop 1
v_cndmask_b32 v169, 0, -1, vcc
v_and_b32 v168, 0xffff, v168
v_and_b32 v169, 0xffff0000, v169
v_or_b32 v185, v168, v169
v_mov_b32 v186, 0x3f803f80
v_mov_b32 v187, 0x3f803f80
v_mov_b32 v188, 0x3f803f80
v_mov_b32 v189, 0x3f803f80
s_sub_u32 s58, s49, 0
s_cmp_eq_u32 s34, 3
s_cselect_b32 s55, s58, s47
s_cmp_eq_u32 s32, 0
s_cselect_b32 s58, 0x80000000, 0
v_add_u32 v248, s58, v1
s_cmp_eq_u32 s32, 31
s_cselect_b32 s58, 0, s45
s_lshl_b32 s58, s58, 7
v_lshrrev_b32 v166, 5, v0
v_mul_u32_u24 v166, s58, v166
v_add_u32 v8, v8, v166
s_add_u32 s61, s74, s53
v_bfe_u32 v166, v0, 4, 1
v_mad_i32_i24 v166, v166, -3, 7
s_cmp_eq_u32 s37, 0
s_cbranch_scc1 EXF_105
v_mov_b32 v11, 7
s_waitcnt vmcnt(1)
s_mov_b64 exec, 1
buffer_store_dword v11, off, s[4:7], s43 sc1
s_mov_b64 exec, -1
EXF_105:
POLL_106:
buffer_load_dword v11, v7, s[4:7], 0 offen sc1
s_waitcnt vmcnt(0)
v_cmp_gt_u32 vcc, v166, v11
s_cbranch_vccz POLLD_107
s_sub_u32 s39, s39, 1
s_cbranch_scc0 POLL_106
s_branch BAIL
POLLD_107:
s_add_u32 s59, s51, 0x1320000
buffer_load_dwordx4 v[146:149], v1, s[4:7], s59 offen sc1
s_add_u32 m0, s74, 65536
s_add_u32 s48, s50, 0xa00000
buffer_load_dwordx4 v1, s[4:7], s48 offen offset:0 sc1 lds
buffer_load_dwordx4 v1, s[4:7], s48 offen offset:1024 sc1 lds
buffer_load_dwordx4 v1, s[4:7], s48 offen offset:2048 sc1 lds
buffer_load_dwordx4 v1, s[4:7], s48 offen offset:3072 sc1 lds
s_add_u32 m0, s74, 81920
s_add_u32 s48, s50, 0xa01000
buffer_load_dwordx4 v1, s[4:7], s48 offen offset:0 sc1 lds
buffer_load_dwordx4 v1, s[4:7], s48 offen offset:1024 sc1 lds
s_waitcnt vmcnt(2)
s_barrier
ds_read_b128 v[114:117], v249 offset:0
ds_read_b128 v[118:121], v249 offset:4096
ds_read_b128 v[122:125], v249 offset:8192
ds_read_b128 v[126:129], v249 offset:12288
s_waitcnt lgkmcnt(3)
v_mfma_f32_16x16x32_bf16 v[58:61], a[0:3], v[114:117], 0
ds_read_b128 v[130:133], v249 offset:1024
v_mfma_f32_16x16x32_bf16 v[62:65], a[4:7], v[114:117], 0
buffer_load_dwordx4 v1, s[4:7], s48 offen offset:2048 sc1 lds
v_mfma_f32_16x16x32_bf16 v[66:69], v[114:117], a[8:11], 0
s_waitcnt lgkmcnt(3)
v_mfma_f32_16x16x32_bf16 v[70:73], a[0:3], v[118:121], 0
ds_read_b128 v[134:137], v249 offset:5120
v_mfma_f32_16x16x32_bf16 v[74:77], a[4:7], v[118:121], 0
v_mfma_f32_16x16x32_bf16 v[78:81], v[118:121], a[8:11], 0
buffer_load_dwordx4 v1, s[4:7], s48 offen offset:3072 sc1 lds
s_waitcnt lgkmcnt(3)
v_mfma_f32_16x16x32_bf16 v[82:85], a[0:3], v[122:125], 0
ds_read_b128 v[138:141], v249 offset:9216
v_mfma_f32_16x16x32_bf16 v[86:89], a[4:7], v[122:125], 0
v_mfma_f32_16x16x32_bf16 v[90:93], v[122:125], a[8:11], 0
s_waitcnt lgkmcnt(3)
v_mfma_f32_16x16x32_bf16 v[94:97], a[0:3], v[126:129], 0
ds_read_b128 v[142:145], v249 offset:13312
v_mfma_f32_16x16x32_bf16 v[98:101], a[4:7], v[126:129], 0
s_add_u32 m0, s74, 98304
s_add_u32 s48, s50, 0xa02000
buffer_load_dwordx4 v1, s[4:7], s48 offen offset:0 sc1 lds
v_mfma_f32_16x16x32_bf16 v[102:105], v[126:129], a[8:11], 0
s_waitcnt lgkmcnt(3)
v_mfma_f32_16x16x32_bf16 v[58:61], a[12:15], v[130:133], v[58:61]
ds_read_b128 v[114:117], v249 offset:2048
v_mfma_f32_16x16x32_bf16 v[62:65], a[16:19], v[130:133], v[62:65]
v_add_f32 v146, v146, v148
v_mfma_f32_16x16x32_bf16 v[66:69], v[130:133], a[20:23], v[66:69]
buffer_load_dwordx4 v1, s[4:7], s48 offen offset:1024 sc1 lds
v_add_f32 v147, v147, v149
s_waitcnt lgkmcnt(3)
v_mfma_f32_16x16x32_bf16 v[70:73], a[12:15], v[134:137], v[70:73]
ds_read_b128 v[118:121], v249 offset:6144
v_mfma_f32_16x16x32_bf16 v[74:77], a[16:19], v[134:137], v[74:77]
v_permlane32_swap_b32 v146, v147
v_mfma_f32_16x16x32_bf16 v[78:81], v[134:137], a[20:23], v[78:81]
v_add_f32 v146, v146, v147
s_waitcnt lgkmcnt(3)
v_mfma_f32_16x16x32_bf16 v[82:85], a[12:15], v[138:141], v[82:85]
ds_read_b128 v[122:125], v249 offset:10240
v_mfma_f32_16x16x32_bf16 v[86:89], a[16:19], v[138:141], v[86:89]
buffer_load_dwordx4 v1, s[4:7], s48 offen offset:2048 sc1 lds
v_mov_b32 v147, v146
v_mfma_f32_16x16x32_bf16 v[90:93], v[138:141], a[20:23], v[90:93]
s_nop 0
v_permlane16_swap_b32 v146, v147
s_waitcnt lgkmcnt(3)
v_mfma_f32_16x16x32_bf16 v[94:97], a[12:15], v[142:145], v[94:97]
ds_read_b128 v[126:129], v249 offset:14336
v_mfma_f32_16x16x32_bf16 v[98:101], a[16:19], v[142:145], v[98:101]
v_add_f32 v146, v146, v147
v_mfma_f32_16x16x32_bf16 v[102:105], v[142:145], a[20:23], v[102:105]
buffer_load_dwordx4 v1, s[4:7], s48 offen offset:3072 sc1 lds
v_mov_b32 v147, v146
s_waitcnt lgkmcnt(3)
v_mfma_f32_16x16x32_bf16 v[58:61], a[24:27], v[114:117], v[58:61]
ds_read_b128 v[130:133], v249 offset:3072
v_mfma_f32_16x16x32_bf16 v[62:65], a[28:31], v[114:117], v[62:65]
v_permlane32_swap_b32 v146, v147
v_mfma_f32_16x16x32_bf16 v[66:69], v[114:117], a[32:35], v[66:69]
v_mul_f32 v166, 0x3b000000, v146
s_waitcnt lgkmcnt(3)
v_mfma_f32_16x16x32_bf16 v[70:73], a[24:27], v[118:121], v[70:73]
ds_read_b128 v[134:137], v249 offset:7168
v_mfma_f32_16x16x32_bf16 v[74:77], a[28:31], v[118:121], v[74:77]
s_add_u32 m0, s74, 114688
s_add_u32 s48, s50, 0xa03000
buffer_load_dwordx4 v1, s[4:7], s48 offen offset:0 sc1 lds
v_mul_f32 v147, 0x3b000000, v147
v_mfma_f32_16x16x32_bf16 v[78:81], v[118:121], a[32:35], v[78:81]
v_fma_f32 v167, -v166, v166, v147
s_waitcnt lgkmcnt(3)
v_mfma_f32_16x16x32_bf16 v[82:85], a[24:27], v[122:125], v[82:85]
ds_read_b128 v[138:141], v249 offset:11264
v_mfma_f32_16x16x32_bf16 v[86:89], a[28:31], v[122:125], v[86:89]
v_max_f32 v167, 0, v167
v_mfma_f32_16x16x32_bf16 v[90:93], v[122:125], a[32:35], v[90:93]
buffer_load_dwordx4 v1, s[4:7], s48 offen offset:1024 sc1 lds
v_add_f32 v167, 0x3727c5ac, v167
s_waitcnt lgkmcnt(3)
v_mfma_f32_16x16x32_bf16 v[94:97], a[24:27], v[126:129], v[94:97]
ds_read_b128 v[142:145], v249 offset:15360
v_mfma_f32_16x16x32_bf16 v[98:101], a[28:31], v[126:129], v[98:101]
v_rsq_f32 v167, v167
v_mfma_f32_16x16x32_bf16 v[102:105], v[126:129], a[32:35], v[102:105]
s_lshl_b32 s58, s34, 6
s_waitcnt vmcnt(6)
s_barrier
s_waitcnt lgkmcnt(3)
v_mfma_f32_16x16x32_bf16 v[58:61], a[36:39], v[130:133], v[58:61]
ds_read_b128 v[114:117], v249 offset:16384
v_mfma_f32_16x16x32_bf16 v[62:65], a[40:43], v[130:133], v[62:65]
buffer_load_dwordx4 v1, s[4:7], s48 offen offset:2048 sc1 lds
s_add_u32 s58, s58, 64
v_mfma_f32_16x16x32_bf16 v[66:69], v[130:133], a[44:47], v[66:69]
v_add_u32 v168, s58, v250
s_waitcnt lgkmcnt(3)
v_mfma_f32_16x16x32_bf16 v[70:73], a[36:39], v[134:137], v[70:73]
ds_read_b128 v[118:121], v249 offset:20480
v_mfma_f32_16x16x32_bf16 v[74:77], a[40:43], v[134:137], v[74:77]
v_mul_f32 v166, v167, -v166
v_mfma_f32_16x16x32_bf16 v[78:81], v[134:137], a[44:47], v[78:81]
buffer_load_dwordx4 v1, s[4:7], s48 offen offset:3072 sc1 lds
ds_write2_b32 v168, v167, v166 offset0:0 offset1:128
s_waitcnt lgkmcnt(4)
v_mfma_f32_16x16x32_bf16 v[82:85], a[36:39], v[138:141], v[82:85]
ds_read_b128 v[122:125], v249 offset:24576
v_mfma_f32_16x16x32_bf16 v[86:89], a[40:43], v[138:141], v[86:89]
v_mfma_f32_16x16x32_bf16 v[90:93], v[138:141], a[44:47], v[90:93]
s_waitcnt lgkmcnt(4)
v_mfma_f32_16x16x32_bf16 v[94:97], a[36:39], v[142:145], v[94:97]
ds_read_b128 v[126:129], v249 offset:28672
v_mfma_f32_16x16x32_bf16 v[98:101], a[40:43], v[142:145], v[98:101]
buffer_load_dwordx4 v[150:153], v248, s[4:7], s54 offen sc1
v_mfma_f32_16x16x32_bf16 v[102:105], v[142:145], a[44:47], v[102:105]
s_waitcnt lgkmcnt(4)
v_mfma_f32_16x16x32_bf16 v[58:61], a[48:51], v[114:117], v[58:61]
ds_read_b128 v[130:133], v249 offset:17408
v_mfma_f32_16x16x32_bf16 v[62:65], a[52:55], v[114:117], v[62:65]
v_mfma_f32_16x16x32_bf16 v[66:69], v[114:117], a[56:59], v[66:69]
s_add_u32 m0, s74, 49152
s_add_u32 s48, s61, 0x0
buffer_load_dwordx4 v248, s[4:7], s48 offen offset:0 sc1 lds
s_waitcnt lgkmcnt(4)
v_mfma_f32_16x16x32_bf16 v[70:73], a[48:51], v[118:121], v[70:73]
ds_read_b128 v[134:137], v249 offset:21504
v_mfma_f32_16x16x32_bf16 v[74:77], a[52:55], v[118:121], v[74:77]
v_mfma_f32_16x16x32_bf16 v[78:81], v[118:121], a[56:59], v[78:81]
s_waitcnt lgkmcnt(3)
v_mfma_f32_16x16x32_bf16 v[82:85], a[48:51], v[122:125], v[82:85]
ds_read_b128 v[138:141], v249 offset:25600
v_mfma_f32_16x16x32_bf16 v[86:89], a[52:55], v[122:125], v[86:89]
buffer_load_dwordx4 v248, s[4:7], s48 offen offset:1024 sc1 lds
v_mfma_f32_16x16x32_bf16 v[90:93], v[122:125], a[56:59], v[90:93]
s_waitcnt lgkmcnt(3)
v_mfma_f32_16x16x32_bf16 v[94:97], a[48:51], v[126:129], v[94:97]
ds_read_b128 v[142:145], v249 offset:29696
v_mfma_f32_16x16x32_bf16 v[98:101], a[52:55], v[126:129], v[98:101]
v_mfma_f32_16x16x32_bf16 v[102:105], v[126:129], a[56:59], v[102:105]
buffer_load_dwordx4 v248, s[4:7], s48 offen offset:2048 sc1 lds
s_waitcnt lgkmcnt(3)
v_mfma_f32_16x16x32_bf16 v[58:61], a[60:63], v[130:133], v[58:61]
ds_read_b128 v[114:117], v249 offset:18432
v_mfma_f32_16x16x32_bf16 v[62:65], a[64:67], v[130:133], v[62:65]
v_mfma_f32_16x16x32_bf16 v[66:69], v[130:133], a[68:71], v[66:69]
s_waitcnt lgkmcnt(3)
v_mfma_f32_16x16x32_bf16 v[70:73], a[60:63], v[134:137], v[70:73]
ds_read_b128 v[118:121], v249 offset:22528
v_mfma_f32_16x16x32_bf16 v[74:77], a[64:67], v[134:137], v[74:77]
buffer_load_dwordx4 v248, s[4:7], s48 offen offset:3072 sc1 lds
v_mfma_f32_16x16x32_bf16 v[78:81], v[134:137], a[68:71], v[78:81]
s_waitcnt lgkmcnt(3)
v_mfma_f32_16x16x32_bf16 v[82:85], a[60:63], v[138:141], v[82:85]
ds_read_b128 v[122:125], v249 offset:26624
v_mfma_f32_16x16x32_bf16 v[86:89], a[64:67], v[138:141], v[86:89]
s_add_u32 m0, s73, 0
s_add_u32 s48, s75, 0
v_mfma_f32_16x16x32_bf16 v[90:93], v[138:141], a[68:71], v[90:93]
buffer_load_dwordx4 v45, s[8:11], s48 offen lds
s_waitcnt lgkmcnt(3)
v_mfma_f32_16x16x32_bf16 v[94:97], a[60:63], v[142:145], v[94:97]
ds_read_b128 v[126:129], v249 offset:30720
v_mfma_f32_16x16x32_bf16 v[98:101], a[64:67], v[142:145], v[98:101]
v_mfma_f32_16x16x32_bf16 v[102:105], v[142:145], a[68:71], v[102:105]
s_add_u32 m0, s73, 4096
s_add_u32 s48, s75, 32768
s_waitcnt lgkmcnt(3)
v_mfma_f32_16x16x32_bf16 v[58:61], a[72:75], v[114:117], v[58:61]
ds_read_b128 v[130:133], v249 offset:19456
v_mfma_f32_16x16x32_bf16 v[62:65], a[76:79], v[114:117], v[62:65]
buffer_load_dwordx4 v45, s[8:11], s48 offen lds
v_mfma_f32_16x16x32_bf16 v[66:69], v[114:117], a[80:83], v[66:69]
s_waitcnt lgkmcnt(3)
v_mfma_f32_16x16x32_bf16 v[70:73], a[72:75], v[118:121], v[70:73]
ds_read_b128 v[134:137], v249 offset:23552
v_mfma_f32_16x16x32_bf16 v[74:77], a[76:79], v[118:121], v[74:77]
s_add_u32 m0, s73, 8192
s_add_u32 s48, s75, 65536
v_mfma_f32_16x16x32_bf16 v[78:81], v[118:121], a[80:83], v[78:81]
buffer_load_dwordx4 v45, s[8:11], s48 offen lds
s_waitcnt lgkmcnt(3)
v_mfma_f32_16x16x32_bf16 v[82:85], a[72:75], v[122:125], v[82:85]
ds_read_b128 v[138:141], v249 offset:27648
v_mfma_f32_16x16x32_bf16 v[86:89], a[76:79], v[122:125], v[86:89]
v_mfma_f32_16x16x32_bf16 v[90:93], v[122:125], a[80:83], v[90:93]
s_add_u32 m0, s73, 12288
s_add_u32 s48, s75, 98304
s_waitcnt lgkmcnt(3)
v_mfma_f32_16x16x32_bf16 v[94:97], a[72:75], v[126:129], v[94:97]
ds_read_b128 v[142:145], v249 offset:31744
v_mfma_f32_16x16x32_bf16 v[98:101], a[76:79], v[126:129], v[98:101]
buffer_load_dwordx4 v45, s[8:11], s48 offen lds
v_mfma_f32_16x16x32_bf16 v[102:105], v[126:129], a[80:83], v[102:105]
s_waitcnt vmcnt(13)
s_waitcnt vmcnt(4)
v_add_u32 v169, 49152, v1
s_barrier
s_waitcnt lgkmcnt(3)
v_mfma_f32_16x16x32_bf16 v[58:61], a[84:87], v[130:133], v[58:61]
ds_read_b128 v[114:117], v249 offset:32768
v_mfma_f32_16x16x32_bf16 v[62:65], a[88:91], v[130:133], v[62:65]
s_add_u32 m0, s73, 16384
s_add_u32 s48, s75, 131072
v_mfma_f32_16x16x32_bf16 v[66:69], v[130:133], a[92:95], v[66:69]
buffer_load_dwordx4 v45, s[8:11], s48 offen lds
s_waitcnt lgkmcnt(3)
v_mfma_f32_16x16x32_bf16 v[70:73], a[84:87], v[134:137], v[70:73]
ds_read_b128 v[118:121], v249 offset:36864
v_mfma_f32_16x16x32_bf16 v[74:77], a[88:91], v[134:137], v[74:77]
v_mfma_f32_16x16x32_bf16 v[78:81], v[134:137], a[92:95], v[78:81]
s_add_u32 m0, s73, 20480
s_add_u32 s48, s75, 163840
s_waitcnt lgkmcnt(3)
v_mfma_f32_16x16x32_bf16 v[82:85], a[84:87], v[138:141], v[82:85]
ds_read_b128 v[122:125], v249 offset:40960
v_mfma_f32_16x16x32_bf16 v[86:89], a[88:91], v[138:141], v[86:89]
buffer_load_dwordx4 v45, s[8:11], s48 offen lds
v_mfma_f32_16x16x32_bf16 v[90:93], v[138:141], a[92:95], v[90:93]
ds_read_b128 v[230:233], v169 offset:0
s_waitcnt lgkmcnt(4)
v_mfma_f32_16x16x32_bf16 v[94:97], a[84:87], v[142:145], v[94:97]
ds_read_b128 v[126:129], v249 offset:45056
v_mfma_f32_16x16x32_bf16 v[98:101], a[88:91], v[142:145], v[98:101]
s_add_u32 m0, s73, 24576
s_add_u32 s48, s75, 196608
v_mfma_f32_16x16x32_bf16 v[102:105], v[142:145], a[92:95], v[102:105]
buffer_load_dwordx4 v45, s[8:11], s48 offen lds
ds_read_b128 v[234:237], v169 offset:1024
s_waitcnt lgkmcnt(5)
v_mfma_f32_16x16x32_bf16 v[58:61], a[96:99], v[114:117], v[58:61]
ds_read_b128 v[130:133], v249 offset:33792
v_mfma_f32_16x16x32_bf16 v[62:65], a[100:103], v[114:117], v[62:65]
v_add_f32 v150, v150, v152
v_mfma_f32_16x16x32_bf16 v[66:69], v[114:117], a[104:107], v[66:69]
s_add_u32 m0, s73, 28672
s_add_u32 s48, s75, 229376
v_add_f32 v151, v151, v153
s_waitcnt lgkmcnt(3)
v_mfma_f32_16x16x32_bf16 v[106:109], a[4:7], v[230:233], 0
v_mfma_f32_16x16x32_bf16 v[110:113], v[230:233], a[8:11], 0
ds_read_b128 v[230:233], v169 offset:2048
v_mfma_f32_16x16x32_bf16 v[70:73], a[96:99], v[118:121], v[70:73]
ds_read_b128 v[134:137], v249 offset:37888
v_mfma_f32_16x16x32_bf16 v[74:77], a[100:103], v[118:121], v[74:77]
buffer_load_dwordx4 v45, s[8:11], s48 offen lds
v_permlane32_swap_b32 v150, v151
v_mfma_f32_16x16x32_bf16 v[78:81], v[118:121], a[104:107], v[78:81]
v_add_f32 v150, v150, v151
v_mfma_f32_16x16x32_bf16 v[82:85], a[96:99], v[122:125], v[82:85]
ds_read_b128 v[138:141], v249 offset:41984
v_mfma_f32_16x16x32_bf16 v[86:89], a[100:103], v[122:125], v[86:89]
s_add_u32 m0, s73, 32768
s_add_u32 s48, s75, 262144
v_mov_b32 v151, v150
v_mfma_f32_16x16x32_bf16 v[90:93], v[122:125], a[104:107], v[90:93]
buffer_load_dwordx4 v45, s[8:11], s48 offen lds
v_permlane16_swap_b32 v150, v151
s_waitcnt lgkmcnt(4)
v_mfma_f32_16x16x32_bf16 v[106:109], a[16:19], v[234:237], v[106:109]
v_mfma_f32_16x16x32_bf16 v[110:113], v[234:237], a[20:23], v[110:113]
ds_read_b128 v[234:237], v169 offset:3072
v_mfma_f32_16x16x32_bf16 v[94:97], a[96:99], v[126:129], v[94:97]
ds_read_b128 v[142:145], v249 offset:46080
v_mfma_f32_16x16x32_bf16 v[98:101], a[100:103], v[126:129], v[98:101]
s_add_u32 m0, s73, 36864
s_add_u32 s48, s75, 294912
v_add_f32 v150, v150, v151
v_mfma_f32_16x16x32_bf16 v[102:105], v[126:129], a[104:107], v[102:105]
buffer_load_dwordx4 v45, s[8:11], s48 offen lds
v_mov_b32 v151, v150
s_waitcnt lgkmcnt(5)
v_mfma_f32_16x16x32_bf16 v[58:61], a[108:111], v[130:133], v[58:61]
ds_read_b128 v[114:117], v249 offset:34816
v_mfma_f32_16x16x32_bf16 v[62:65], a[112:115], v[130:133], v[62:65]
v_permlane32_swap_b32 v150, v151
v_mfma_f32_16x16x32_bf16 v[66:69], v[130:133], a[116:119], v[66:69]
s_add_u32 m0, s73, 40960
s_add_u32 s48, s75, 327680
v_mul_f32 v166, 0x3b000000, v150
s_waitcnt lgkmcnt(5)
v_mfma_f32_16x16x32_bf16 v[106:109], a[28:31], v[230:233], v[106:109]
v_mfma_f32_16x16x32_bf16 v[110:113], v[230:233], a[32:35], v[110:113]
ds_read_b128 v[230:233], v169 offset:4096
s_waitcnt lgkmcnt(5)
v_mfma_f32_16x16x32_bf16 v[70:73], a[108:111], v[134:137], v[70:73]
ds_read_b128 v[118:121], v249 offset:38912
v_mfma_f32_16x16x32_bf16 v[74:77], a[112:115], v[134:137], v[74:77]
buffer_load_dwordx4 v45, s[8:11], s48 offen lds
v_mul_f32 v151, 0x3b000000, v151
v_mfma_f32_16x16x32_bf16 v[78:81], v[134:137], a[116:119], v[78:81]
v_fma_f32 v167, -v166, v166, v151
s_waitcnt lgkmcnt(5)
v_mfma_f32_16x16x32_bf16 v[82:85], a[108:111], v[138:141], v[82:85]
ds_read_b128 v[122:125], v249 offset:43008
v_mfma_f32_16x16x32_bf16 v[86:89], a[112:115], v[138:141], v[86:89]
s_add_u32 m0, s73, 45056
s_add_u32 s48, s75, 360448
v_max_f32 v167, 0, v167
v_mfma_f32_16x16x32_bf16 v[90:93], v[138:141], a[116:119], v[90:93]
buffer_load_dwordx4 v45, s[8:11], s48 offen lds
v_add_f32 v167, 0x3727c5ac, v167
s_waitcnt lgkmcnt(5)
v_mfma_f32_16x16x32_bf16 v[106:109], a[40:43], v[234:237], v[106:109]
v_mfma_f32_16x16x32_bf16 v[110:113], v[234:237], a[44:47], v[110:113]
ds_read_b128 v[234:237], v169 offset:5120
s_waitcnt lgkmcnt(5)
v_mfma_f32_16x16x32_bf16 v[94:97], a[108:111], v[142:145], v[94:97]
ds_read_b128 v[126:129], v249 offset:47104
v_mfma_f32_16x16x32_bf16 v[98:101], a[112:115], v[142:145], v[98:101]
s_getpc_b64 s[76:77]
PC_108:
s_add_u32 s76, s76, PH11-PC_108
s_addc_u32 s77, s77, 0
v_min_u32 v11, PH13-PH11-4, v56
s_mov_b64 exec, 3
global_load_dword v54, v11, s[76:77]
s_mov_b64 exec, -1
v_rsq_f32 v167, v167
v_mfma_f32_16x16x32_bf16 v[102:105], v[142:145], a[116:119], v[102:105]
v_mul_f32 v166, v167, -v166
s_waitcnt lgkmcnt(5)
v_mfma_f32_16x16x32_bf16 v[58:61], a[120:123], v[114:117], v[58:61]
ds_read_b128 v[130:133], v249 offset:35840
v_mfma_f32_16x16x32_bf16 v[62:65], a[124:127], v[114:117], v[62:65]
s_add_u32 m0, s73, 65536
s_add_u32 s48, s75, 0
ds_write2_b32 v250, v167, v166 offset0:0 offset1:128
v_mfma_f32_16x16x32_bf16 v[66:69], v[114:117], a[128:131], v[66:69]
buffer_load_dwordx4 v45, s[12:15], s48 offen lds
s_waitcnt lgkmcnt(6)
v_mfma_f32_16x16x32_bf16 v[106:109], a[52:55], v[230:233], v[106:109]
v_mfma_f32_16x16x32_bf16 v[110:113], v[230:233], a[56:59], v[110:113]
ds_read_b128 v[230:233], v169 offset:6144
s_waitcnt lgkmcnt(6)
v_mfma_f32_16x16x32_bf16 v[70:73], a[120:123], v[118:121], v[70:73]
ds_read_b128 v[134:137], v249 offset:39936
v_mfma_f32_16x16x32_bf16 v[74:77], a[124:127], v[118:121], v[74:77]
s_add_u32 m0, s73, 69632
s_add_u32 s48, s75, 32768
v_mfma_f32_16x16x32_bf16 v[78:81], v[118:121], a[128:131], v[78:81]
buffer_load_dwordx4 v45, s[12:15], s48 offen lds
s_waitcnt lgkmcnt(6)
v_mfma_f32_16x16x32_bf16 v[82:85], a[120:123], v[122:125], v[82:85]
ds_read_b128 v[138:141], v249 offset:44032
v_mfma_f32_16x16x32_bf16 v[86:89], a[124:127], v[122:125], v[86:89]
v_mfma_f32_16x16x32_bf16 v[90:93], v[122:125], a[128:131], v[90:93]
s_add_u32 m0, s73, 73728
s_add_u32 s48, s75, 65536
s_waitcnt lgkmcnt(6)
v_mfma_f32_16x16x32_bf16 v[106:109], a[64:67], v[234:237], v[106:109]
v_mfma_f32_16x16x32_bf16 v[110:113], v[234:237], a[68:71], v[110:113]
ds_read_b128 v[234:237], v169 offset:7168
s_waitcnt lgkmcnt(6)
v_mfma_f32_16x16x32_bf16 v[94:97], a[120:123], v[126:129], v[94:97]
ds_read_b128 v[142:145], v249 offset:48128
v_mfma_f32_16x16x32_bf16 v[98:101], a[124:127], v[126:129], v[98:101]
buffer_load_dwordx4 v45, s[12:15], s48 offen lds
v_mfma_f32_16x16x32_bf16 v[102:105], v[126:129], a[128:131], v[102:105]
s_barrier
s_waitcnt lgkmcnt(6)
v_mfma_f32_16x16x32_bf16 v[58:61], a[132:135], v[130:133], v[58:61]
ds_read_b128 v[114:117], v249 offset:49152
v_mfma_f32_16x16x32_bf16 v[62:65], a[136:139], v[130:133], v[62:65]
s_add_u32 m0, s73, 77824
s_add_u32 s48, s75, 98304
v_mfma_f32_16x16x32_bf16 v[66:69], v[130:133], a[140:143], v[66:69]
buffer_load_dwordx4 v45, s[12:15], s48 offen lds
s_waitcnt lgkmcnt(5)
v_mfma_f32_16x16x32_bf16 v[106:109], a[76:79], v[230:233], v[106:109]
v_mfma_f32_16x16x32_bf16 v[110:113], v[230:233], a[80:83], v[110:113]
ds_read_b128 v[230:233], v169 offset:8192
s_waitcnt lgkmcnt(5)
v_mfma_f32_16x16x32_bf16 v[70:73], a[132:135], v[134:137], v[70:73]
ds_read_b128 v[118:121], v249 offset:53248
v_mfma_f32_16x16x32_bf16 v[74:77], a[136:139], v[134:137], v[74:77]
s_add_u32 m0, s73, 81920
s_add_u32 s48, s75, 131072
v_mfma_f32_16x16x32_bf16 v[78:81], v[134:137], a[140:143], v[78:81]
buffer_load_dwordx4 v45, s[12:15], s48 offen lds
s_waitcnt lgkmcnt(5)
v_mfma_f32_16x16x32_bf16 v[82:85], a[132:135], v[138:141], v[82:85]
ds_read_b128 v[122:125], v249 offset:57344
v_mfma_f32_16x16x32_bf16 v[86:89], a[136:139], v[138:141], v[86:89]
v_mfma_f32_16x16x32_bf16 v[90:93], v[138:141], a[140:143], v[90:93]
s_add_u32 m0, s73, 86016
s_add_u32 s48, s75, 163840
s_waitcnt lgkmcnt(5)
v_mfma_f32_16x16x32_bf16 v[106:109], a[88:91], v[234:237], v[106:109]
v_mfma_f32_16x16x32_bf16 v[110:113], v[234:237], a[92:95], v[110:113]
ds_read_b128 v[234:237], v169 offset:9216
s_waitcnt lgkmcnt(5)
v_mfma_f32_16x16x32_bf16 v[94:97], a[132:135], v[142:145], v[94:97]
ds_read_b128 v[126:129], v249 offset:61440
v_mfma_f32_16x16x32_bf16 v[98:101], a[136:139], v[142:145], v[98:101]
buffer_load_dwordx4 v45, s[12:15], s48 offen lds
v_mfma_f32_16x16x32_bf16 v[102:105], v[142:145], a[140:143], v[102:105]
s_waitcnt lgkmcnt(5)
v_mfma_f32_16x16x32_bf16 v[58:61], a[144:147], v[114:117], v[58:61]
ds_read_b128 v[130:133], v249 offset:50176
v_mfma_f32_16x16x32_bf16 v[62:65], a[148:151], v[114:117], v[62:65]
s_add_u32 m0, s73, 90112
s_add_u32 s48, s75, 196608
v_mfma_f32_16x16x32_bf16 v[66:69], v[114:117], a[152:155], v[66:69]
buffer_load_dwordx4 v45, s[12:15], s48 offen lds
s_waitcnt lgkmcnt(5)
v_mfma_f32_16x16x32_bf16 v[106:109], a[100:103], v[230:233], v[106:109]
v_mfma_f32_16x16x32_bf16 v[110:113], v[230:233], a[104:107], v[110:113]
ds_read_b128 v[230:233], v169 offset:10240
s_waitcnt lgkmcnt(5)
v_mfma_f32_16x16x32_bf16 v[70:73], a[144:147], v[118:121], v[70:73]
ds_read_b128 v[134:137], v249 offset:54272
v_mfma_f32_16x16x32_bf16 v[74:77], a[148:151], v[118:121], v[74:77]
s_add_u32 m0, s73, 94208
s_add_u32 s48, s75, 229376
v_mfma_f32_16x16x32_bf16 v[78:81], v[118:121], a[152:155], v[78:81]
buffer_load_dwordx4 v45, s[12:15], s48 offen lds
s_waitcnt lgkmcnt(5)
v_mfma_f32_16x16x32_bf16 v[82:85], a[144:147], v[122:125], v[82:85]
ds_read_b128 v[138:141], v249 offset:58368
v_mfma_f32_16x16x32_bf16 v[86:89], a[148:151], v[122:125], v[86:89]
v_mfma_f32_16x16x32_bf16 v[90:93], v[122:125], a[152:155], v[90:93]
s_waitcnt lgkmcnt(5)
v_mfma_f32_16x16x32_bf16 v[106:109], a[112:115], v[234:237], v[106:109]
v_mfma_f32_16x16x32_bf16 v[110:113], v[234:237], a[116:119], v[110:113]
ds_read_b128 v[234:237], v169 offset:11264
s_waitcnt lgkmcnt(5)
v_mfma_f32_16x16x32_bf16 v[94:97], a[144:147], v[126:129], v[94:97]
ds_read_b128 v[142:145], v249 offset:62464
v_mfma_f32_16x16x32_bf16 v[98:101], a[148:151], v[126:129], v[98:101]
v_mfma_f32_16x16x32_bf16 v[102:105], v[126:129], a[152:155], v[102:105]
s_waitcnt lgkmcnt(5)
v_mfma_f32_16x16x32_bf16 v[58:61], a[156:159], v[130:133], v[58:61]
ds_read_b128 v[114:117], v249 offset:51200
v_mfma_f32_16x16x32_bf16 v[62:65], a[160:163], v[130:133], v[62:65]
v_mfma_f32_16x16x32_bf16 v[66:69], v[130:133], a[164:167], v[66:69]
s_waitcnt lgkmcnt(5)
v_mfma_f32_16x16x32_bf16 v[106:109], a[124:127], v[230:233], v[106:109]
v_mfma_f32_16x16x32_bf16 v[110:113], v[230:233], a[128:131], v[110:113]
ds_read_b128 v[230:233], v169 offset:12288
s_waitcnt lgkmcnt(5)
v_mfma_f32_16x16x32_bf16 v[70:73], a[156:159], v[134:137], v[70:73]
ds_read_b128 v[118:121], v249 offset:55296
v_mfma_f32_16x16x32_bf16 v[74:77], a[160:163], v[134:137], v[74:77]
v_mfma_f32_16x16x32_bf16 v[78:81], v[134:137], a[164:167], v[78:81]
s_waitcnt lgkmcnt(5)
v_mfma_f32_16x16x32_bf16 v[82:85], a[156:159], v[138:141], v[82:85]
ds_read_b128 v[122:125], v249 offset:59392
v_mfma_f32_16x16x32_bf16 v[86:89], a[160:163], v[138:141], v[86:89]
v_mfma_f32_16x16x32_bf16 v[90:93], v[138:141], a[164:167], v[90:93]
s_waitcnt lgkmcnt(5)
v_mfma_f32_16x16x32_bf16 v[106:109], a[136:139], v[234:237], v[106:109]
v_mfma_f32_16x16x32_bf16 v[110:113], v[234:237], a[140:143], v[110:113]
ds_read_b128 v[234:237], v169 offset:13312
s_waitcnt lgkmcnt(5)
v_mfma_f32_16x16x32_bf16 v[94:97], a[156:159], v[142:145], v[94:97]
ds_read_b128 v[126:129], v249 offset:63488
v_mfma_f32_16x16x32_bf16 v[98:101], a[160:163], v[142:145], v[98:101]
v_mfma_f32_16x16x32_bf16 v[102:105], v[142:145], a[164:167], v[102:105]
s_waitcnt lgkmcnt(5)
v_mfma_f32_16x16x32_bf16 v[58:61], a[168:171], v[114:117], v[58:61]
ds_read_b128 v[130:133], v249 offset:52224
v_mfma_f32_16x16x32_bf16 v[62:65], a[172:175], v[114:117], v[62:65]
v_mfma_f32_16x16x32_bf16 v[66:69], v[114:117], a[176:179], v[66:69]
s_waitcnt lgkmcnt(5)
v_mfma_f32_16x16x32_bf16 v[106:109], a[148:151], v[230:233], v[106:109]
v_mfma_f32_16x16x32_bf16 v[110:113], v[230:233], a[152:155], v[110:113]
ds_read_b128 v[230:233], v169 offset:14336
s_waitcnt lgkmcnt(5)
v_mfma_f32_16x16x32_bf16 v[70:73], a[168:171], v[118:121], v[70:73]
ds_read_b128 v[134:137], v249 offset:56320
v_mfma_f32_16x16x32_bf16 v[74:77], a[172:175], v[118:121], v[74:77]
v_mfma_f32_16x16x32_bf16 v[78:81], v[118:121], a[176:179], v[78:81]
s_waitcnt lgkmcnt(5)
v_mfma_f32_16x16x32_bf16 v[82:85], a[168:171], v[122:125], v[82:85]
ds_read_b128 v[138:141], v249 offset:60416
v_mfma_f32_16x16x32_bf16 v[86:89], a[172:175], v[122:125], v[86:89]
v_mfma_f32_16x16x32_bf16 v[90:93], v[122:125], a[176:179], v[90:93]
s_waitcnt lgkmcnt(5)
v_mfma_f32_16x16x32_bf16 v[106:109], a[160:163], v[234:237], v[106:109]
v_mfma_f32_16x16x32_bf16 v[110:113], v[234:237], a[164:167], v[110:113]
ds_read_b128 v[234:237], v169 offset:15360
s_waitcnt lgkmcnt(5)
v_mfma_f32_16x16x32_bf16 v[94:97], a[168:171], v[126:129], v[94:97]
ds_read_b128 v[142:145], v249 offset:64512
v_mfma_f32_16x16x32_bf16 v[98:101], a[172:175], v[126:129], v[98:101]
v_mfma_f32_16x16x32_bf16 v[102:105], v[126:129], a[176:179], v[102:105]
s_barrier
s_waitcnt lgkmcnt(5)
v_mfma_f32_16x16x32_bf16 v[58:61], a[180:183], v[130:133], v[58:61]
s_add_u32 m0, s73, 98304
s_add_u32 s48, s75, 262144
ds_read2_b32 v[238:239], v250 offset0:0 offset1:128
ds_read_b128 v[190:193], v251 offset:0
ds_read_b128 v[194:197], v251 offset:512
v_mfma_f32_16x16x32_bf16 v[62:65], a[184:187], v[130:133], v[62:65]
buffer_load_dwordx4 v45, s[12:15], s48 offen lds
ds_read2_b32 v[240:241], v250 offset0:16 offset1:144
ds_read_b128 v[198:201], v251 offset:64
ds_read_b128 v[202:205], v251 offset:576
v_mfma_f32_16x16x32_bf16 v[66:69], v[130:133], a[188:191], v[66:69]
ds_read2_b32 v[242:243], v250 offset0:32 offset1:160
ds_read_b128 v[206:209], v251 offset:128
ds_read_b128 v[210:213], v251 offset:640
s_waitcnt lgkmcnt(13)
v_mfma_f32_16x16x32_bf16 v[106:109], a[172:175], v[230:233], v[106:109]
v_mfma_f32_16x16x32_bf16 v[110:113], v[230:233], a[176:179], v[110:113]
s_waitcnt lgkmcnt(12)
v_mfma_f32_16x16x32_bf16 v[70:73], a[180:183], v[134:137], v[70:73]
s_add_u32 m0, s73, 102400
s_add_u32 s48, s75, 294912
ds_read2_b32 v[244:245], v250 offset0:48 offset1:176
ds_read_b128 v[214:217], v251 offset:192
ds_read_b128 v[218:221], v251 offset:704
v_mfma_f32_16x16x32_bf16 v[74:77], a[184:187], v[134:137], v[74:77]
buffer_load_dwordx4 v45, s[12:15], s48 offen lds
ds_read2_b32 v[246:247], v250 offset0:64 offset1:192
ds_read_b128 v[222:225], v251 offset:256
ds_read_b128 v[226:229], v251 offset:768
v_mfma_f32_16x16x32_bf16 v[78:81], v[134:137], a[188:191], v[78:81]
s_lshl_b32 s58, s34, 6
v_add_u32 v166, s58, v251
v_add_u32 v167, s58, v250
s_waitcnt lgkmcnt(15)
v_mfma_f32_16x16x32_bf16 v[82:85], a[180:183], v[138:141], v[82:85]
s_add_u32 m0, s73, 106496
s_add_u32 s48, s75, 327680
ds_read_b128 v[154:157], v166 offset:1024
ds_read_b128 v[158:161], v166 offset:1280
ds_read_b32 v162, v167 offset:1536
v_mfma_f32_16x16x32_bf16 v[86:89], a[184:187], v[138:141], v[86:89]
buffer_load_dwordx4 v45, s[12:15], s48 offen lds
v_mfma_f32_16x16x32_bf16 v[90:93], v[138:141], a[188:191], v[90:93]
s_waitcnt lgkmcnt(15)
v_mfma_f32_16x16x32_bf16 v[106:109], a[184:187], v[234:237], v[106:109]
v_mfma_f32_16x16x32_bf16 v[110:113], v[234:237], a[188:191], v[110:113]
s_waitcnt lgkmcnt(15)
v_mfma_f32_16x16x32_bf16 v[94:97], a[180:183], v[142:145], v[94:97]
s_add_u32 m0, s73, 110592
s_add_u32 s48, s75, 360448
v_mfma_f32_16x16x32_bf16 v[98:101], a[184:187], v[142:145], v[98:101]
buffer_load_dwordx4 v45, s[12:15], s48 offen lds
v_mfma_f32_16x16x32_bf16 v[102:105], v[142:145], a[188:191], v[102:105]
s_waitcnt vmcnt(13)
s_waitcnt lgkmcnt(0)
s_barrier
v_pk_mul_f32 v[230:231], v[158:159], v[240:241] op_sel:[0,1]
v_pk_mul_f32 v[232:233], v[160:161], v[240:241] op_sel:[0,1]
v_pk_fma_f32 v[230:231], v[62:63], v[240:241], v[230:231] op_sel_hi:[1,0,1]
v_pk_fma_f32 v[232:233], v[64:65], v[240:241], v[232:233] op_sel_hi:[1,0,1]
v_cvt_pk_bf16_f32 v126, v230, v231
s_add_u32 m0, s73, 49152
s_add_u32 s48, s75, 393216
v_cvt_pk_bf16_f32 v127, v232, v233
v_pk_mul_f32 v[230:231], v[154:155], v[240:241] op_sel:[0,1]
v_pk_mul_f32 v[232:233], v[156:157], v[240:241] op_sel:[0,1]
buffer_load_dwordx4 v45, s[8:11], s48 offen lds
v_pk_fma_f32 v[230:231], v[58:59], v[240:241], v[230:231] op_sel_hi:[1,0,1]
v_pk_fma_f32 v[232:233], v[60:61], v[240:241], v[232:233] op_sel_hi:[1,0,1]
v_cvt_pk_bf16_f32 v134, v230, v231
v_cvt_pk_bf16_f32 v135, v232, v233
v_pk_mul_f32 v[234:235], v[202:203], v[162:163] op_sel_hi:[1,0]
v_pk_mul_f32 v[236:237], v[204:205], v[162:163] op_sel_hi:[1,0]
v_pk_fma_f32 v[234:235], v[66:67], v[198:199], v[234:235]
v_pk_fma_f32 v[236:237], v[68:69], v[200:201], v[236:237]
s_add_u32 m0, s73, 53248
s_add_u32 s48, s75, 425984
v_cvt_pk_bf16_f32 v116, v234, v235
v_cvt_pk_bf16_f32 v117, v236, v237
v_pk_mul_f32 v[230:231], v[158:159], v[242:243] op_sel:[0,1]
v_pk_mul_f32 v[232:233], v[160:161], v[242:243] op_sel:[0,1]
buffer_load_dwordx4 v45, s[8:11], s48 offen lds
v_pk_fma_f32 v[230:231], v[74:75], v[242:243], v[230:231] op_sel_hi:[1,0,1]
v_pk_fma_f32 v[232:233], v[76:77], v[242:243], v[232:233] op_sel_hi:[1,0,1]
v_cvt_pk_bf16_f32 v128, v230, v231
v_cvt_pk_bf16_f32 v129, v232, v233
v_pk_mul_f32 v[230:231], v[154:155], v[242:243] op_sel:[0,1]
v_pk_mul_f32 v[232:233], v[156:157], v[242:243] op_sel:[0,1]
v_pk_fma_f32 v[230:231], v[70:71], v[242:243], v[230:231] op_sel_hi:[1,0,1]
v_pk_fma_f32 v[232:233], v[72:73], v[242:243], v[232:233] op_sel_hi:[1,0,1]
s_add_u32 m0, s73, 57344
s_add_u32 s48, s75, 458752
v_cvt_pk_bf16_f32 v136, v230, v231
v_cvt_pk_bf16_f32 v137, v232, v233
v_pk_mul_f32 v[234:235], v[210:211], v[162:163] op_sel_hi:[1,0]
v_pk_mul_f32 v[236:237], v[212:213], v[162:163] op_sel_hi:[1,0]
buffer_load_dwordx4 v45, s[8:11], s48 offen lds
v_pk_fma_f32 v[234:235], v[78:79], v[206:207], v[234:235]
v_pk_fma_f32 v[236:237], v[80:81], v[208:209], v[236:237]
v_cvt_pk_bf16_f32 v118, v234, v235
v_cvt_pk_bf16_f32 v119, v236, v237
v_pk_mul_f32 v[230:231], v[158:159], v[244:245] op_sel:[0,1]
v_pk_mul_f32 v[232:233], v[160:161], v[244:245] op_sel:[0,1]
v_pk_fma_f32 v[230:231], v[86:87], v[244:245], v[230:231] op_sel_hi:[1,0,1]
v_pk_fma_f32 v[232:233], v[88:89], v[244:245], v[232:233] op_sel_hi:[1,0,1]
s_add_u32 m0, s73, 61440
s_add_u32 s48, s75, 491520
v_cvt_pk_bf16_f32 v130, v230, v231
v_cvt_pk_bf16_f32 v131, v232, v233
v_pk_mul_f32 v[230:231], v[154:155], v[244:245] op_sel:[0,1]
v_pk_mul_f32 v[232:233], v[156:157], v[244:245] op_sel:[0,1]
buffer_load_dwordx4 v45, s[8:11], s48 offen lds
v_pk_fma_f32 v[230:231], v[82:83], v[244:245], v[230:231] op_sel_hi:[1,0,1]
v_pk_fma_f32 v[232:233], v[84:85], v[244:245], v[232:233] op_sel_hi:[1,0,1]
v_cvt_pk_bf16_f32 v138, v230, v231
v_cvt_pk_bf16_f32 v139, v232, v233
v_pk_mul_f32 v[234:235], v[218:219], v[162:163] op_sel_hi:[1,0]
v_pk_mul_f32 v[236:237], v[220:221], v[162:163] op_sel_hi:[1,0]
v_pk_fma_f32 v[234:235], v[90:91], v[214:215], v[234:235]
v_pk_fma_f32 v[236:237], v[92:93], v[216:217], v[236:237]
s_add_u32 m0, s73, 114688
s_add_u32 s48, s75, 393216
v_cvt_pk_bf16_f32 v120, v234, v235
v_cvt_pk_bf16_f32 v121, v236, v237
v_pk_mul_f32 v[230:231], v[158:159], v[246:247] op_sel:[0,1]
v_pk_mul_f32 v[232:233], v[160:161], v[246:247] op_sel:[0,1]
buffer_load_dwordx4 v45, s[12:15], s48 offen lds
v_pk_fma_f32 v[230:231], v[98:99], v[246:247], v[230:231] op_sel_hi:[1,0,1]
v_pk_fma_f32 v[232:233], v[100:101], v[246:247], v[232:233] op_sel_hi:[1,0,1]
v_cvt_pk_bf16_f32 v132, v230, v231
v_cvt_pk_bf16_f32 v133, v232, v233
v_pk_mul_f32 v[230:231], v[154:155], v[246:247] op_sel:[0,1]
v_pk_mul_f32 v[232:233], v[156:157], v[246:247] op_sel:[0,1]
v_pk_fma_f32 v[230:231], v[94:95], v[246:247], v[230:231] op_sel_hi:[1,0,1]
v_pk_fma_f32 v[232:233], v[96:97], v[246:247], v[232:233] op_sel_hi:[1,0,1]
s_add_u32 m0, s73, 118784
s_add_u32 s48, s75, 425984
v_cvt_pk_bf16_f32 v140, v230, v231
v_cvt_pk_bf16_f32 v141, v232, v233
v_pk_mul_f32 v[234:235], v[226:227], v[162:163] op_sel_hi:[1,0]
v_pk_mul_f32 v[236:237], v[228:229], v[162:163] op_sel_hi:[1,0]
buffer_load_dwordx4 v45, s[12:15], s48 offen lds
v_pk_fma_f32 v[234:235], v[102:103], v[222:223], v[234:235]
v_pk_fma_f32 v[236:237], v[104:105], v[224:225], v[236:237]
v_cvt_pk_bf16_f32 v122, v234, v235
v_cvt_pk_bf16_f32 v123, v236, v237
v_pk_mul_f32 v[230:231], v[158:159], v[238:239] op_sel:[0,1]
v_pk_mul_f32 v[232:233], v[160:161], v[238:239] op_sel:[0,1]
v_pk_fma_f32 v[230:231], v[106:107], v[238:239], v[230:231] op_sel_hi:[1,0,1]
v_pk_fma_f32 v[232:233], v[108:109], v[238:239], v[232:233] op_sel_hi:[1,0,1]
s_add_u32 m0, s73, 122880
s_add_u32 s48, s75, 458752
v_cvt_pk_bf16_f32 v124, v230, v231
v_cvt_pk_bf16_f32 v125, v232, v233
v_pk_mul_f32 v[234:235], v[194:195], v[162:163] op_sel_hi:[1,0]
v_pk_mul_f32 v[236:237], v[196:197], v[162:163] op_sel_hi:[1,0]
buffer_load_dwordx4 v45, s[12:15], s48 offen lds
v_pk_fma_f32 v[234:235], v[110:111], v[190:191], v[234:235]
v_pk_fma_f32 v[236:237], v[112:113], v[192:193], v[236:237]
v_cvt_pk_bf16_f32 v114, v234, v235
v_cvt_pk_bf16_f32 v115, v236, v237
v_mfma_f32_16x16x16_bf16 v[58:61], v[124:125], v[134:135], v[178:181]
v_mfma_f32_16x16x16_bf16 v[62:65], v[126:127], v[134:135], v[170:173]
s_add_u32 m0, s73, 126976
s_add_u32 s48, s75, 491520
v_mfma_f32_16x16x16_bf16 v[66:69], v[126:127], v[136:137], v[174:177]
buffer_load_dwordx4 v45, s[12:15], s48 offen lds
v_mfma_f32_16x16x16_bf16 v[70:73], v[128:129], v[136:137], v[170:173]
v_mfma_f32_16x16x16_bf16 v[74:77], v[128:129], v[138:139], v[174:177]
v_mfma_f32_16x16x16_bf16 v[78:81], v[130:131], v[138:139], v[170:173]
v_mfma_f32_16x16x16_bf16 v[82:85], v[130:131], v[140:141], v[174:177]
s_add_u32 s60, s47, 0
buffer_load_dwordx4 a[224:227], v50, s[4:7], s60 offen offset:0
v_mfma_f32_16x16x16_bf16 v[86:89], v[132:133], v[140:141], v[170:173]
v_max3_f32 v190, v58, v59, v62
v_max3_f32 v191, v60, v61, v64
v_max_f32 v190, v190, v63
v_max_f32 v191, v191, v65
v_max_f32 v198, v190, v191
v_max3_f32 v192, v66, v67, v70
v_max3_f32 v193, v68, v69, v72
v_max_f32 v192, v192, v71
v_max_f32 v193, v193, v73
v_max_f32 v199, v192, v193
v_max3_f32 v194, v74, v75, v78
buffer_load_dwordx4 a[228:231], v50, s[4:7], s60 offen offset:1024
v_max3_f32 v195, v76, v77, v80
v_max_f32 v194, v194, v79
v_max_f32 v195, v195, v81
v_max_f32 v200, v194, v195
v_max3_f32 v196, v82, v83, v86
v_max3_f32 v197, v84, v85, v88
v_max_f32 v196, v196, v87
v_max_f32 v197, v197, v89
v_max_f32 v201, v196, v197
v_permlane32_swap_b32 v198, v199
s_nop 0
v_permlane32_swap_b32 v200, v201
buffer_load_dwordx4 a[232:235], v50, s[4:7], s60 offen offset:2048
v_max_f32 v198, v198, v199
v_max_f32 v200, v200, v201
s_nop 1
v_permlane16_swap_b32 v198, v200
v_max_f32 v198, v198, v200
v_mul_f32 v198, s56, -v198
v_mov_b32 v200, v198
s_nop 1
v_permlane16_swap_b32 v198, v200
v_mov_b32 v199, v198
v_mov_b32 v201, v200
s_nop 0
v_permlane32_swap_b32 v198, v199
buffer_load_dwordx4 a[236:239], v50, s[4:7], s60 offen offset:3072
v_permlane32_swap_b32 v200, v201
v_pk_fma_f32 v[190:191], v[190:191], s[56:57], v[198:199] op_sel_hi:[1,1,0]
v_pk_fma_f32 v[192:193], v[192:193], s[56:57], v[198:199] op_sel:[0,0,1]
v_pk_fma_f32 v[194:195], v[194:195], s[56:57], v[200:201] op_sel_hi:[1,1,0]
v_pk_fma_f32 v[196:197], v[196:197], s[56:57], v[200:201] op_sel:[0,0,1]
v_exp_f32 v190, v190
v_exp_f32 v191, v191
v_exp_f32 v192, v192
v_exp_f32 v193, v193
v_exp_f32 v194, v194
v_exp_f32 v195, v195
v_exp_f32 v196, v196
v_exp_f32 v197, v197
v_cvt_pk_bf16_f32 v190, v190, v190
v_cvt_pk_bf16_f32 v191, v191, v191
v_cvt_pk_bf16_f32 v192, v192, v192
v_cvt_pk_bf16_f32 v193, v193, v193
v_cvt_pk_bf16_f32 v194, v194, v194
v_cvt_pk_bf16_f32 v195, v195, v195
v_cvt_pk_bf16_f32 v196, v196, v196
v_cvt_pk_bf16_f32 v197, v197, v197
v_and_b32 v206, v182, v190
v_and_b32 v207, v183, v191
v_and_b32 v208, v184, v190
v_and_b32 v209, v185, v191
v_and_b32 v210, v182, v192
v_and_b32 v211, v183, v193
v_and_b32 v212, v184, v192
v_and_b32 v213, v185, v193
v_and_b32 v214, v182, v194
v_and_b32 v215, v183, v195
v_and_b32 v216, v184, v194
v_and_b32 v217, v185, v195
v_and_b32 v218, v182, v196
v_and_b32 v219, v183, v197
v_and_b32 v220, v184, v196
v_and_b32 v221, v185, v197
v_mfma_f32_16x16x32_bf16 v[74:77], v[186:189], v[206:209], 0
v_mfma_f32_16x16x32_bf16 v[58:61], v[114:117], v[206:209], 0
v_mfma_f32_16x16x32_bf16 v[78:81], v[186:189], v[210:213], 0
v_mfma_f32_16x16x32_bf16 v[62:65], v[116:119], v[210:213], 0
v_mfma_f32_16x16x32_bf16 v[82:85], v[186:189], v[214:217], 0
v_mfma_f32_16x16x32_bf16 v[66:69], v[118:121], v[214:217], 0
v_mfma_f32_16x16x32_bf16 v[86:89], v[186:189], v[218:221], 0
v_mfma_f32_16x16x32_bf16 v[70:73], v[120:123], v[218:221], 0
s_lshl_b32 s58, s32, 16
s_add_u32 s58, s58, s52
s_lshr_b32 s59, s34, 1
s_lshl_b32 s59, s59, 10
s_add_u32 s58, s58, s59
s_add_u32 s61, s58, 0x800000
s_add_u32 s94, s61, 0x8000
v_rcp_f32 v74, v74
v_rcp_f32 v78, v78
v_rcp_f32 v82, v82
v_rcp_f32 v86, v86
v_pk_mul_f32 v[58:59], v[58:59], v[74:75] op_sel_hi:[1,0]
v_pk_mul_f32 v[60:61], v[60:61], v[74:75] op_sel_hi:[1,0]
v_pk_mul_f32 v[62:63], v[62:63], v[78:79] op_sel_hi:[1,0]
v_pk_mul_f32 v[64:65], v[64:65], v[78:79] op_sel_hi:[1,0]
v_pk_mul_f32 v[66:67], v[66:67], v[82:83] op_sel_hi:[1,0]
v_pk_mul_f32 v[68:69], v[68:69], v[82:83] op_sel_hi:[1,0]
v_pk_mul_f32 v[70:71], v[70:71], v[86:87] op_sel_hi:[1,0]
v_pk_mul_f32 v[72:73], v[72:73], v[86:87] op_sel_hi:[1,0]
v_cvt_pk_bf16_f32 v190, v58, v59
v_cvt_pk_bf16_f32 v191, v60, v61
v_cvt_pk_bf16_f32 v192, v62, v63
v_cvt_pk_bf16_f32 v193, v64, v65
v_cvt_pk_bf16_f32 v194, v66, v67
v_cvt_pk_bf16_f32 v195, v68, v69
v_cvt_pk_bf16_f32 v196, v70, v71
v_cvt_pk_bf16_f32 v197, v72, v73
v_permlane32_swap_b32 v190, v192
v_permlane32_swap_b32 v191, v193
v_permlane32_swap_b32 v194, v196
v_permlane32_swap_b32 v195, v197
s_cmp_lg_u32 s36, 0
s_cbranch_scc1 ALT_109
buffer_store_dwordx4 v[190:193], v52, s[4:7], s61 offen
buffer_store_dwordx4 v[194:197], v52, s[4:7], s94 offen
ALTE_110:
s_cmp_lg_u32 s36, 0
s_cbranch_scc1 ALT_111
v_mov_b32 v11, 8
s_waitcnt vmcnt(0)
s_mov_b64 exec, 1
buffer_store_dword v11, off, s[4:7], s42
s_mov_b64 exec, -1
ALTE_112:
s_barrier
PH8:
v_lshrrev_b32 v242, 5, v0
v_lshl_add_u32 v234, v242, 10, v2
v_lshl_add_u32 v235, v242, 10, v3
v_lshl_add_u32 v236, v242, 10, v4
v_lshl_add_u32 v237, v242, 10, v5
s_add_u32 s60, s47, 4096
buffer_load_dwordx4 a[240:243], v50, s[4:7], s60 offen offset:0
ds_read_b64_tr_b16 v[90:91], v234 offset:0
ds_read_b64_tr_b16 v[92:93], v234 offset:1024
ds_read_b64_tr_b16 v[94:95], v235 offset:0
ds_read_b64_tr_b16 v[96:97], v235 offset:1024
ds_read_b64_tr_b16 v[98:99], v236 offset:0
ds_read_b64_tr_b16 v[100:101], v236 offset:1024
ds_read_b64_tr_b16 v[102:103], v237 offset:0
ds_read_b64_tr_b16 v[104:105], v237 offset:1024
buffer_load_dwordx4 a[244:247], v50, s[4:7], s60 offen offset:1024
ds_read_b64_tr_b16 v[106:107], v234 offset:4096
ds_read_b64_tr_b16 v[108:109], v234 offset:5120
ds_read_b64_tr_b16 v[110:111], v235 offset:4096
ds_read_b64_tr_b16 v[112:113], v235 offset:5120
ds_read_b64_tr_b16 v[114:115], v236 offset:4096
ds_read_b64_tr_b16 v[116:117], v236 offset:5120
ds_read_b64_tr_b16 v[118:119], v237 offset:4096
ds_read_b64_tr_b16 v[120:121], v237 offset:5120
buffer_load_dwordx4 a[248:251], v50, s[4:7], s60 offen offset:2048
ds_read_b64_tr_b16 v[122:123], v234 offset:8192
ds_read_b64_tr_b16 v[124:125], v234 offset:9216
ds_read_b64_tr_b16 v[126:127], v235 offset:8192
ds_read_b64_tr_b16 v[128:129], v235 offset:9216
ds_read_b64_tr_b16 v[130:131], v236 offset:8192
ds_read_b64_tr_b16 v[132:133], v236 offset:9216
ds_read_b64_tr_b16 v[134:135], v237 offset:8192
ds_read_b64_tr_b16 v[136:137], v237 offset:9216
buffer_load_dwordx4 a[252:255], v50, s[4:7], s60 offen offset:3072
ds_read_b64_tr_b16 v[138:139], v234 offset:12288
ds_read_b64_tr_b16 v[140:141], v234 offset:13312
ds_read_b64_tr_b16 v[142:143], v235 offset:12288
ds_read_b64_tr_b16 v[144:145], v235 offset:13312
ds_read_b64_tr_b16 v[146:147], v236 offset:12288
ds_read_b64_tr_b16 v[148:149], v236 offset:13312
ds_read_b64_tr_b16 v[150:151], v237 offset:12288
ds_read_b64_tr_b16 v[152:153], v237 offset:13312
s_add_u32 s60, s47, 8192
buffer_load_dwordx4 a[192:195], v50, s[4:7], s60 offen offset:0
POLL_113:
buffer_load_dword v11, v8, s[4:7], 0 offen sc1
s_waitcnt vmcnt(0)
v_cmp_gt_u32 vcc, 8, v11
s_cbranch_vccz POLLD_114
s_sub_u32 s39, s39, 1
s_cbranch_scc0 POLL_113
s_branch BAIL
POLLD_114:
s_add_u32 s61, s50, 0x800000
buffer_load_dwordx4 v[58:61], v1, s[4:7], s61 offen offset:0 sc1
buffer_load_dwordx4 v[62:65], v1, s[4:7], s61 offen offset:1024 sc1
buffer_load_dwordx4 v[66:69], v1, s[4:7], s61 offen offset:2048 sc1
ds_read_b64_tr_b16 v[154:155], v234 offset:16384
ds_read_b64_tr_b16 v[156:157], v234 offset:17408
ds_read_b64_tr_b16 v[158:159], v235 offset:16384
ds_read_b64_tr_b16 v[160:161], v235 offset:17408
ds_read_b64_tr_b16 v[162:163], v236 offset:16384
ds_read_b64_tr_b16 v[164:165], v236 offset:17408
ds_read_b64_tr_b16 v[166:167], v237 offset:16384
ds_read_b64_tr_b16 v[168:169], v237 offset:17408
buffer_load_dwordx4 v[70:73], v1, s[4:7], s61 offen offset:3072 sc1
s_add_u32 s61, s50, 0x801000
buffer_load_dwordx4 v[74:77], v1, s[4:7], s61 offen offset:0 sc1
ds_read_b64_tr_b16 v[170:171], v234 offset:20480
ds_read_b64_tr_b16 v[172:173], v234 offset:21504
ds_read_b64_tr_b16 v[174:175], v235 offset:20480
ds_read_b64_tr_b16 v[176:177], v235 offset:21504
ds_read_b64_tr_b16 v[178:179], v236 offset:20480
ds_read_b64_tr_b16 v[180:181], v236 offset:21504
ds_read_b64_tr_b16 v[182:183], v237 offset:20480
ds_read_b64_tr_b16 v[184:185], v237 offset:21504
buffer_load_dwordx4 v[78:81], v1, s[4:7], s61 offen offset:1024 sc1
buffer_load_dwordx4 v[82:85], v1, s[4:7], s61 offen offset:2048 sc1
ds_read_b64_tr_b16 v[186:187], v234 offset:24576
ds_read_b64_tr_b16 v[188:189], v234 offset:25600
ds_read_b64_tr_b16 v[190:191], v235 offset:24576
ds_read_b64_tr_b16 v[192:193], v235 offset:25600
ds_read_b64_tr_b16 v[194:195], v236 offset:24576
ds_read_b64_tr_b16 v[196:197], v236 offset:25600
ds_read_b64_tr_b16 v[198:199], v237 offset:24576
ds_read_b64_tr_b16 v[200:201], v237 offset:25600
ds_read_b64_tr_b16 v[202:203], v234 offset:28672
ds_read_b64_tr_b16 v[204:205], v234 offset:29696
ds_read_b64_tr_b16 v[206:207], v235 offset:28672
ds_read_b64_tr_b16 v[208:209], v235 offset:29696
ds_read_b64_tr_b16 v[210:211], v236 offset:28672
ds_read_b64_tr_b16 v[212:213], v236 offset:29696
ds_read_b64_tr_b16 v[214:215], v237 offset:28672
ds_read_b64_tr_b16 v[216:217], v237 offset:29696
s_waitcnt vmcnt(6) lgkmcnt(15)
v_mfma_f32_16x16x32_bf16 v[12:15], v[90:93], v[58:61], v[12:15]
buffer_load_dwordx4 v[86:89], v1, s[4:7], s61 offen offset:3072 sc1
ds_read_b64_tr_b16 v[90:91], v234 offset:32768
ds_read_b64_tr_b16 v[92:93], v234 offset:33792
v_mfma_f32_16x16x32_bf16 v[16:19], v[94:97], v[58:61], v[16:19]
ds_read_b64_tr_b16 v[94:95], v235 offset:32768
ds_read_b64_tr_b16 v[96:97], v235 offset:33792
v_mfma_f32_16x16x32_bf16 v[20:23], v[98:101], v[58:61], v[20:23]
v_mfma_f32_16x16x32_bf16 v[24:27], v[102:105], v[58:61], v[24:27]
ds_read_b64_tr_b16 v[98:99], v236 offset:32768
ds_read_b64_tr_b16 v[100:101], v236 offset:33792
s_waitcnt vmcnt(6) lgkmcnt(15)
v_mfma_f32_16x16x32_bf16 v[12:15], v[106:109], v[62:65], v[12:15]
s_add_u32 s61, s50, 0x802000
buffer_load_dwordx4 v[58:61], v1, s[4:7], s61 offen offset:0 sc1
ds_read_b64_tr_b16 v[102:103], v237 offset:32768
ds_read_b64_tr_b16 v[104:105], v237 offset:33792
v_mfma_f32_16x16x32_bf16 v[16:19], v[110:113], v[62:65], v[16:19]
v_mfma_f32_16x16x32_bf16 v[20:23], v[114:117], v[62:65], v[20:23]
ds_read_b64_tr_b16 v[106:107], v234 offset:36864
ds_read_b64_tr_b16 v[108:109], v234 offset:37888
v_mfma_f32_16x16x32_bf16 v[24:27], v[118:121], v[62:65], v[24:27]
s_waitcnt vmcnt(6) lgkmcnt(15)
v_mfma_f32_16x16x32_bf16 v[12:15], v[122:125], v[66:69], v[12:15]
buffer_load_dwordx4 v[62:65], v1, s[4:7], s61 offen offset:1024 sc1
ds_read_b64_tr_b16 v[110:111], v235 offset:36864
ds_read_b64_tr_b16 v[112:113], v235 offset:37888
v_mfma_f32_16x16x32_bf16 v[16:19], v[126:129], v[66:69], v[16:19]
ds_read_b64_tr_b16 v[114:115], v236 offset:36864
ds_read_b64_tr_b16 v[116:117], v236 offset:37888
v_mfma_f32_16x16x32_bf16 v[20:23], v[130:133], v[66:69], v[20:23]
v_mfma_f32_16x16x32_bf16 v[24:27], v[134:137], v[66:69], v[24:27]
ds_read_b64_tr_b16 v[118:119], v237 offset:36864
ds_read_b64_tr_b16 v[120:121], v237 offset:37888
s_waitcnt vmcnt(6) lgkmcnt(15)
v_mfma_f32_16x16x32_bf16 v[12:15], v[138:141], v[70:73], v[12:15]
buffer_load_dwordx4 v[66:69], v1, s[4:7], s61 offen offset:2048 sc1
v_mfma_f32_16x16x32_bf16 v[16:19], v[142:145], v[70:73], v[16:19]
ds_read_b64_tr_b16 v[122:123], v234 offset:40960
ds_read_b64_tr_b16 v[124:125], v234 offset:41984
v_mfma_f32_16x16x32_bf16 v[20:23], v[146:149], v[70:73], v[20:23]
ds_read_b64_tr_b16 v[126:127], v235 offset:40960
ds_read_b64_tr_b16 v[128:129], v235 offset:41984
v_mfma_f32_16x16x32_bf16 v[24:27], v[150:153], v[70:73], v[24:27]
s_waitcnt vmcnt(6) lgkmcnt(15)
v_mfma_f32_16x16x32_bf16 v[12:15], v[154:157], v[74:77], v[12:15]
buffer_load_dwordx4 v[70:73], v1, s[4:7], s61 offen offset:3072 sc1
ds_read_b64_tr_b16 v[130:131], v236 offset:40960
ds_read_b64_tr_b16 v[132:133], v236 offset:41984
v_mfma_f32_16x16x32_bf16 v[16:19], v[158:161], v[74:77], v[16:19]
ds_read_b64_tr_b16 v[134:135], v237 offset:40960
ds_read_b64_tr_b16 v[136:137], v237 offset:41984
v_mfma_f32_16x16x32_bf16 v[20:23], v[162:165], v[74:77], v[20:23]
v_mfma_f32_16x16x32_bf16 v[24:27], v[166:169], v[74:77], v[24:27]
ds_read_b64_tr_b16 v[138:139], v234 offset:45056
ds_read_b64_tr_b16 v[140:141], v234 offset:46080
s_waitcnt vmcnt(6) lgkmcnt(15)
v_mfma_f32_16x16x32_bf16 v[12:15], v[170:173], v[78:81], v[12:15]
s_add_u32 s61, s50, 0x803000
buffer_load_dwordx4 v[74:77], v1, s[4:7], s61 offen offset:0 sc1
v_mfma_f32_16x16x32_bf16 v[16:19], v[174:177], v[78:81], v[16:19]
ds_read_b64_tr_b16 v[142:143], v235 offset:45056
ds_read_b64_tr_b16 v[144:145], v235 offset:46080
v_mfma_f32_16x16x32_bf16 v[20:23], v[178:181], v[78:81], v[20:23]
ds_read_b64_tr_b16 v[146:147], v236 offset:45056
ds_read_b64_tr_b16 v[148:149], v236 offset:46080
v_mfma_f32_16x16x32_bf16 v[24:27], v[182:185], v[78:81], v[24:27]
s_waitcnt vmcnt(6) lgkmcnt(15)
v_mfma_f32_16x16x32_bf16 v[12:15], v[186:189], v[82:85], v[12:15]
buffer_load_dwordx4 v[78:81], v1, s[4:7], s61 offen offset:1024 sc1
ds_read_b64_tr_b16 v[150:151], v237 offset:45056
ds_read_b64_tr_b16 v[152:153], v237 offset:46080
v_mfma_f32_16x16x32_bf16 v[16:19], v[190:193], v[82:85], v[16:19]
v_mfma_f32_16x16x32_bf16 v[20:23], v[194:197], v[82:85], v[20:23]
ds_read_b64_tr_b16 v[154:155], v234 offset:49152
ds_read_b64_tr_b16 v[156:157], v234 offset:50176
v_mfma_f32_16x16x32_bf16 v[24:27], v[198:201], v[82:85], v[24:27]
ds_read_b64_tr_b16 v[158:159], v235 offset:49152
ds_read_b64_tr_b16 v[160:161], v235 offset:50176
s_waitcnt vmcnt(6) lgkmcnt(15)
v_mfma_f32_16x16x32_bf16 v[12:15], v[202:205], v[86:89], v[12:15]
buffer_load_dwordx4 v[82:85], v1, s[4:7], s61 offen offset:2048 sc1
v_mfma_f32_16x16x32_bf16 v[16:19], v[206:209], v[86:89], v[16:19]
ds_read_b64_tr_b16 v[162:163], v236 offset:49152
ds_read_b64_tr_b16 v[164:165], v236 offset:50176
v_mfma_f32_16x16x32_bf16 v[20:23], v[210:213], v[86:89], v[20:23]
ds_read_b64_tr_b16 v[166:167], v237 offset:49152
ds_read_b64_tr_b16 v[168:169], v237 offset:50176
v_mfma_f32_16x16x32_bf16 v[24:27], v[214:217], v[86:89], v[24:27]
s_waitcnt vmcnt(6) lgkmcnt(15)
v_mfma_f32_16x16x32_bf16 v[12:15], v[90:93], v[58:61], v[12:15]
buffer_load_dwordx4 v[86:89], v1, s[4:7], s61 offen offset:3072 sc1
ds_read_b64_tr_b16 v[170:171], v234 offset:53248
ds_read_b64_tr_b16 v[172:173], v234 offset:54272
v_mfma_f32_16x16x32_bf16 v[16:19], v[94:97], v[58:61], v[16:19]
v_mfma_f32_16x16x32_bf16 v[20:23], v[98:101], v[58:61], v[20:23]
ds_read_b64_tr_b16 v[174:175], v235 offset:53248
ds_read_b64_tr_b16 v[176:177], v235 offset:54272
v_mfma_f32_16x16x32_bf16 v[24:27], v[102:105], v[58:61], v[24:27]
ds_read_b64_tr_b16 v[178:179], v236 offset:53248
ds_read_b64_tr_b16 v[180:181], v236 offset:54272
s_waitcnt vmcnt(6) lgkmcnt(15)
v_mfma_f32_16x16x32_bf16 v[12:15], v[106:109], v[62:65], v[12:15]
buffer_load_dwordx4 a[196:199], v50, s[4:7], s60 offen offset:1024
v_mfma_f32_16x16x32_bf16 v[16:19], v[110:113], v[62:65], v[16:19]
ds_read_b64_tr_b16 v[182:183], v237 offset:53248
ds_read_b64_tr_b16 v[184:185], v237 offset:54272
v_mfma_f32_16x16x32_bf16 v[20:23], v[114:117], v[62:65], v[20:23]
v_mfma_f32_16x16x32_bf16 v[24:27], v[118:121], v[62:65], v[24:27]
ds_read_b64_tr_b16 v[186:187], v234 offset:57344
ds_read_b64_tr_b16 v[188:189], v234 offset:58368
s_waitcnt vmcnt(6) lgkmcnt(15)
v_mfma_f32_16x16x32_bf16 v[12:15], v[122:125], v[66:69], v[12:15]
buffer_load_dwordx4 a[200:203], v50, s[4:7], s60 offen offset:2048
ds_read_b64_tr_b16 v[190:191], v235 offset:57344
ds_read_b64_tr_b16 v[192:193], v235 offset:58368
v_mfma_f32_16x16x32_bf16 v[16:19], v[126:129], v[66:69], v[16:19]
v_mfma_f32_16x16x32_bf16 v[20:23], v[130:133], v[66:69], v[20:23]
ds_read_b64_tr_b16 v[194:195], v236 offset:57344
ds_read_b64_tr_b16 v[196:197], v236 offset:58368
v_mfma_f32_16x16x32_bf16 v[24:27], v[134:137], v[66:69], v[24:27]
ds_read_b64_tr_b16 v[198:199], v237 offset:57344
ds_read_b64_tr_b16 v[200:201], v237 offset:58368
s_waitcnt vmcnt(6) lgkmcnt(15)
v_mfma_f32_16x16x32_bf16 v[12:15], v[138:141], v[70:73], v[12:15]
buffer_load_dwordx4 a[204:207], v50, s[4:7], s60 offen offset:3072
v_mfma_f32_16x16x32_bf16 v[16:19], v[142:145], v[70:73], v[16:19]
ds_read_b64_tr_b16 v[202:203], v234 offset:61440
ds_read_b64_tr_b16 v[204:205], v234 offset:62464
v_mfma_f32_16x16x32_bf16 v[20:23], v[146:149], v[70:73], v[20:23]
v_mfma_f32_16x16x32_bf16 v[24:27], v[150:153], v[70:73], v[24:27]
ds_read_b64_tr_b16 v[206:207], v235 offset:61440
ds_read_b64_tr_b16 v[208:209], v235 offset:62464
s_waitcnt vmcnt(6) lgkmcnt(15)
v_mfma_f32_16x16x32_bf16 v[12:15], v[154:157], v[74:77], v[12:15]
s_add_u32 s60, s47, 12288
buffer_load_dwordx4 a[208:211], v50, s[4:7], s60 offen offset:0
ds_read_b64_tr_b16 v[210:211], v236 offset:61440
ds_read_b64_tr_b16 v[212:213], v236 offset:62464
v_mfma_f32_16x16x32_bf16 v[16:19], v[158:161], v[74:77], v[16:19]
v_mfma_f32_16x16x32_bf16 v[20:23], v[162:165], v[74:77], v[20:23]
ds_read_b64_tr_b16 v[214:215], v237 offset:61440
ds_read_b64_tr_b16 v[216:217], v237 offset:62464
v_mfma_f32_16x16x32_bf16 v[24:27], v[166:169], v[74:77], v[24:27]
s_waitcnt vmcnt(6) lgkmcnt(15)
v_mfma_f32_16x16x32_bf16 v[12:15], v[170:173], v[78:81], v[12:15]
buffer_load_dwordx4 a[212:215], v50, s[4:7], s60 offen offset:1024
v_mfma_f32_16x16x32_bf16 v[16:19], v[174:177], v[78:81], v[16:19]
v_mfma_f32_16x16x32_bf16 v[20:23], v[178:181], v[78:81], v[20:23]
v_mfma_f32_16x16x32_bf16 v[24:27], v[182:185], v[78:81], v[24:27]
s_waitcnt vmcnt(6) lgkmcnt(8)
v_mfma_f32_16x16x32_bf16 v[12:15], v[186:189], v[82:85], v[12:15]
buffer_load_dwordx4 a[216:219], v50, s[4:7], s60 offen offset:2048
v_mfma_f32_16x16x32_bf16 v[16:19], v[190:193], v[82:85], v[16:19]
v_mfma_f32_16x16x32_bf16 v[20:23], v[194:197], v[82:85], v[20:23]
v_mfma_f32_16x16x32_bf16 v[24:27], v[198:201], v[82:85], v[24:27]
s_waitcnt vmcnt(6) lgkmcnt(0)
v_mfma_f32_16x16x32_bf16 v[12:15], v[202:205], v[86:89], v[12:15]
buffer_load_dwordx4 a[220:223], v50, s[4:7], s60 offen offset:3072
v_mfma_f32_16x16x32_bf16 v[16:19], v[206:209], v[86:89], v[16:19]
v_mfma_f32_16x16x32_bf16 v[20:23], v[210:213], v[86:89], v[20:23]
v_mfma_f32_16x16x32_bf16 v[24:27], v[214:217], v[86:89], v[24:27]
s_add_u32 s58, s50, s52
s_add_u32 s58, s58, 0xa00000
s_nop 1
v_cvt_pk_bf16_f32 v106, v12, v13
v_cvt_pk_bf16_f32 v107, v14, v15
v_cvt_pk_bf16_f32 v108, v16, v17
v_cvt_pk_bf16_f32 v109, v18, v19
v_cvt_pk_bf16_f32 v110, v20, v21
v_cvt_pk_bf16_f32 v111, v22, v23
v_cvt_pk_bf16_f32 v112, v24, v25
v_cvt_pk_bf16_f32 v113, v26, v27
s_cmp_lg_u32 s36, 0
s_cbranch_scc1 ALT_115
buffer_store_dwordx4 v[106:109], v1, s[4:7], s58 offen
buffer_store_dwordx4 v[110:113], v1, s[4:7], s58 offen offset:1024
ALTE_116:
v_pk_add_f32 v[242:243], v[12:13], v[14:15]
v_pk_mul_f32 v[244:245], v[12:13], v[12:13]
v_pk_fma_f32 v[244:245], v[14:15], v[14:15], v[244:245]
v_pk_add_f32 v[242:243], v[242:243], v[16:17]
v_pk_fma_f32 v[244:245], v[16:17], v[16:17], v[244:245]
v_pk_add_f32 v[242:243], v[242:243], v[18:19]
v_pk_fma_f32 v[244:245], v[18:19], v[18:19], v[244:245]
v_pk_add_f32 v[242:243], v[242:243], v[20:21]
v_pk_fma_f32 v[244:245], v[20:21], v[20:21], v[244:245]
v_pk_add_f32 v[242:243], v[242:243], v[22:23]
v_pk_fma_f32 v[244:245], v[22:23], v[22:23], v[244:245]
v_pk_add_f32 v[242:243], v[242:243], v[24:25]
v_pk_fma_f32 v[244:245], v[24:25], v[24:25], v[244:245]
v_pk_add_f32 v[242:243], v[242:243], v[26:27]
v_pk_fma_f32 v[244:245], v[26:27], v[26:27], v[244:245]
v_add_f32 v242, v242, v243
v_add_f32 v244, v244, v245
s_nop 1
v_permlane32_swap_b32 v242, v244
v_add_f32 v242, v242, v244
v_mov_b32 v243, v242
s_nop 1
v_permlane16_swap_b32 v242, v243
v_add_f32 v242, v242, v243
s_add_u32 s58, s51, 0x1320000
s_cmp_lg_u32 s36, 0
s_cbranch_scc1 ALT_117
buffer_store_dword v242, v44, s[4:7], s58 offen
v_mov_b32 v11, 9
s_waitcnt vmcnt(0)
s_mov_b64 exec, 1
buffer_store_dword v11, off, s[4:7], s42
s_mov_b64 exec, -1
ALTE_118:
s_barrier
PH9:
v_add_u32 v234, 65536, v2
v_add_u32 v235, 65536, v3
v_add_u32 v236, 65536, v4
v_add_u32 v237, 65536, v5
v_and_b32 v252, 48, v0
v_add_u32 v252, 149248, v252
s_add_u32 m0, s73, 0
s_add_u32 s48, s75, 229376
buffer_load_dwordx4 v45, s[16:19], s48 offen lds
ds_read_b64_tr_b16 v[90:91], v234 offset:0
ds_read_b64_tr_b16 v[92:93], v234 offset:2048
ds_read_b64_tr_b16 v[94:95], v235 offset:0
ds_read_b64_tr_b16 v[96:97], v235 offset:2048
ds_read_b64_tr_b16 v[98:99], v236 offset:0
ds_read_b64_tr_b16 v[100:101], v236 offset:2048
ds_read_b64_tr_b16 v[102:103], v237 offset:0
ds_read_b64_tr_b16 v[104:105], v237 offset:2048
s_add_u32 m0, s73, 4096
s_add_u32 s48, s75, 262144
buffer_load_dwordx4 v45, s[16:19], s48 offen lds
ds_read_b64_tr_b16 v[106:107], v234 offset:4096
ds_read_b64_tr_b16 v[108:109], v234 offset:6144
ds_read_b64_tr_b16 v[110:111], v235 offset:4096
ds_read_b64_tr_b16 v[112:113], v235 offset:6144
ds_read_b64_tr_b16 v[114:115], v236 offset:4096
ds_read_b64_tr_b16 v[116:117], v236 offset:6144
ds_read_b64_tr_b16 v[118:119], v237 offset:4096
ds_read_b64_tr_b16 v[120:121], v237 offset:6144
s_add_u32 m0, s73, 8192
s_add_u32 s48, s75, 294912
buffer_load_dwordx4 v45, s[16:19], s48 offen lds
ds_read_b64_tr_b16 v[122:123], v234 offset:8192
ds_read_b64_tr_b16 v[124:125], v234 offset:10240
ds_read_b64_tr_b16 v[126:127], v235 offset:8192
ds_read_b64_tr_b16 v[128:129], v235 offset:10240
ds_read_b64_tr_b16 v[130:131], v236 offset:8192
ds_read_b64_tr_b16 v[132:133], v236 offset:10240
ds_read_b64_tr_b16 v[134:135], v237 offset:8192
ds_read_b64_tr_b16 v[136:137], v237 offset:10240
s_add_u32 m0, s73, 12288
s_add_u32 s48, s75, 327680
buffer_load_dwordx4 v45, s[16:19], s48 offen lds
ds_read_b64_tr_b16 v[138:139], v234 offset:12288
ds_read_b64_tr_b16 v[140:141], v234 offset:14336
ds_read_b64_tr_b16 v[142:143], v235 offset:12288
ds_read_b64_tr_b16 v[144:145], v235 offset:14336
ds_read_b64_tr_b16 v[146:147], v236 offset:12288
ds_read_b64_tr_b16 v[148:149], v236 offset:14336
ds_read_b64_tr_b16 v[150:151], v237 offset:12288
ds_read_b64_tr_b16 v[152:153], v237 offset:14336
s_add_u32 m0, s73, 16384
s_add_u32 s48, s75, 360448
buffer_load_dwordx4 v45, s[16:19], s48 offen lds
POLL_119:
buffer_load_dword v11, v6, s[4:7], 0 offen sc1
s_waitcnt vmcnt(0)
v_cmp_gt_u32 vcc, 9, v11
s_cbranch_vccz POLLD_120
s_sub_u32 s39, s39, 1
s_cbranch_scc0 POLL_119
s_branch BAIL
POLLD_120:
s_add_u32 s61, s50, 0xa00000
buffer_load_dwordx4 v[58:61], v1, s[4:7], s61 offen offset:0 sc1
buffer_load_dwordx4 v[62:65], v1, s[4:7], s61 offen offset:1024 sc1
buffer_load_dwordx4 v[66:69], v1, s[4:7], s61 offen offset:2048 sc1
ds_read_b64_tr_b16 v[154:155], v234 offset:16384
ds_read_b64_tr_b16 v[156:157], v234 offset:18432
ds_read_b64_tr_b16 v[158:159], v235 offset:16384
ds_read_b64_tr_b16 v[160:161], v235 offset:18432
ds_read_b64_tr_b16 v[162:163], v236 offset:16384
ds_read_b64_tr_b16 v[164:165], v236 offset:18432
ds_read_b64_tr_b16 v[166:167], v237 offset:16384
ds_read_b64_tr_b16 v[168:169], v237 offset:18432
buffer_load_dwordx4 v[70:73], v1, s[4:7], s61 offen offset:3072 sc1
s_add_u32 s61, s50, 0xa01000
buffer_load_dwordx4 v[74:77], v1, s[4:7], s61 offen offset:0 sc1
ds_read_b64_tr_b16 v[170:171], v234 offset:20480
ds_read_b64_tr_b16 v[172:173], v234 offset:22528
ds_read_b64_tr_b16 v[174:175], v235 offset:20480
ds_read_b64_tr_b16 v[176:177], v235 offset:22528
ds_read_b64_tr_b16 v[178:179], v236 offset:20480
ds_read_b64_tr_b16 v[180:181], v236 offset:22528
ds_read_b64_tr_b16 v[182:183], v237 offset:20480
ds_read_b64_tr_b16 v[184:185], v237 offset:22528
buffer_load_dwordx4 v[78:81], v1, s[4:7], s61 offen offset:1024 sc1
buffer_load_dwordx4 v[82:85], v1, s[4:7], s61 offen offset:2048 sc1
ds_read_b64_tr_b16 v[186:187], v234 offset:24576
ds_read_b64_tr_b16 v[188:189], v234 offset:26624
ds_read_b64_tr_b16 v[190:191], v235 offset:24576
ds_read_b64_tr_b16 v[192:193], v235 offset:26624
ds_read_b64_tr_b16 v[194:195], v236 offset:24576
ds_read_b64_tr_b16 v[196:197], v236 offset:26624
ds_read_b64_tr_b16 v[198:199], v237 offset:24576
ds_read_b64_tr_b16 v[200:201], v237 offset:26624
ds_read_b64_tr_b16 v[202:203], v234 offset:28672
ds_read_b64_tr_b16 v[204:205], v234 offset:30720
ds_read_b64_tr_b16 v[206:207], v235 offset:28672
ds_read_b64_tr_b16 v[208:209], v235 offset:30720
ds_read_b64_tr_b16 v[210:211], v236 offset:28672
ds_read_b64_tr_b16 v[212:213], v236 offset:30720
ds_read_b64_tr_b16 v[214:215], v237 offset:28672
ds_read_b64_tr_b16 v[216:217], v237 offset:30720
s_waitcnt vmcnt(6) lgkmcnt(15)
v_mfma_f32_16x16x32_bf16 v[218:221], v[90:93], v[58:61], 0
buffer_load_dwordx4 v[86:89], v1, s[4:7], s61 offen offset:3072 sc1
ds_read_b64_tr_b16 v[90:91], v234 offset:32768
ds_read_b64_tr_b16 v[92:93], v234 offset:34816
v_mfma_f32_16x16x32_bf16 v[222:225], v[94:97], v[58:61], 0
ds_read_b64_tr_b16 v[94:95], v235 offset:32768
ds_read_b64_tr_b16 v[96:97], v235 offset:34816
v_mfma_f32_16x16x32_bf16 v[226:229], v[98:101], v[58:61], 0
ds_read_b64_tr_b16 v[98:99], v236 offset:32768
ds_read_b64_tr_b16 v[100:101], v236 offset:34816
v_mfma_f32_16x16x32_bf16 v[230:233], v[102:105], v[58:61], 0
ds_read_b64_tr_b16 v[102:103], v237 offset:32768
ds_read_b64_tr_b16 v[104:105], v237 offset:34816
s_waitcnt vmcnt(6) lgkmcnt(15)
v_mfma_f32_16x16x32_bf16 v[218:221], v[106:109], v[62:65], v[218:221]
s_add_u32 s61, s50, 0xa02000
buffer_load_dwordx4 v[58:61], v1, s[4:7], s61 offen offset:0 sc1
ds_read_b64_tr_b16 v[106:107], v234 offset:36864
ds_read_b64_tr_b16 v[108:109], v234 offset:38912
v_mfma_f32_16x16x32_bf16 v[222:225], v[110:113], v[62:65], v[222:225]
ds_read_b64_tr_b16 v[110:111], v235 offset:36864
ds_read_b64_tr_b16 v[112:113], v235 offset:38912
v_mfma_f32_16x16x32_bf16 v[226:229], v[114:117], v[62:65], v[226:229]
ds_read_b64_tr_b16 v[114:115], v236 offset:36864
ds_read_b64_tr_b16 v[116:117], v236 offset:38912
v_mfma_f32_16x16x32_bf16 v[230:233], v[118:121], v[62:65], v[230:233]
ds_read_b64_tr_b16 v[118:119], v237 offset:36864
ds_read_b64_tr_b16 v[120:121], v237 offset:38912
s_waitcnt vmcnt(6) lgkmcnt(15)
v_mfma_f32_16x16x32_bf16 v[218:221], v[122:125], v[66:69], v[218:221]
s_add_u32 s48, s51, 0x1320000
buffer_load_dwordx4 v[238:241], v1, s[4:7], s48 offen sc1
buffer_load_dwordx4 v[62:65], v1, s[4:7], s61 offen offset:1024 sc1
ds_read_b64_tr_b16 v[122:123], v234 offset:40960
ds_read_b64_tr_b16 v[124:125], v234 offset:43008
v_mfma_f32_16x16x32_bf16 v[222:225], v[126:129], v[66:69], v[222:225]
ds_read_b64_tr_b16 v[126:127], v235 offset:40960
ds_read_b64_tr_b16 v[128:129], v235 offset:43008
v_mfma_f32_16x16x32_bf16 v[226:229], v[130:133], v[66:69], v[226:229]
ds_read_b64_tr_b16 v[130:131], v236 offset:40960
ds_read_b64_tr_b16 v[132:133], v236 offset:43008
v_mfma_f32_16x16x32_bf16 v[230:233], v[134:137], v[66:69], v[230:233]
ds_read_b64_tr_b16 v[134:135], v237 offset:40960
ds_read_b64_tr_b16 v[136:137], v237 offset:43008
s_waitcnt vmcnt(7) lgkmcnt(15)
v_mfma_f32_16x16x32_bf16 v[218:221], v[138:141], v[70:73], v[218:221]
buffer_load_dwordx4 v[66:69], v1, s[4:7], s61 offen offset:2048 sc1
ds_read_b64_tr_b16 v[138:139], v234 offset:45056
ds_read_b64_tr_b16 v[140:141], v234 offset:47104
v_mfma_f32_16x16x32_bf16 v[222:225], v[142:145], v[70:73], v[222:225]
ds_read_b64_tr_b16 v[142:143], v235 offset:45056
ds_read_b64_tr_b16 v[144:145], v235 offset:47104
v_mfma_f32_16x16x32_bf16 v[226:229], v[146:149], v[70:73], v[226:229]
ds_read_b64_tr_b16 v[146:147], v236 offset:45056
ds_read_b64_tr_b16 v[148:149], v236 offset:47104
v_mfma_f32_16x16x32_bf16 v[230:233], v[150:153], v[70:73], v[230:233]
ds_read_b64_tr_b16 v[150:151], v237 offset:45056
ds_read_b64_tr_b16 v[152:153], v237 offset:47104
s_waitcnt vmcnt(7) lgkmcnt(15)
v_mfma_f32_16x16x32_bf16 v[218:221], v[154:157], v[74:77], v[218:221]
buffer_load_dwordx4 v[70:73], v1, s[4:7], s61 offen offset:3072 sc1
ds_read_b64_tr_b16 v[154:155], v234 offset:49152
ds_read_b64_tr_b16 v[156:157], v234 offset:51200
v_mfma_f32_16x16x32_bf16 v[222:225], v[158:161], v[74:77], v[222:225]
ds_read_b64_tr_b16 v[158:159], v235 offset:49152
ds_read_b64_tr_b16 v[160:161], v235 offset:51200
v_mfma_f32_16x16x32_bf16 v[226:229], v[162:165], v[74:77], v[226:229]
ds_read_b64_tr_b16 v[162:163], v236 offset:49152
ds_read_b64_tr_b16 v[164:165], v236 offset:51200
v_mfma_f32_16x16x32_bf16 v[230:233], v[166:169], v[74:77], v[230:233]
ds_read_b64_tr_b16 v[166:167], v237 offset:49152
ds_read_b64_tr_b16 v[168:169], v237 offset:51200
s_waitcnt vmcnt(7) lgkmcnt(15)
v_mfma_f32_16x16x32_bf16 v[218:221], v[170:173], v[78:81], v[218:221]
s_add_u32 s61, s50, 0xa03000
buffer_load_dwordx4 v[74:77], v1, s[4:7], s61 offen offset:0 sc1
ds_read_b64_tr_b16 v[170:171], v234 offset:53248
ds_read_b64_tr_b16 v[172:173], v234 offset:55296
v_mfma_f32_16x16x32_bf16 v[222:225], v[174:177], v[78:81], v[222:225]
ds_read_b64_tr_b16 v[174:175], v235 offset:53248
ds_read_b64_tr_b16 v[176:177], v235 offset:55296
v_mfma_f32_16x16x32_bf16 v[226:229], v[178:181], v[78:81], v[226:229]
ds_read_b64_tr_b16 v[178:179], v236 offset:53248
ds_read_b64_tr_b16 v[180:181], v236 offset:55296
v_mfma_f32_16x16x32_bf16 v[230:233], v[182:185], v[78:81], v[230:233]
ds_read_b64_tr_b16 v[182:183], v237 offset:53248
ds_read_b64_tr_b16 v[184:185], v237 offset:55296
s_waitcnt vmcnt(7) lgkmcnt(15)
v_mfma_f32_16x16x32_bf16 v[218:221], v[186:189], v[82:85], v[218:221]
buffer_load_dwordx4 v[78:81], v1, s[4:7], s61 offen offset:1024 sc1
ds_read_b64_tr_b16 v[186:187], v234 offset:57344
ds_read_b64_tr_b16 v[188:189], v234 offset:59392
v_mfma_f32_16x16x32_bf16 v[222:225], v[190:193], v[82:85], v[222:225]
ds_read_b64_tr_b16 v[190:191], v235 offset:57344
ds_read_b64_tr_b16 v[192:193], v235 offset:59392
v_mfma_f32_16x16x32_bf16 v[226:229], v[194:197], v[82:85], v[226:229]
ds_read_b64_tr_b16 v[194:195], v236 offset:57344
ds_read_b64_tr_b16 v[196:197], v236 offset:59392
v_mfma_f32_16x16x32_bf16 v[230:233], v[198:201], v[82:85], v[230:233]
ds_read_b64_tr_b16 v[198:199], v237 offset:57344
ds_read_b64_tr_b16 v[200:201], v237 offset:59392
s_waitcnt vmcnt(7) lgkmcnt(15)
v_mfma_f32_16x16x32_bf16 v[218:221], v[202:205], v[86:89], v[218:221]
buffer_load_dwordx4 v[82:85], v1, s[4:7], s61 offen offset:2048 sc1
ds_read_b64_tr_b16 v[202:203], v234 offset:61440
ds_read_b64_tr_b16 v[204:205], v234 offset:63488
v_mfma_f32_16x16x32_bf16 v[222:225], v[206:209], v[86:89], v[222:225]
ds_read_b64_tr_b16 v[206:207], v235 offset:61440
ds_read_b64_tr_b16 v[208:209], v235 offset:63488
v_mfma_f32_16x16x32_bf16 v[226:229], v[210:213], v[86:89], v[226:229]
ds_read_b64_tr_b16 v[210:211], v236 offset:61440
ds_read_b64_tr_b16 v[212:213], v236 offset:63488
v_mfma_f32_16x16x32_bf16 v[230:233], v[214:217], v[86:89], v[230:233]
ds_read_b64_tr_b16 v[214:215], v237 offset:61440
ds_read_b64_tr_b16 v[216:217], v237 offset:63488
s_waitcnt vmcnt(7) lgkmcnt(15)
v_mfma_f32_16x16x32_bf16 v[218:221], v[90:93], v[58:61], v[218:221]
ds_read_b128 v[90:93], v252 offset:0
buffer_load_dwordx4 v[86:89], v1, s[4:7], s61 offen offset:3072 sc1
v_mfma_f32_16x16x32_bf16 v[222:225], v[94:97], v[58:61], v[222:225]
ds_read_b128 v[94:97], v252 offset:64
v_mfma_f32_16x16x32_bf16 v[226:229], v[98:101], v[58:61], v[226:229]
ds_read_b128 v[98:101], v252 offset:128
v_mfma_f32_16x16x32_bf16 v[230:233], v[102:105], v[58:61], v[230:233]
ds_read_b128 v[102:105], v252 offset:192
s_waitcnt vmcnt(6) lgkmcnt(15)
v_mfma_f32_16x16x32_bf16 v[218:221], v[106:109], v[62:65], v[218:221]
v_add_f32 v238, v238, v240
s_mov_b32 s48, 0xc00000
buffer_load_dword v54, v57, s[4:7], s48 offen sc1
v_mfma_f32_16x16x32_bf16 v[222:225], v[110:113], v[62:65], v[222:225]
v_add_f32 v239, v239, v241
s_nop 1
v_permlane32_swap_b32 v238, v239
v_mfma_f32_16x16x32_bf16 v[226:229], v[114:117], v[62:65], v[226:229]
v_add_f32 v238, v238, v239
v_mov_b32 v239, v238
v_mfma_f32_16x16x32_bf16 v[230:233], v[118:121], v[62:65], v[230:233]
s_nop 0
v_permlane16_swap_b32 v238, v239
v_add_f32 v238, v238, v239
s_waitcnt vmcnt(6) lgkmcnt(15)
v_mfma_f32_16x16x32_bf16 v[218:221], v[122:125], v[66:69], v[218:221]
v_mov_b32 v239, v238
s_add_u32 m0, s73, 20480
s_add_u32 s48, s75, 393216
v_mfma_f32_16x16x32_bf16 v[222:225], v[126:129], v[66:69], v[222:225]
v_permlane32_swap_b32 v238, v239
v_mul_f32 v247, 0x3b000000, v238
v_mfma_f32_16x16x32_bf16 v[226:229], v[130:133], v[66:69], v[226:229]
v_mul_f32 v239, 0x3b000000, v239
v_fma_f32 v243, -v247, v247, v239
v_mfma_f32_16x16x32_bf16 v[230:233], v[134:137], v[66:69], v[230:233]
v_max_f32 v243, 0, v243
v_add_f32 v242, 0x3727c5ac, v243
s_waitcnt vmcnt(5) lgkmcnt(15)
v_mfma_f32_16x16x32_bf16 v[218:221], v[138:141], v[70:73], v[218:221]
s_waitcnt lgkmcnt(0)
v_rsq_f32 v248, v242
buffer_load_dwordx4 v45, s[16:19], s48 offen lds
v_mfma_f32_16x16x32_bf16 v[222:225], v[142:145], v[70:73], v[222:225]
v_mul_f32 v90, v90, -v247
v_mul_f32 v91, v91, -v247
v_mfma_f32_16x16x32_bf16 v[226:229], v[146:149], v[70:73], v[226:229]
v_mul_f32 v92, v92, -v247
v_mul_f32 v93, v93, -v247
v_mfma_f32_16x16x32_bf16 v[230:233], v[150:153], v[70:73], v[230:233]
v_mul_f32 v94, v94, -v247
v_mul_f32 v95, v95, -v247
s_waitcnt vmcnt(5)
v_mfma_f32_16x16x32_bf16 v[218:221], v[154:157], v[74:77], v[218:221]
v_mul_f32 v96, v96, -v247
s_add_u32 m0, s73, 24576
s_add_u32 s48, s75, 425984
v_mfma_f32_16x16x32_bf16 v[222:225], v[158:161], v[74:77], v[222:225]
v_mul_f32 v97, v97, -v247
v_mul_f32 v98, v98, -v247
v_mfma_f32_16x16x32_bf16 v[226:229], v[162:165], v[74:77], v[226:229]
v_mul_f32 v99, v99, -v247
v_mul_f32 v100, v100, -v247
v_mfma_f32_16x16x32_bf16 v[230:233], v[166:169], v[74:77], v[230:233]
v_mul_f32 v101, v101, -v247
v_mul_f32 v102, v102, -v247
s_waitcnt vmcnt(4)
v_mfma_f32_16x16x32_bf16 v[218:221], v[170:173], v[78:81], v[218:221]
v_mul_f32 v103, v103, -v247
buffer_load_dwordx4 v45, s[16:19], s48 offen lds
v_mfma_f32_16x16x32_bf16 v[222:225], v[174:177], v[78:81], v[222:225]
v_mul_f32 v104, v104, -v247
v_mul_f32 v105, v105, -v247
v_mfma_f32_16x16x32_bf16 v[226:229], v[178:181], v[78:81], v[226:229]
v_mul_f32 v242, v248, v248
v_mul_f32 v242, v242, v243
v_mfma_f32_16x16x32_bf16 v[230:233], v[182:185], v[78:81], v[230:233]
v_add_f32 v242, 0x3727c5ac, v242
v_rsq_f32 v242, v242
s_waitcnt vmcnt(4)
v_mfma_f32_16x16x32_bf16 v[218:221], v[186:189], v[82:85], v[218:221]
v_mul_f32 v242, v242, v248
s_add_u32 m0, s73, 28672
s_add_u32 s48, s75, 458752
v_mfma_f32_16x16x32_bf16 v[222:225], v[190:193], v[82:85], v[222:225]
v_rcp_f32 v246, v242
v_mul_f32 v244, 0xc0135761, v242
v_mfma_f32_16x16x32_bf16 v[226:229], v[194:197], v[82:85], v[226:229]
v_mul_f32 v242, v242, v242
v_mul_f32 v245, 0x3d372713, v242
v_mfma_f32_16x16x32_bf16 v[230:233], v[198:201], v[82:85], v[230:233]
v_mul_f32 v245, v245, v244
s_waitcnt vmcnt(3)
v_mfma_f32_16x16x32_bf16 v[218:221], v[202:205], v[86:89], v[218:221]
buffer_load_dwordx4 v45, s[16:19], s48 offen lds
v_mfma_f32_16x16x32_bf16 v[222:225], v[206:209], v[86:89], v[222:225]
v_mfma_f32_16x16x32_bf16 v[226:229], v[210:213], v[86:89], v[226:229]
v_mfma_f32_16x16x32_bf16 v[230:233], v[214:217], v[86:89], v[230:233]
s_nop 3
v_pk_add_f32 v[218:219], v[218:219], v[90:91]
s_add_u32 m0, s73, 32768
s_add_u32 s48, s75, 491520
v_pk_add_f32 v[220:221], v[220:221], v[92:93]
v_pk_add_f32 v[222:223], v[222:223], v[94:95]
buffer_load_dwordx4 v45, s[16:19], s48 offen lds
v_pk_add_f32 v[224:225], v[224:225], v[96:97]
v_pk_add_f32 v[226:227], v[226:227], v[98:99]
v_pk_add_f32 v[228:229], v[228:229], v[100:101]
v_pk_add_f32 v[230:231], v[230:231], v[102:103]
v_pk_add_f32 v[232:233], v[232:233], v[104:105]
v_pk_mul_f32 v[114:115], v[218:219], v[218:219]
v_pk_mul_f32 v[116:117], v[220:221], v[220:221]
v_pk_mul_f32 v[118:119], v[222:223], v[222:223]
v_pk_mul_f32 v[120:121], v[224:225], v[224:225]
v_pk_mul_f32 v[122:123], v[226:227], v[226:227]
v_pk_mul_f32 v[124:125], v[228:229], v[228:229]
v_pk_mul_f32 v[126:127], v[230:231], v[230:231]
v_pk_mul_f32 v[128:129], v[232:233], v[232:233]
s_add_u32 s60, s47, 16384
buffer_load_dwordx4 a[0:3], v50, s[4:7], s60 offen offset:0
v_pk_fma_f32 v[114:115], v[114:115], v[244:245], v[244:245] op_sel:[0,1,0] op_sel_hi:[1,1,0]
v_pk_fma_f32 v[116:117], v[116:117], v[244:245], v[244:245] op_sel:[0,1,0] op_sel_hi:[1,1,0]
v_pk_fma_f32 v[118:119], v[118:119], v[244:245], v[244:245] op_sel:[0,1,0] op_sel_hi:[1,1,0]
v_pk_fma_f32 v[120:121], v[120:121], v[244:245], v[244:245] op_sel:[0,1,0] op_sel_hi:[1,1,0]
v_pk_fma_f32 v[122:123], v[122:123], v[244:245], v[244:245] op_sel:[0,1,0] op_sel_hi:[1,1,0]
v_pk_fma_f32 v[124:125], v[124:125], v[244:245], v[244:245] op_sel:[0,1,0] op_sel_hi:[1,1,0]
v_pk_fma_f32 v[126:127], v[126:127], v[244:245], v[244:245] op_sel:[0,1,0] op_sel_hi:[1,1,0]
v_pk_fma_f32 v[128:129], v[128:129], v[244:245], v[244:245] op_sel:[0,1,0] op_sel_hi:[1,1,0]
v_pk_mul_f32 v[114:115], v[114:115], v[218:219]
v_pk_mul_f32 v[116:117], v[116:117], v[220:221]
v_pk_mul_f32 v[118:119], v[118:119], v[222:223]
v_pk_mul_f32 v[120:121], v[120:121], v[224:225]
v_pk_mul_f32 v[122:123], v[122:123], v[226:227]
buffer_load_dwordx4 a[4:7], v50, s[4:7], s60 offen offset:1024
v_pk_mul_f32 v[124:125], v[124:125], v[228:229]
v_pk_mul_f32 v[126:127], v[126:127], v[230:231]
v_pk_mul_f32 v[128:129], v[128:129], v[232:233]
v_exp_f32 v114, v114
v_exp_f32 v115, v115
v_exp_f32 v116, v116
v_exp_f32 v117, v117
v_exp_f32 v118, v118
buffer_load_dwordx4 a[8:11], v50, s[4:7], s60 offen offset:2048
v_exp_f32 v119, v119
v_exp_f32 v120, v120
v_exp_f32 v121, v121
v_exp_f32 v122, v122
v_exp_f32 v123, v123
v_exp_f32 v124, v124
v_exp_f32 v125, v125
buffer_load_dwordx4 a[12:15], v50, s[4:7], s60 offen offset:3072
v_exp_f32 v126, v126
v_exp_f32 v127, v127
v_exp_f32 v128, v128
v_exp_f32 v129, v129
v_pk_fma_f32 v[114:115], v[114:115], v[246:247], v[246:247] op_sel_hi:[1,0,0]
v_pk_fma_f32 v[116:117], v[116:117], v[246:247], v[246:247] op_sel_hi:[1,0,0]
v_pk_fma_f32 v[118:119], v[118:119], v[246:247], v[246:247] op_sel_hi:[1,0,0]
v_pk_fma_f32 v[120:121], v[120:121], v[246:247], v[246:247] op_sel_hi:[1,0,0]
v_pk_fma_f32 v[122:123], v[122:123], v[246:247], v[246:247] op_sel_hi:[1,0,0]
s_add_u32 s60, s47, 20480
buffer_load_dwordx4 a[16:19], v50, s[4:7], s60 offen offset:0
v_pk_fma_f32 v[124:125], v[124:125], v[246:247], v[246:247] op_sel_hi:[1,0,0]
v_pk_fma_f32 v[126:127], v[126:127], v[246:247], v[246:247] op_sel_hi:[1,0,0]
v_pk_fma_f32 v[128:129], v[128:129], v[246:247], v[246:247] op_sel_hi:[1,0,0]
v_rcp_f32 v114, v114
v_rcp_f32 v115, v115
v_rcp_f32 v116, v116
v_rcp_f32 v117, v117
v_rcp_f32 v118, v118
buffer_load_dwordx4 a[20:23], v50, s[4:7], s60 offen offset:1024
v_rcp_f32 v119, v119
v_rcp_f32 v120, v120
v_rcp_f32 v121, v121
v_rcp_f32 v122, v122
v_rcp_f32 v123, v123
v_rcp_f32 v124, v124
v_rcp_f32 v125, v125
buffer_load_dwordx4 a[24:27], v50, s[4:7], s60 offen offset:2048
v_rcp_f32 v126, v126
v_rcp_f32 v127, v127
v_rcp_f32 v128, v128
v_rcp_f32 v129, v129
v_pk_mul_f32 v[218:219], v[218:219], v[114:115]
v_pk_mul_f32 v[220:221], v[220:221], v[116:117]
v_pk_mul_f32 v[222:223], v[222:223], v[118:119]
v_pk_mul_f32 v[224:225], v[224:225], v[120:121]
v_pk_mul_f32 v[226:227], v[226:227], v[122:123]
buffer_load_dwordx4 a[28:31], v50, s[4:7], s60 offen offset:3072
v_pk_mul_f32 v[228:229], v[228:229], v[124:125]
v_pk_mul_f32 v[230:231], v[230:231], v[126:127]
v_pk_mul_f32 v[232:233], v[232:233], v[128:129]
s_add_u32 s58, s50, s52
s_add_u32 s58, s58, 0x800000
v_cvt_pk_bf16_f32 v106, v218, v219
v_cvt_pk_bf16_f32 v107, v220, v221
v_cvt_pk_bf16_f32 v108, v222, v223
v_cvt_pk_bf16_f32 v109, v224, v225
v_cvt_pk_bf16_f32 v110, v226, v227
v_cvt_pk_bf16_f32 v111, v228, v229
v_cvt_pk_bf16_f32 v112, v230, v231
v_cvt_pk_bf16_f32 v113, v232, v233
s_cmp_lg_u32 s36, 0
s_cbranch_scc1 ALT_121
buffer_store_dwordx4 v[106:109], v1, s[4:7], s58 offen
buffer_store_dwordx4 v[110:113], v1, s[4:7], s58 offen offset:1024
ALTE_122:
s_lshl_b32 s58, s32, 15
s_add_u32 s58, s58, s52
s_cmp_eq_u32 s34, 0
s_cselect_b32 s59, 0x4000, 0
s_add_u32 s58, s58, s59
s_add_u32 s61, s58, 0x1600000
s_cmp_lg_u32 s36, 0
s_cbranch_scc1 ALT_123
v_mov_b32 v11, 10
s_cmp_eq_u32 s38, 0
s_cbranch_scc1 EXP_127
buffer_store_dwordx4 v[106:109], v1, s[4:7], s61 offen sc1
buffer_store_dwordx4 v[110:113], v1, s[4:7], s61 offen offset:1024 sc1
s_waitcnt vmcnt(2)
s_branch EXW_128
EXP_127:
s_waitcnt vmcnt(0)
EXW_128:
s_mov_b64 exec, 1
buffer_store_dword v11, off, s[4:7], s42
s_mov_b64 exec, -1
ALTE_124:
v_mul_f32 v242, v248, -v247
v_pk_fma_f32 v[28:29], v[12:13], v[248:249], v[242:243] op_sel_hi:[1,0,0]
v_pk_fma_f32 v[30:31], v[14:15], v[248:249], v[242:243] op_sel_hi:[1,0,0]
v_pk_fma_f32 v[32:33], v[16:17], v[248:249], v[242:243] op_sel_hi:[1,0,0]
v_pk_fma_f32 v[34:35], v[18:19], v[248:249], v[242:243] op_sel_hi:[1,0,0]
v_pk_fma_f32 v[36:37], v[20:21], v[248:249], v[242:243] op_sel_hi:[1,0,0]
v_pk_fma_f32 v[38:39], v[22:23], v[248:249], v[242:243] op_sel_hi:[1,0,0]
v_pk_fma_f32 v[40:41], v[24:25], v[248:249], v[242:243] op_sel_hi:[1,0,0]
v_pk_fma_f32 v[42:43], v[26:27], v[248:249], v[242:243] op_sel_hi:[1,0,0]
s_barrier
PH10:
v_add_u32 v234, 131072, v2
v_add_u32 v235, 131072, v3
v_add_u32 v236, 131072, v4
v_add_u32 v237, 131072, v5
v_mov_b32 v242, 0x100000
v_cmp_le_u32 vcc, 0x200000, v46
s_nop 1
v_cndmask_b32 v243, 0, v242, vcc
v_add_u32 v46, v46, v243
v_cmp_le_u32 vcc, 0x200000, v47
s_nop 1
v_cndmask_b32 v243, 0, v242, vcc
v_add_u32 v47, v47, v243
v_cmp_le_u32 vcc, 0x200000, v48
s_nop 1
v_cndmask_b32 v243, 0, v242, vcc
v_add_u32 v48, v48, v243
v_cmp_le_u32 vcc, 0x200000, v49
s_nop 1
v_cndmask_b32 v243, 0, v242, vcc
v_add_u32 v49, v49, v243
s_add_u32 s60, s47, 24576
buffer_load_dwordx4 a[32:35], v50, s[4:7], s60 offen offset:0
ds_read_b64_tr_b16 v[90:91], v234 offset:0
ds_read_b64_tr_b16 v[92:93], v234 offset:2048
ds_read_b64_tr_b16 v[94:95], v235 offset:0
ds_read_b64_tr_b16 v[96:97], v235 offset:2048
ds_read_b64_tr_b16 v[98:99], v236 offset:0
ds_read_b64_tr_b16 v[100:101], v236 offset:2048
ds_read_b64_tr_b16 v[102:103], v237 offset:0
ds_read_b64_tr_b16 v[104:105], v237 offset:2048
buffer_load_dwordx4 a[36:39], v50, s[4:7], s60 offen offset:1024
ds_read_b64_tr_b16 v[106:107], v234 offset:4096
ds_read_b64_tr_b16 v[108:109], v234 offset:6144
ds_read_b64_tr_b16 v[110:111], v235 offset:4096
ds_read_b64_tr_b16 v[112:113], v235 offset:6144
ds_read_b64_tr_b16 v[114:115], v236 offset:4096
ds_read_b64_tr_b16 v[116:117], v236 offset:6144
ds_read_b64_tr_b16 v[118:119], v237 offset:4096
ds_read_b64_tr_b16 v[120:121], v237 offset:6144
buffer_load_dwordx4 a[40:43], v50, s[4:7], s60 offen offset:2048
ds_read_b64_tr_b16 v[122:123], v234 offset:8192
ds_read_b64_tr_b16 v[124:125], v234 offset:10240
ds_read_b64_tr_b16 v[126:127], v235 offset:8192
ds_read_b64_tr_b16 v[128:129], v235 offset:10240
ds_read_b64_tr_b16 v[130:131], v236 offset:8192
ds_read_b64_tr_b16 v[132:133], v236 offset:10240
ds_read_b64_tr_b16 v[134:135], v237 offset:8192
ds_read_b64_tr_b16 v[136:137], v237 offset:10240
buffer_load_dwordx4 a[44:47], v50, s[4:7], s60 offen offset:3072
ds_read_b64_tr_b16 v[138:139], v234 offset:12288
ds_read_b64_tr_b16 v[140:141], v234 offset:14336
ds_read_b64_tr_b16 v[142:143], v235 offset:12288
ds_read_b64_tr_b16 v[144:145], v235 offset:14336
ds_read_b64_tr_b16 v[146:147], v236 offset:12288
ds_read_b64_tr_b16 v[148:149], v236 offset:14336
ds_read_b64_tr_b16 v[150:151], v237 offset:12288
ds_read_b64_tr_b16 v[152:153], v237 offset:14336
s_add_u32 s60, s47, 28672
buffer_load_dwordx4 a[48:51], v50, s[4:7], s60 offen offset:0
s_cmp_eq_u32 s38, 0
s_cbranch_scc1 EXF_129
v_mov_b32 v11, 10
s_waitcnt vmcnt(6)
s_mov_b64 exec, 1
buffer_store_dword v11, off, s[4:7], s43 sc1
s_mov_b64 exec, -1
EXF_129:
POLL_130:
buffer_load_dword v11, v9, s[4:7], 0 offen sc1
s_waitcnt vmcnt(0)
v_cmp_gt_u32 vcc, 10, v11
s_cbranch_vccz POLLD_131
s_sub_u32 s39, s39, 1
s_cbranch_scc0 POLL_130
s_branch BAIL
POLLD_131:
s_mov_b32 s61, 0x800000
buffer_load_dwordx4 v[58:61], v46, s[4:7], s61 offen offset:0 sc1
buffer_load_dwordx4 v[62:65], v46, s[4:7], s61 offen offset:1024 sc1
buffer_load_dwordx4 v[66:69], v46, s[4:7], s61 offen offset:2048 sc1
ds_read_b64_tr_b16 v[154:155], v234 offset:20480
ds_read_b64_tr_b16 v[156:157], v234 offset:22528
ds_read_b64_tr_b16 v[158:159], v235 offset:20480
ds_read_b64_tr_b16 v[160:161], v235 offset:22528
ds_read_b64_tr_b16 v[162:163], v236 offset:20480
ds_read_b64_tr_b16 v[164:165], v236 offset:22528
ds_read_b64_tr_b16 v[166:167], v237 offset:20480
ds_read_b64_tr_b16 v[168:169], v237 offset:22528
buffer_load_dwordx4 v[70:73], v46, s[4:7], s61 offen offset:3072 sc1
s_mov_b32 s61, 0x801000
buffer_load_dwordx4 v[74:77], v47, s[4:7], s61 offen offset:0 sc1
ds_read_b64_tr_b16 v[170:171], v234 offset:24576
ds_read_b64_tr_b16 v[172:173], v234 offset:26624
ds_read_b64_tr_b16 v[174:175], v235 offset:24576
ds_read_b64_tr_b16 v[176:177], v235 offset:26624
ds_read_b64_tr_b16 v[178:179], v236 offset:24576
ds_read_b64_tr_b16 v[180:181], v236 offset:26624
ds_read_b64_tr_b16 v[182:183], v237 offset:24576
ds_read_b64_tr_b16 v[184:185], v237 offset:26624
buffer_load_dwordx4 v[78:81], v47, s[4:7], s61 offen offset:1024 sc1
buffer_load_dwordx4 v[82:85], v47, s[4:7], s61 offen offset:2048 sc1
ds_read_b64_tr_b16 v[186:187], v234 offset:28672
ds_read_b64_tr_b16 v[188:189], v234 offset:30720
ds_read_b64_tr_b16 v[190:191], v235 offset:28672
ds_read_b64_tr_b16 v[192:193], v235 offset:30720
ds_read_b64_tr_b16 v[194:195], v236 offset:28672
ds_read_b64_tr_b16 v[196:197], v236 offset:30720
ds_read_b64_tr_b16 v[198:199], v237 offset:28672
ds_read_b64_tr_b16 v[200:201], v237 offset:30720
ds_read_b64_tr_b16 v[202:203], v2 offset:0
ds_read_b64_tr_b16 v[204:205], v2 offset:2048
ds_read_b64_tr_b16 v[206:207], v3 offset:0
ds_read_b64_tr_b16 v[208:209], v3 offset:2048
ds_read_b64_tr_b16 v[210:211], v4 offset:0
ds_read_b64_tr_b16 v[212:213], v4 offset:2048
ds_read_b64_tr_b16 v[214:215], v5 offset:0
ds_read_b64_tr_b16 v[216:217], v5 offset:2048
s_waitcnt vmcnt(6) lgkmcnt(15)
v_mfma_f32_16x16x32_bf16 v[28:31], v[90:93], v[58:61], v[28:31]
buffer_load_dwordx4 v[86:89], v47, s[4:7], s61 offen offset:3072 sc1
ds_read_b64_tr_b16 v[90:91], v2 offset:4096
ds_read_b64_tr_b16 v[92:93], v2 offset:6144
v_mfma_f32_16x16x32_bf16 v[32:35], v[94:97], v[58:61], v[32:35]
ds_read_b64_tr_b16 v[94:95], v3 offset:4096
ds_read_b64_tr_b16 v[96:97], v3 offset:6144
v_mfma_f32_16x16x32_bf16 v[36:39], v[98:101], v[58:61], v[36:39]
v_mfma_f32_16x16x32_bf16 v[40:43], v[102:105], v[58:61], v[40:43]
ds_read_b64_tr_b16 v[98:99], v4 offset:4096
ds_read_b64_tr_b16 v[100:101], v4 offset:6144
s_waitcnt vmcnt(6) lgkmcnt(15)
v_mfma_f32_16x16x32_bf16 v[28:31], v[106:109], v[62:65], v[28:31]
s_mov_b32 s61, 0x802000
buffer_load_dwordx4 v[58:61], v48, s[4:7], s61 offen offset:0 sc1
ds_read_b64_tr_b16 v[102:103], v5 offset:4096
ds_read_b64_tr_b16 v[104:105], v5 offset:6144
v_mfma_f32_16x16x32_bf16 v[32:35], v[110:113], v[62:65], v[32:35]
v_mfma_f32_16x16x32_bf16 v[36:39], v[114:117], v[62:65], v[36:39]
ds_read_b64_tr_b16 v[106:107], v2 offset:8192
ds_read_b64_tr_b16 v[108:109], v2 offset:10240
v_mfma_f32_16x16x32_bf16 v[40:43], v[118:121], v[62:65], v[40:43]
s_waitcnt vmcnt(6) lgkmcnt(15)
v_mfma_f32_16x16x32_bf16 v[28:31], v[122:125], v[66:69], v[28:31]
buffer_load_dwordx4 v[62:65], v48, s[4:7], s61 offen offset:1024 sc1
ds_read_b64_tr_b16 v[110:111], v3 offset:8192
ds_read_b64_tr_b16 v[112:113], v3 offset:10240
v_mfma_f32_16x16x32_bf16 v[32:35], v[126:129], v[66:69], v[32:35]
ds_read_b64_tr_b16 v[114:115], v4 offset:8192
ds_read_b64_tr_b16 v[116:117], v4 offset:10240
v_mfma_f32_16x16x32_bf16 v[36:39], v[130:133], v[66:69], v[36:39]
v_mfma_f32_16x16x32_bf16 v[40:43], v[134:137], v[66:69], v[40:43]
ds_read_b64_tr_b16 v[118:119], v5 offset:8192
ds_read_b64_tr_b16 v[120:121], v5 offset:10240
s_waitcnt vmcnt(6) lgkmcnt(15)
v_mfma_f32_16x16x32_bf16 v[28:31], v[138:141], v[70:73], v[28:31]
buffer_load_dwordx4 v[66:69], v48, s[4:7], s61 offen offset:2048 sc1
v_mfma_f32_16x16x32_bf16 v[32:35], v[142:145], v[70:73], v[32:35]
ds_read_b64_tr_b16 v[122:123], v2 offset:12288
ds_read_b64_tr_b16 v[124:125], v2 offset:14336
v_mfma_f32_16x16x32_bf16 v[36:39], v[146:149], v[70:73], v[36:39]
ds_read_b64_tr_b16 v[126:127], v3 offset:12288
ds_read_b64_tr_b16 v[128:129], v3 offset:14336
v_mfma_f32_16x16x32_bf16 v[40:43], v[150:153], v[70:73], v[40:43]
s_waitcnt vmcnt(6) lgkmcnt(15)
v_mfma_f32_16x16x32_bf16 v[28:31], v[154:157], v[74:77], v[28:31]
buffer_load_dwordx4 v[70:73], v48, s[4:7], s61 offen offset:3072 sc1
ds_read_b64_tr_b16 v[130:131], v4 offset:12288
ds_read_b64_tr_b16 v[132:133], v4 offset:14336
v_mfma_f32_16x16x32_bf16 v[32:35], v[158:161], v[74:77], v[32:35]
ds_read_b64_tr_b16 v[134:135], v5 offset:12288
ds_read_b64_tr_b16 v[136:137], v5 offset:14336
v_mfma_f32_16x16x32_bf16 v[36:39], v[162:165], v[74:77], v[36:39]
v_mfma_f32_16x16x32_bf16 v[40:43], v[166:169], v[74:77], v[40:43]
ds_read_b64_tr_b16 v[138:139], v2 offset:16384
ds_read_b64_tr_b16 v[140:141], v2 offset:18432
s_waitcnt vmcnt(6) lgkmcnt(15)
v_mfma_f32_16x16x32_bf16 v[28:31], v[170:173], v[78:81], v[28:31]
s_mov_b32 s61, 0x803000
buffer_load_dwordx4 v[74:77], v49, s[4:7], s61 offen offset:0 sc1
v_mfma_f32_16x16x32_bf16 v[32:35], v[174:177], v[78:81], v[32:35]
ds_read_b64_tr_b16 v[142:143], v3 offset:16384
ds_read_b64_tr_b16 v[144:145], v3 offset:18432
v_mfma_f32_16x16x32_bf16 v[36:39], v[178:181], v[78:81], v[36:39]
ds_read_b64_tr_b16 v[146:147], v4 offset:16384
ds_read_b64_tr_b16 v[148:149], v4 offset:18432
v_mfma_f32_16x16x32_bf16 v[40:43], v[182:185], v[78:81], v[40:43]
s_waitcnt vmcnt(6) lgkmcnt(15)
v_mfma_f32_16x16x32_bf16 v[28:31], v[186:189], v[82:85], v[28:31]
buffer_load_dwordx4 v[78:81], v49, s[4:7], s61 offen offset:1024 sc1
ds_read_b64_tr_b16 v[150:151], v5 offset:16384
ds_read_b64_tr_b16 v[152:153], v5 offset:18432
v_mfma_f32_16x16x32_bf16 v[32:35], v[190:193], v[82:85], v[32:35]
v_mfma_f32_16x16x32_bf16 v[36:39], v[194:197], v[82:85], v[36:39]
ds_read_b64_tr_b16 v[154:155], v2 offset:20480
ds_read_b64_tr_b16 v[156:157], v2 offset:22528
v_mfma_f32_16x16x32_bf16 v[40:43], v[198:201], v[82:85], v[40:43]
ds_read_b64_tr_b16 v[158:159], v3 offset:20480
ds_read_b64_tr_b16 v[160:161], v3 offset:22528
s_waitcnt vmcnt(6) lgkmcnt(15)
v_mfma_f32_16x16x32_bf16 v[28:31], v[202:205], v[86:89], v[28:31]
buffer_load_dwordx4 v[82:85], v49, s[4:7], s61 offen offset:2048 sc1
v_mfma_f32_16x16x32_bf16 v[32:35], v[206:209], v[86:89], v[32:35]
ds_read_b64_tr_b16 v[162:163], v4 offset:20480
ds_read_b64_tr_b16 v[164:165], v4 offset:22528
v_mfma_f32_16x16x32_bf16 v[36:39], v[210:213], v[86:89], v[36:39]
ds_read_b64_tr_b16 v[166:167], v5 offset:20480
ds_read_b64_tr_b16 v[168:169], v5 offset:22528
v_mfma_f32_16x16x32_bf16 v[40:43], v[214:217], v[86:89], v[40:43]
s_waitcnt vmcnt(6) lgkmcnt(15)
v_mfma_f32_16x16x32_bf16 v[28:31], v[90:93], v[58:61], v[28:31]
buffer_load_dwordx4 v[86:89], v49, s[4:7], s61 offen offset:3072 sc1
ds_read_b64_tr_b16 v[170:171], v2 offset:24576
ds_read_b64_tr_b16 v[172:173], v2 offset:26624
v_mfma_f32_16x16x32_bf16 v[32:35], v[94:97], v[58:61], v[32:35]
v_mfma_f32_16x16x32_bf16 v[36:39], v[98:101], v[58:61], v[36:39]
ds_read_b64_tr_b16 v[174:175], v3 offset:24576
ds_read_b64_tr_b16 v[176:177], v3 offset:26624
v_mfma_f32_16x16x32_bf16 v[40:43], v[102:105], v[58:61], v[40:43]
ds_read_b64_tr_b16 v[178:179], v4 offset:24576
ds_read_b64_tr_b16 v[180:181], v4 offset:26624
s_waitcnt vmcnt(6) lgkmcnt(15)
v_mfma_f32_16x16x32_bf16 v[28:31], v[106:109], v[62:65], v[28:31]
buffer_load_dwordx4 a[52:55], v50, s[4:7], s60 offen offset:1024
v_mfma_f32_16x16x32_bf16 v[32:35], v[110:113], v[62:65], v[32:35]
ds_read_b64_tr_b16 v[182:183], v5 offset:24576
ds_read_b64_tr_b16 v[184:185], v5 offset:26624
v_mfma_f32_16x16x32_bf16 v[36:39], v[114:117], v[62:65], v[36:39]
v_mfma_f32_16x16x32_bf16 v[40:43], v[118:121], v[62:65], v[40:43]
ds_read_b64_tr_b16 v[186:187], v2 offset:28672
ds_read_b64_tr_b16 v[188:189], v2 offset:30720
s_waitcnt vmcnt(6) lgkmcnt(15)
v_mfma_f32_16x16x32_bf16 v[28:31], v[122:125], v[66:69], v[28:31]
buffer_load_dwordx4 a[56:59], v50, s[4:7], s60 offen offset:2048
ds_read_b64_tr_b16 v[190:191], v3 offset:28672
ds_read_b64_tr_b16 v[192:193], v3 offset:30720
v_mfma_f32_16x16x32_bf16 v[32:35], v[126:129], v[66:69], v[32:35]
v_mfma_f32_16x16x32_bf16 v[36:39], v[130:133], v[66:69], v[36:39]
ds_read_b64_tr_b16 v[194:195], v4 offset:28672
ds_read_b64_tr_b16 v[196:197], v4 offset:30720
v_mfma_f32_16x16x32_bf16 v[40:43], v[134:137], v[66:69], v[40:43]
ds_read_b64_tr_b16 v[198:199], v5 offset:28672
ds_read_b64_tr_b16 v[200:201], v5 offset:30720
s_waitcnt vmcnt(6) lgkmcnt(15)
v_mfma_f32_16x16x32_bf16 v[28:31], v[138:141], v[70:73], v[28:31]
buffer_load_dwordx4 a[60:63], v50, s[4:7], s60 offen offset:3072
v_mfma_f32_16x16x32_bf16 v[32:35], v[142:145], v[70:73], v[32:35]
ds_read_b64_tr_b16 v[202:203], v2 offset:32768
ds_read_b64_tr_b16 v[204:205], v2 offset:34816
v_mfma_f32_16x16x32_bf16 v[36:39], v[146:149], v[70:73], v[36:39]
v_mfma_f32_16x16x32_bf16 v[40:43], v[150:153], v[70:73], v[40:43]
ds_read_b64_tr_b16 v[206:207], v3 offset:32768
ds_read_b64_tr_b16 v[208:209], v3 offset:34816
s_waitcnt vmcnt(6) lgkmcnt(15)
v_mfma_f32_16x16x32_bf16 v[28:31], v[154:157], v[74:77], v[28:31]
s_add_u32 s60, s55, 32768
buffer_load_dwordx4 a[64:67], v50, s[4:7], s60 offen offset:0
ds_read_b64_tr_b16 v[210:211], v4 offset:32768
ds_read_b64_tr_b16 v[212:213], v4 offset:34816
v_mfma_f32_16x16x32_bf16 v[32:35], v[158:161], v[74:77], v[32:35]
v_mfma_f32_16x16x32_bf16 v[36:39], v[162:165], v[74:77], v[36:39]
ds_read_b64_tr_b16 v[214:215], v5 offset:32768
ds_read_b64_tr_b16 v[216:217], v5 offset:34816
v_mfma_f32_16x16x32_bf16 v[40:43], v[166:169], v[74:77], v[40:43]
s_waitcnt vmcnt(6) lgkmcnt(15)
v_mfma_f32_16x16x32_bf16 v[28:31], v[170:173], v[78:81], v[28:31]
buffer_load_dwordx4 a[68:71], v50, s[4:7], s60 offen offset:1024
v_mfma_f32_16x16x32_bf16 v[32:35], v[174:177], v[78:81], v[32:35]
v_mfma_f32_16x16x32_bf16 v[36:39], v[178:181], v[78:81], v[36:39]
v_mfma_f32_16x16x32_bf16 v[40:43], v[182:185], v[78:81], v[40:43]
s_waitcnt vmcnt(6) lgkmcnt(8)
v_mfma_f32_16x16x32_bf16 v[28:31], v[186:189], v[82:85], v[28:31]
buffer_load_dwordx4 a[72:75], v50, s[4:7], s60 offen offset:2048
v_mfma_f32_16x16x32_bf16 v[32:35], v[190:193], v[82:85], v[32:35]
v_mfma_f32_16x16x32_bf16 v[36:39], v[194:197], v[82:85], v[36:39]
v_mfma_f32_16x16x32_bf16 v[40:43], v[198:201], v[82:85], v[40:43]
s_waitcnt vmcnt(6) lgkmcnt(0)
v_mfma_f32_16x16x32_bf16 v[28:31], v[202:205], v[86:89], v[28:31]
buffer_load_dwordx4 a[76:79], v50, s[4:7], s60 offen offset:3072
v_mfma_f32_16x16x32_bf16 v[32:35], v[206:209], v[86:89], v[32:35]
v_mfma_f32_16x16x32_bf16 v[36:39], v[210:213], v[86:89], v[36:39]
v_mfma_f32_16x16x32_bf16 v[40:43], v[214:217], v[86:89], v[40:43]
s_add_u32 s58, s50, s52
s_add_u32 s58, s58, 0xa00000
s_nop 1
v_cvt_pk_bf16_f32 v106, v28, v29
v_cvt_pk_bf16_f32 v107, v30, v31
v_cvt_pk_bf16_f32 v108, v32, v33
v_cvt_pk_bf16_f32 v109, v34, v35
v_cvt_pk_bf16_f32 v110, v36, v37
v_cvt_pk_bf16_f32 v111, v38, v39
v_cvt_pk_bf16_f32 v112, v40, v41
v_cvt_pk_bf16_f32 v113, v42, v43
s_cmp_lg_u32 s36, 0
s_cbranch_scc1 ALT_132
buffer_store_dwordx4 v[106:109], v1, s[4:7], s58 offen
buffer_store_dwordx4 v[110:113], v1, s[4:7], s58 offen offset:1024
ALTE_133:
v_pk_add_f32 v[242:243], v[28:29], v[30:31]
v_pk_mul_f32 v[244:245], v[28:29], v[28:29]
v_pk_fma_f32 v[244:245], v[30:31], v[30:31], v[244:245]
v_pk_add_f32 v[242:243], v[242:243], v[32:33]
v_pk_fma_f32 v[244:245], v[32:33], v[32:33], v[244:245]
v_pk_add_f32 v[242:243], v[242:243], v[34:35]
v_pk_fma_f32 v[244:245], v[34:35], v[34:35], v[244:245]
v_pk_add_f32 v[242:243], v[242:243], v[36:37]
v_pk_fma_f32 v[244:245], v[36:37], v[36:37], v[244:245]
v_pk_add_f32 v[242:243], v[242:243], v[38:39]
v_pk_fma_f32 v[244:245], v[38:39], v[38:39], v[244:245]
v_pk_add_f32 v[242:243], v[242:243], v[40:41]
v_pk_fma_f32 v[244:245], v[40:41], v[40:41], v[244:245]
v_pk_add_f32 v[242:243], v[242:243], v[42:43]
v_pk_fma_f32 v[244:245], v[42:43], v[42:43], v[244:245]
v_add_f32 v242, v242, v243
v_add_f32 v244, v244, v245
s_nop 1
v_permlane32_swap_b32 v242, v244
v_add_f32 v242, v242, v244
v_mov_b32 v243, v242
s_nop 1
v_permlane16_swap_b32 v242, v243
v_add_f32 v242, v242, v243
s_add_u32 s58, s51, 0x1320000
s_cmp_lg_u32 s36, 0
s_cbranch_scc1 ALT_134
buffer_store_dword v242, v44, s[4:7], s58 offen
v_mov_b32 v11, 11
s_waitcnt vmcnt(0)
s_mov_b64 exec, 1
buffer_store_dword v11, off, s[4:7], s42
s_mov_b64 exec, -1
ALTE_135:
v_pk_add_f32 v[12:13], v[12:13], v[28:29]
v_pk_add_f32 v[14:15], v[14:15], v[30:31]
v_pk_add_f32 v[16:17], v[16:17], v[32:33]
v_pk_add_f32 v[18:19], v[18:19], v[34:35]
v_pk_add_f32 v[20:21], v[20:21], v[36:37]
v_pk_add_f32 v[22:23], v[22:23], v[38:39]
v_pk_add_f32 v[24:25], v[24:25], v[40:41]
v_pk_add_f32 v[26:27], v[26:27], v[42:43]
PH11:
v_lshrrev_b32 v244, 5, v0
v_lshlrev_b32 v245, 4, v244
s_lshl_b32 s58, s34, 8
s_add_u32 s58, s58, 149504
v_add_u32 v245, s58, v245
s_add_u32 s60, s55, 36864
buffer_load_dwordx4 a[80:83], v50, s[4:7], s60 offen offset:0
ds_read_b128 v[154:157], v245 offset:0
ds_read_b128 v[158:161], v245 offset:32
ds_read_b128 v[162:165], v245 offset:64
ds_read_b128 v[166:169], v245 offset:96
ds_read_b128 v[170:173], v245 offset:128
ds_read_b128 v[174:177], v245 offset:160
ds_read_b128 v[178:181], v245 offset:192
ds_read_b128 v[182:185], v245 offset:224
v_and_b32 v245, 16, v0
v_lshlrev_b32 v245, 8, v245
v_lshl_add_u32 v245, v244, 8, v245
v_and_b32 v244, 15, v0
v_lshl_add_u32 v242, v244, 4, v245
v_add_u32 v242, 65536, v242
buffer_load_dwordx4 a[84:87], v50, s[4:7], s60 offen offset:1024
s_mul_i32 s58, s32, 224
s_add_u32 s61, s58, s71
s_lshl_b32 s61, s61, 10
s_add_u32 s61, s61, 0xc00000
s_lshl_b32 s58, s32, 16
s_lshl_b32 s59, s33, 11
s_add_u32 s58, s58, s59
s_add_u32 s58, s58, s73
s_add_u32 s58, s58, 0x800000
s_bitcmp1_b32 s33, 0
s_cselect_b32 s95, s61, s58
s_cselect_b32 s58, 114688, 0
s_cselect_b32 s59, 0, 32768
s_add_u32 s94, s95, s58
s_add_u32 s94, s94, s59
s_lshr_b32 s58, s59, 10
s_mul_i32 s58, s58, 80
v_and_b32 v243, 16, v0
v_mul_u32_u24 v243, s58, v243
buffer_load_dwordx4 a[88:91], v50, s[4:7], s60 offen offset:2048
v_sub_u32 v243, v53, v243
s_lshl_b32 s58, s32, 7
s_add_u32 s58, s58, 0x548000
s_cmp_eq_u32 s32, 0
s_cselect_b32 s59, 0, s44
s_lshl_b32 s59, s59, 5
s_sub_u32 s92, s58, s59
s_cmp_eq_u32 s32, 31
s_cselect_b32 s59, 0, s45
s_lshl_b32 s59, s59, 7
s_add_u32 s93, s58, s59
s_sub_u32 s93, s93, s92
v_bfe_u32 v248, v0, 3, 1
v_mul_u32_u24 v248, s93, v248
v_and_b32 v245, 7, v0
v_lshl_add_u32 v248, v245, 2, v248
v_add_u32 v248, s92, v248
buffer_load_dwordx4 a[92:95], v50, s[4:7], s60 offen offset:3072
s_lshl_b32 s58, s34, 6
s_add_u32 s58, s58, 147456
v_lshlrev_b32 v246, 2, v244
v_add_u32 v246, s58, v246
v_and_b32 v247, 31, v0
v_lshlrev_b32 v247, 2, v247
v_add_u32 v247, 147456, v247
s_add_u32 s60, s55, 40960
buffer_load_dwordx4 a[96:99], v50, s[4:7], s60 offen offset:0
s_waitcnt lgkmcnt(0)
POLL_136:
buffer_load_dword v11, v6, s[4:7], 0 offen sc1
s_waitcnt vmcnt(0)
v_cmp_gt_u32 vcc, 11, v11
s_cbranch_vccz POLLD_137
s_sub_u32 s39, s39, 1
s_cbranch_scc0 POLL_136
s_branch BAIL
POLLD_137:
s_cmp_eq_u32 s34, 3
s_cbranch_scc1 P5W3_138
s_add_u32 s59, s51, 0x1320000
buffer_load_dwordx4 v[226:229], v1, s[4:7], s59 offen sc1
s_add_u32 m0, s74, 65536
s_add_u32 s48, s50, 0xa00000
buffer_load_dwordx4 v1, s[4:7], s48 offen offset:0 sc1 lds
buffer_load_dwordx4 v1, s[4:7], s48 offen offset:1024 sc1 lds
buffer_load_dwordx4 v1, s[4:7], s48 offen offset:2048 sc1 lds
buffer_load_dwordx4 v1, s[4:7], s48 offen offset:3072 sc1 lds
s_add_u32 m0, s74, 81920
s_add_u32 s48, s50, 0xa01000
buffer_load_dwordx4 v1, s[4:7], s48 offen offset:0 sc1 lds
buffer_load_dwordx4 v1, s[4:7], s48 offen offset:1024 sc1 lds
s_waitcnt vmcnt(2)
s_barrier
ds_read_b128 v[122:125], v242 offset:0
ds_read_b128 v[126:129], v242 offset:8192
ds_read_b128 v[130:133], v242 offset:512
ds_read_b128 v[134:137], v242 offset:8704
ds_read_b128 v[138:141], v242 offset:1024
ds_read_b128 v[142:145], v242 offset:9216
s_waitcnt lgkmcnt(4)
v_mfma_f32_32x32x16_bf16 v[58:73], a[224:227], v[122:125], 0
ds_read_b128 v[146:149], v242 offset:1536
buffer_load_dwordx4 v1, s[4:7], s48 offen offset:2048 sc1 lds
v_mfma_f32_32x32x16_bf16 v[74:89], a[224:227], v[126:129], 0
v_add_f32 v226, v226, v228
v_add_f32 v227, v227, v229
s_nop 1
v_permlane32_swap_b32 v226, v227
ds_read_b128 v[150:153], v242 offset:9728
s_waitcnt lgkmcnt(4)
v_mfma_f32_32x32x16_bf16 v[58:73], a[228:231], v[130:133], v[58:73]
v_add_f32 v226, v226, v227
v_mov_b32 v227, v226
s_nop 1
v_permlane16_swap_b32 v226, v227
ds_read_b128 v[122:125], v242 offset:2048
buffer_load_dwordx4 v1, s[4:7], s48 offen offset:3072 sc1 lds
v_mfma_f32_32x32x16_bf16 v[74:89], a[228:231], v[134:137], v[74:89]
v_add_f32 v226, v226, v227
v_mov_b32 v227, v226
s_nop 1
v_permlane32_swap_b32 v226, v227
ds_read_b128 v[126:129], v242 offset:10240
s_waitcnt lgkmcnt(4)
v_mfma_f32_32x32x16_bf16 v[58:73], a[232:235], v[138:141], v[58:73]
v_mul_f32 v244, 0x3b000000, v226
v_mul_f32 v227, 0x3b000000, v227
v_fma_f32 v245, -v244, v244, v227
ds_read_b128 v[130:133], v242 offset:2560
s_add_u32 m0, s74, 98304
s_add_u32 s48, s50, 0xa02000
buffer_load_dwordx4 v1, s[4:7], s48 offen offset:0 sc1 lds
v_mfma_f32_32x32x16_bf16 v[74:89], a[232:235], v[142:145], v[74:89]
v_max_f32 v245, 0, v245
v_add_f32 v245, 0x3727c5ac, v245
v_rsq_f32 v245, v245
ds_read_b128 v[134:137], v242 offset:10752
s_waitcnt lgkmcnt(4)
v_mfma_f32_32x32x16_bf16 v[58:73], a[236:239], v[146:149], v[58:73]
v_sub_f32 v244, 0, v244
ds_write2_b32 v246, v245, v244 offset0:0 offset1:128
ds_read_b128 v[138:141], v242 offset:3072
buffer_load_dwordx4 v1, s[4:7], s48 offen offset:1024 sc1 lds
v_mfma_f32_32x32x16_bf16 v[74:89], a[236:239], v[150:153], v[74:89]
ds_read_b128 v[142:145], v242 offset:11264
s_waitcnt lgkmcnt(5)
v_mfma_f32_32x32x16_bf16 v[58:73], a[240:243], v[122:125], v[58:73]
ds_read_b128 v[146:149], v242 offset:3584
buffer_load_dwordx4 v1, s[4:7], s48 offen offset:2048 sc1 lds
v_mfma_f32_32x32x16_bf16 v[74:89], a[240:243], v[126:129], v[74:89]
ds_read_b128 v[150:153], v242 offset:11776
s_waitcnt lgkmcnt(5)
v_mfma_f32_32x32x16_bf16 v[58:73], a[244:247], v[130:133], v[58:73]
s_waitcnt vmcnt(3)
s_waitcnt lgkmcnt(4)
s_barrier
ds_read2_b32 v[230:231], v247 offset0:0 offset1:128
ds_read2_b32 v[236:237], v247 offset0:32 offset1:160
ds_read_b128 v[122:125], v242 offset:16384
buffer_load_dwordx4 v1, s[4:7], s48 offen offset:3072 sc1 lds
v_mfma_f32_32x32x16_bf16 v[74:89], a[244:247], v[134:137], v[74:89]
ds_read_b128 v[126:129], v242 offset:24576
s_waitcnt lgkmcnt(6)
v_mfma_f32_32x32x16_bf16 v[58:73], a[248:251], v[138:141], v[58:73]
ds_read_b128 v[130:133], v242 offset:16896
s_add_u32 m0, s74, 114688
s_add_u32 s48, s50, 0xa03000
buffer_load_dwordx4 v1, s[4:7], s48 offen offset:0 sc1 lds
v_mfma_f32_32x32x16_bf16 v[74:89], a[248:251], v[142:145], v[74:89]
ds_read_b128 v[134:137], v242 offset:25088
s_waitcnt lgkmcnt(6)
v_mfma_f32_32x32x16_bf16 v[58:73], a[252:255], v[146:149], v[58:73]
ds_read_b128 v[138:141], v242 offset:17408
buffer_load_dwordx4 v1, s[4:7], s48 offen offset:1024 sc1 lds
v_mfma_f32_32x32x16_bf16 v[74:89], a[252:255], v[150:153], v[74:89]
ds_read_b128 v[142:145], v242 offset:25600
s_waitcnt lgkmcnt(4)
v_mfma_f32_32x32x16_bf16 v[58:73], a[192:195], v[122:125], v[58:73]
ds_read_b128 v[146:149], v242 offset:17920
buffer_load_dwordx4 v1, s[4:7], s48 offen offset:2048 sc1 lds
v_rcp_f32 v234, v230
v_mfma_f32_32x32x16_bf16 v[74:89], a[192:195], v[126:129], v[74:89]
ds_read_b128 v[150:153], v242 offset:26112
s_waitcnt lgkmcnt(4)
v_mfma_f32_32x32x16_bf16 v[58:73], a[196:199], v[130:133], v[58:73]
ds_read_b128 v[122:125], v242 offset:18432
buffer_load_dwordx4 v1, s[4:7], s48 offen offset:3072 sc1 lds
v_mul_f32 v232, 0xc0135761, v230
v_mfma_f32_32x32x16_bf16 v[74:89], a[196:199], v[134:137], v[74:89]
ds_read_b128 v[126:129], v242 offset:26624
v_mul_f32 v230, v230, v230
s_waitcnt lgkmcnt(4)
v_mfma_f32_32x32x16_bf16 v[58:73], a[200:203], v[138:141], v[58:73]
ds_read_b128 v[130:133], v242 offset:18944
buffer_load_dword v255, v248, s[4:7], 0 offen sc1
v_mul_f32 v233, 0x3d372713, v230
v_mfma_f32_32x32x16_bf16 v[74:89], a[200:203], v[142:145], v[74:89]
ds_read_b128 v[134:137], v242 offset:27136
v_mul_f32 v233, v233, v232
s_waitcnt lgkmcnt(4)
v_mfma_f32_32x32x16_bf16 v[58:73], a[204:207], v[146:149], v[58:73]
ds_read_b128 v[138:141], v242 offset:19456
buffer_load_dwordx4 a[100:103], v50, s[4:7], s60 offen offset:1024
v_rcp_f32 v240, v236
v_mfma_f32_32x32x16_bf16 v[74:89], a[204:207], v[150:153], v[74:89]
ds_read_b128 v[142:145], v242 offset:27648
s_waitcnt lgkmcnt(4)
v_mfma_f32_32x32x16_bf16 v[58:73], a[208:211], v[122:125], v[58:73]
ds_read_b128 v[146:149], v242 offset:19968
buffer_load_dwordx4 a[104:107], v50, s[4:7], s60 offen offset:2048
v_mul_f32 v238, 0xc0135761, v236
v_mfma_f32_32x32x16_bf16 v[74:89], a[208:211], v[126:129], v[74:89]
ds_read_b128 v[150:153], v242 offset:28160
v_mul_f32 v236, v236, v236
s_waitcnt lgkmcnt(4)
v_mfma_f32_32x32x16_bf16 v[58:73], a[212:215], v[130:133], v[58:73]
s_waitcnt vmcnt(7)
s_barrier
ds_read_b128 v[122:125], v242 offset:32768
buffer_load_dwordx4 a[108:111], v50, s[4:7], s60 offen offset:3072
v_mul_f32 v239, 0x3d372713, v236
v_mfma_f32_32x32x16_bf16 v[74:89], a[212:215], v[134:137], v[74:89]
ds_read_b128 v[126:129], v242 offset:40960
v_mul_f32 v239, v239, v238
s_waitcnt lgkmcnt(4)
v_mfma_f32_32x32x16_bf16 v[58:73], a[216:219], v[138:141], v[58:73]
ds_read_b128 v[130:133], v242 offset:33280
s_add_u32 s60, s55, 45056
buffer_load_dwordx4 a[112:115], v50, s[4:7], s60 offen offset:0
v_mul_f32 v90, v170, v231
v_mfma_f32_32x32x16_bf16 v[74:89], a[216:219], v[142:145], v[74:89]
ds_read_b128 v[134:137], v242 offset:41472
v_mul_f32 v91, v171, v231
s_waitcnt lgkmcnt(4)
v_mfma_f32_32x32x16_bf16 v[58:73], a[220:223], v[146:149], v[58:73]
ds_read_b128 v[138:141], v242 offset:33792
buffer_load_dwordx4 a[116:119], v50, s[4:7], s60 offen offset:1024
v_mul_f32 v92, v172, v231
v_mfma_f32_32x32x16_bf16 v[74:89], a[220:223], v[150:153], v[74:89]
ds_read_b128 v[142:145], v242 offset:41984
v_mul_f32 v93, v173, v231
s_waitcnt lgkmcnt(4)
v_mfma_f32_32x32x16_bf16 v[58:73], a[0:3], v[122:125], v[58:73]
ds_read_b128 v[146:149], v242 offset:34304
buffer_load_dwordx4 a[120:123], v50, s[4:7], s60 offen offset:2048
v_mul_f32 v94, v174, v231
v_mfma_f32_32x32x16_bf16 v[74:89], a[0:3], v[126:129], v[74:89]
ds_read_b128 v[150:153], v242 offset:42496
v_mul_f32 v95, v175, v231
s_waitcnt lgkmcnt(4)
v_mfma_f32_32x32x16_bf16 v[58:73], a[4:7], v[130:133], v[58:73]
ds_read_b128 v[122:125], v242 offset:34816
buffer_load_dwordx4 a[124:127], v50, s[4:7], s60 offen offset:3072
v_mul_f32 v96, v176, v231
v_mfma_f32_32x32x16_bf16 v[74:89], a[4:7], v[134:137], v[74:89]
ds_read_b128 v[126:129], v242 offset:43008
v_mul_f32 v97, v177, v231
s_waitcnt lgkmcnt(4)
v_mfma_f32_32x32x16_bf16 v[58:73], a[8:11], v[138:141], v[58:73]
ds_read_b128 v[130:133], v242 offset:35328
s_add_u32 s60, s55, 49152
buffer_load_dwordx4 a[128:131], v50, s[4:7], s60 offen offset:0
v_mul_f32 v98, v178, v231
v_mfma_f32_32x32x16_bf16 v[74:89], a[8:11], v[142:145], v[74:89]
ds_read_b128 v[134:137], v242 offset:43520
v_mul_f32 v99, v179, v231
s_waitcnt lgkmcnt(4)
v_mfma_f32_32x32x16_bf16 v[58:73], a[12:15], v[146:149], v[58:73]
ds_read_b128 v[138:141], v242 offset:35840
buffer_load_dwordx4 a[132:135], v50, s[4:7], s60 offen offset:1024
v_mul_f32 v100, v180, v231
v_mfma_f32_32x32x16_bf16 v[74:89], a[12:15], v[150:153], v[74:89]
ds_read_b128 v[142:145], v242 offset:44032
v_mul_f32 v101, v181, v231
s_waitcnt lgkmcnt(4)
v_mfma_f32_32x32x16_bf16 v[58:73], a[16:19], v[122:125], v[58:73]
ds_read_b128 v[146:149], v242 offset:36352
buffer_load_dwordx4 a[136:139], v50, s[4:7], s60 offen offset:2048
v_mul_f32 v102, v182, v231
v_mfma_f32_32x32x16_bf16 v[74:89], a[16:19], v[126:129], v[74:89]
ds_read_b128 v[150:153], v242 offset:44544
v_mul_f32 v103, v183, v231
s_waitcnt lgkmcnt(4)
v_mfma_f32_32x32x16_bf16 v[58:73], a[20:23], v[130:133], v[58:73]
s_waitcnt vmcnt(11)
s_barrier
ds_read_b128 v[122:125], v242 offset:49152
buffer_load_dwordx4 a[140:143], v50, s[4:7], s60 offen offset:3072
v_mul_f32 v104, v184, v231
v_mfma_f32_32x32x16_bf16 v[74:89], a[20:23], v[134:137], v[74:89]
ds_read_b128 v[126:129], v242 offset:57344
v_mul_f32 v105, v185, v231
s_waitcnt lgkmcnt(4)
v_mfma_f32_32x32x16_bf16 v[58:73], a[24:27], v[138:141], v[58:73]
ds_read_b128 v[130:133], v242 offset:49664
s_add_u32 s60, s55, 53248
buffer_load_dwordx4 a[144:147], v50, s[4:7], s60 offen offset:0
v_mul_f32 v106, v170, v237
v_mfma_f32_32x32x16_bf16 v[74:89], a[24:27], v[142:145], v[74:89]
ds_read_b128 v[134:137], v242 offset:57856
v_mul_f32 v107, v171, v237
s_waitcnt lgkmcnt(4)
v_mfma_f32_32x32x16_bf16 v[58:73], a[28:31], v[146:149], v[58:73]
ds_read_b128 v[138:141], v242 offset:50176
buffer_load_dwordx4 a[148:151], v50, s[4:7], s60 offen offset:1024
v_mul_f32 v108, v172, v237
v_mfma_f32_32x32x16_bf16 v[74:89], a[28:31], v[150:153], v[74:89]
ds_read_b128 v[142:145], v242 offset:58368
v_mul_f32 v109, v173, v237
s_waitcnt lgkmcnt(4)
v_mfma_f32_32x32x16_bf16 v[58:73], a[32:35], v[122:125], v[58:73]
ds_read_b128 v[146:149], v242 offset:50688
buffer_load_dwordx4 a[152:155], v50, s[4:7], s60 offen offset:2048
v_mul_f32 v110, v174, v237
v_mfma_f32_32x32x16_bf16 v[74:89], a[32:35], v[126:129], v[74:89]
ds_read_b128 v[150:153], v242 offset:58880
v_mul_f32 v111, v175, v237
s_waitcnt lgkmcnt(4)
v_mfma_f32_32x32x16_bf16 v[58:73], a[36:39], v[130:133], v[58:73]
ds_read_b128 v[122:125], v242 offset:51200
buffer_load_dwordx4 a[156:159], v50, s[4:7], s60 offen offset:3072
v_mul_f32 v112, v176, v237
v_mfma_f32_32x32x16_bf16 v[74:89], a[36:39], v[134:137], v[74:89]
ds_read_b128 v[126:129], v242 offset:59392
v_mul_f32 v113, v177, v237
s_waitcnt lgkmcnt(4)
v_mfma_f32_32x32x16_bf16 v[58:73], a[40:43], v[138:141], v[58:73]
ds_read_b128 v[130:133], v242 offset:51712
s_add_u32 s60, s55, 57344
buffer_load_dwordx4 a[160:163], v50, s[4:7], s60 offen offset:0
v_mul_f32 v114, v178, v237
v_mfma_f32_32x32x16_bf16 v[74:89], a[40:43], v[142:145], v[74:89]
ds_read_b128 v[134:137], v242 offset:59904
v_mul_f32 v115, v179, v237
s_waitcnt lgkmcnt(4)
v_mfma_f32_32x32x16_bf16 v[58:73], a[44:47], v[146:149], v[58:73]
ds_read_b128 v[138:141], v242 offset:52224
buffer_load_dwordx4 a[164:167], v50, s[4:7], s60 offen offset:1024
v_mul_f32 v116, v180, v237
v_mfma_f32_32x32x16_bf16 v[74:89], a[44:47], v[150:153], v[74:89]
ds_read_b128 v[142:145], v242 offset:60416
v_mul_f32 v117, v181, v237
s_waitcnt lgkmcnt(4)
v_mfma_f32_32x32x16_bf16 v[58:73], a[48:51], v[122:125], v[58:73]
ds_read_b128 v[146:149], v242 offset:52736
buffer_load_dwordx4 a[168:171], v50, s[4:7], s60 offen offset:2048
v_mul_f32 v118, v182, v237
v_mfma_f32_32x32x16_bf16 v[74:89], a[48:51], v[126:129], v[74:89]
ds_read_b128 v[150:153], v242 offset:60928
v_mul_f32 v119, v183, v237
s_waitcnt lgkmcnt(4)
v_mfma_f32_32x32x16_bf16 v[58:73], a[52:55], v[130:133], v[58:73]
ds_read_b128 v[122:125], v242 offset:0
buffer_load_dwordx4 a[172:175], v50, s[4:7], s60 offen offset:3072
v_mul_f32 v120, v184, v237
v_mfma_f32_32x32x16_bf16 v[74:89], a[52:55], v[134:137], v[74:89]
ds_read_b128 v[126:129], v242 offset:8192
v_mul_f32 v121, v185, v237
s_waitcnt lgkmcnt(4)
v_mfma_f32_32x32x16_bf16 v[58:73], a[56:59], v[138:141], v[58:73]
ds_read_b128 v[130:133], v242 offset:512
s_add_u32 s60, s55, 61440
buffer_load_dwordx4 a[176:179], v50, s[4:7], s60 offen offset:0
v_mfma_f32_32x32x16_bf16 v[74:89], a[56:59], v[142:145], v[74:89]
ds_read_b128 v[134:137], v242 offset:1024
s_waitcnt lgkmcnt(4)
v_mfma_f32_32x32x16_bf16 v[58:73], a[60:63], v[146:149], v[58:73]
ds_read_b128 v[138:141], v242 offset:8704
buffer_load_dwordx4 a[180:183], v50, s[4:7], s60 offen offset:1024
v_mfma_f32_32x32x16_bf16 v[74:89], a[60:63], v[150:153], v[74:89]
ds_read_b128 v[142:145], v242 offset:1536
s_waitcnt vmcnt(21)
ACK_140:
v_cmp_gt_u32 vcc, 11, v255
s_cbranch_vccz ACKD_141
buffer_load_dword v255, v248, s[4:7], 0 offen sc1
s_waitcnt vmcnt(0)
s_sub_u32 s39, s39, 1
s_cbranch_scc0 ACK_140
s_branch BAIL
ACKD_141:
s_waitcnt lgkmcnt(4)
v_mfma_f32_32x32x16_bf16 v[90:105], a[64:67], v[122:125], v[90:105]
ds_read_b128 v[146:149], v242 offset:9216
v_mfma_f32_32x32x16_bf16 v[106:121], a[64:67], v[126:129], v[106:121]
ds_read_b128 v[150:153], v242 offset:2048
buffer_load_dwordx4 a[184:187], v50, s[4:7], s60 offen offset:2048
s_waitcnt lgkmcnt(4)
v_mfma_f32_32x32x16_bf16 v[90:105], a[68:71], v[130:133], v[90:105]
ds_read_b128 v[122:125], v242 offset:2560
v_mfma_f32_32x32x16_bf16 v[90:105], a[72:75], v[134:137], v[90:105]
ds_read_b128 v[126:129], v242 offset:9728
buffer_load_dwordx4 a[188:191], v50, s[4:7], s60 offen offset:3072
v_fma_f32 v202, v154, v231, v58
v_fma_f32 v203, v155, v231, v59
v_fma_f32 v204, v156, v231, v60
v_fma_f32 v205, v157, v231, v61
v_fma_f32 v206, v158, v231, v62
v_fma_f32 v207, v159, v231, v63
v_fma_f32 v208, v160, v231, v64
v_fma_f32 v209, v161, v231, v65
v_mul_f32 v186, v202, v202
v_mul_f32 v187, v203, v203
s_waitcnt lgkmcnt(4)
v_mfma_f32_32x32x16_bf16 v[106:121], a[68:71], v[138:141], v[106:121]
ds_read_b128 v[130:133], v242 offset:3072
s_add_u32 s60, s49, 0
buffer_load_dwordx4 a[224:227], v50, s[4:7], s60 offen offset:0
v_mul_f32 v188, v204, v204
v_mul_f32 v189, v205, v205
v_mul_f32 v190, v206, v206
v_mul_f32 v191, v207, v207
v_mul_f32 v192, v208, v208
v_mul_f32 v193, v209, v209
v_fma_f32 v186, v186, v233, v232
v_fma_f32 v187, v187, v233, v232
v_fma_f32 v188, v188, v233, v232
v_mfma_f32_32x32x16_bf16 v[90:105], a[76:79], v[142:145], v[90:105]
ds_read_b128 v[134:137], v242 offset:10240
buffer_load_dwordx4 a[228:231], v50, s[4:7], s60 offen offset:1024
v_fma_f32 v189, v189, v233, v232
v_fma_f32 v190, v190, v233, v232
v_fma_f32 v191, v191, v233, v232
v_fma_f32 v192, v192, v233, v232
v_fma_f32 v193, v193, v233, v232
v_mul_f32 v186, v186, v202
v_mul_f32 v187, v187, v203
v_mul_f32 v188, v188, v204
v_mul_f32 v189, v189, v205
v_mul_f32 v190, v190, v206
s_waitcnt lgkmcnt(4)
v_mfma_f32_32x32x16_bf16 v[106:121], a[72:75], v[146:149], v[106:121]
ds_read_b128 v[138:141], v242 offset:3584
buffer_load_dwordx4 a[232:235], v50, s[4:7], s60 offen offset:2048
v_mul_f32 v191, v191, v207
v_mul_f32 v192, v192, v208
v_mul_f32 v193, v193, v209
v_exp_f32 v186, v186
v_exp_f32 v187, v187
v_exp_f32 v188, v188
v_mfma_f32_32x32x16_bf16 v[90:105], a[80:83], v[150:153], v[90:105]
ds_read_b128 v[142:145], v242 offset:16384
v_exp_f32 v189, v189
v_exp_f32 v190, v190
v_exp_f32 v191, v191
v_exp_f32 v192, v192
v_exp_f32 v193, v193
s_waitcnt lgkmcnt(4)
v_mfma_f32_32x32x16_bf16 v[90:105], a[84:87], v[122:125], v[90:105]
ds_read_b128 v[146:149], v242 offset:10752
buffer_load_dwordx4 a[236:239], v50, s[4:7], s60 offen offset:3072
v_fma_f32 v186, v186, v234, v234
v_fma_f32 v187, v187, v234, v234
v_fma_f32 v188, v188, v234, v234
v_fma_f32 v189, v189, v234, v234
v_fma_f32 v190, v190, v234, v234
v_fma_f32 v191, v191, v234, v234
v_fma_f32 v192, v192, v234, v234
v_fma_f32 v193, v193, v234, v234
v_rcp_f32 v186, v186
v_mfma_f32_32x32x16_bf16 v[106:121], a[76:79], v[126:129], v[106:121]
ds_read_b128 v[150:153], v242 offset:16896
s_add_u32 s60, s49, 4096
buffer_load_dwordx4 a[240:243], v50, s[4:7], s60 offen offset:0
v_rcp_f32 v187, v187
v_rcp_f32 v188, v188
v_rcp_f32 v189, v189
v_rcp_f32 v190, v190
v_rcp_f32 v191, v191
s_waitcnt lgkmcnt(4)
v_mfma_f32_32x32x16_bf16 v[90:105], a[88:91], v[130:133], v[90:105]
ds_read_b128 v[122:125], v242 offset:17408
buffer_load_dwordx4 a[244:247], v50, s[4:7], s60 offen offset:1024
v_rcp_f32 v192, v192
v_rcp_f32 v193, v193
v_mul_f32 v186, v202, v186
v_mul_f32 v187, v203, v187
v_mul_f32 v188, v204, v188
v_mul_f32 v189, v205, v189
v_mul_f32 v190, v206, v190
v_mfma_f32_32x32x16_bf16 v[106:121], a[80:83], v[134:137], v[106:121]
ds_read_b128 v[126:129], v242 offset:11264
v_mul_f32 v191, v207, v191
v_mul_f32 v192, v208, v192
v_mul_f32 v193, v209, v193
v_cvt_pk_bf16_f32 v218, v186, v187
v_cvt_pk_bf16_f32 v219, v188, v189
v_cvt_pk_bf16_f32 v220, v190, v191
v_cvt_pk_bf16_f32 v221, v192, v193
s_cmp_lg_u32 s36, 0
s_cbranch_scc1 ALT_142
buffer_store_dwordx4 v[218:221], v243, s[4:7], s95 offen offset:0
ALTE_143:
s_waitcnt lgkmcnt(4)
v_mfma_f32_32x32x16_bf16 v[90:105], a[92:95], v[138:141], v[90:105]
ds_read_b128 v[130:133], v242 offset:17920
v_fma_f32 v210, v162, v231, v66
v_fma_f32 v211, v163, v231, v67
v_fma_f32 v212, v164, v231, v68
v_fma_f32 v213, v165, v231, v69
v_fma_f32 v214, v166, v231, v70
v_fma_f32 v215, v167, v231, v71
v_fma_f32 v216, v168, v231, v72
v_fma_f32 v217, v169, v231, v73
v_mul_f32 v194, v210, v210
v_mul_f32 v195, v211, v211
v_mfma_f32_32x32x16_bf16 v[90:105], a[96:99], v[142:145], v[90:105]
ds_read_b128 v[134:137], v242 offset:11776
buffer_load_dwordx4 a[248:251], v50, s[4:7], s60 offen offset:2048
v_mul_f32 v196, v212, v212
v_mul_f32 v197, v213, v213
v_mul_f32 v198, v214, v214
v_mul_f32 v199, v215, v215
v_mul_f32 v200, v216, v216
v_mul_f32 v201, v217, v217
v_fma_f32 v194, v194, v233, v232
v_fma_f32 v195, v195, v233, v232
v_fma_f32 v196, v196, v233, v232
s_waitcnt lgkmcnt(4)
v_mfma_f32_32x32x16_bf16 v[106:121], a[84:87], v[146:149], v[106:121]
ds_read_b128 v[138:141], v242 offset:18432
buffer_load_dwordx4 a[252:255], v50, s[4:7], s60 offen offset:3072
v_fma_f32 v197, v197, v233, v232
v_fma_f32 v198, v198, v233, v232
v_fma_f32 v199, v199, v233, v232
v_fma_f32 v200, v200, v233, v232
v_fma_f32 v201, v201, v233, v232
v_mul_f32 v194, v194, v210
v_mul_f32 v195, v195, v211
v_mul_f32 v196, v196, v212
v_mul_f32 v197, v197, v213
v_mul_f32 v198, v198, v214
s_waitcnt vmcnt(31)
v_mfma_f32_32x32x16_bf16 v[90:105], a[100:103], v[150:153], v[90:105]
ds_read_b128 v[142:145], v242 offset:18944
s_add_u32 s60, s49, 8192
buffer_load_dwordx4 a[192:195], v50, s[4:7], s60 offen offset:0
v_mul_f32 v199, v199, v215
v_mul_f32 v200, v200, v216
v_mul_f32 v201, v201, v217
v_exp_f32 v194, v194
v_exp_f32 v195, v195
v_exp_f32 v196, v196
s_waitcnt vmcnt(31)
s_waitcnt lgkmcnt(4)
v_mfma_f32_32x32x16_bf16 v[90:105], a[104:107], v[122:125], v[90:105]
ds_read_b128 v[146:149], v242 offset:24576
buffer_load_dwordx4 a[196:199], v50, s[4:7], s60 offen offset:1024
v_exp_f32 v197, v197
v_exp_f32 v198, v198
v_exp_f32 v199, v199
v_exp_f32 v200, v200
v_exp_f32 v201, v201
v_mfma_f32_32x32x16_bf16 v[106:121], a[88:91], v[126:129], v[106:121]
ds_read_b128 v[150:153], v242 offset:19456
buffer_load_dwordx4 a[200:203], v50, s[4:7], s60 offen offset:2048
v_fma_f32 v194, v194, v234, v234
v_fma_f32 v195, v195, v234, v234
v_fma_f32 v196, v196, v234, v234
v_fma_f32 v197, v197, v234, v234
v_fma_f32 v198, v198, v234, v234
v_fma_f32 v199, v199, v234, v234
v_fma_f32 v200, v200, v234, v234
v_fma_f32 v201, v201, v234, v234
v_rcp_f32 v194, v194
s_waitcnt vmcnt(32)
s_waitcnt lgkmcnt(4)
v_mfma_f32_32x32x16_bf16 v[90:105], a[108:111], v[130:133], v[90:105]
ds_read_b128 v[122:125], v242 offset:25088
buffer_load_dwordx4 a[204:207], v50, s[4:7], s60 offen offset:3072
v_rcp_f32 v195, v195
v_rcp_f32 v196, v196
v_rcp_f32 v197, v197
v_rcp_f32 v198, v198
v_rcp_f32 v199, v199
v_mfma_f32_32x32x16_bf16 v[106:121], a[92:95], v[134:137], v[106:121]
ds_read_b128 v[126:129], v242 offset:19968
s_add_u32 s60, s49, 12288
buffer_load_dwordx4 a[208:211], v50, s[4:7], s60 offen offset:0
v_rcp_f32 v200, v200
v_rcp_f32 v201, v201
v_mul_f32 v194, v210, v194
v_mul_f32 v195, v211, v195
v_mul_f32 v196, v212, v196
v_mul_f32 v197, v213, v197
v_mul_f32 v198, v214, v198
s_waitcnt vmcnt(33)
s_waitcnt lgkmcnt(4)
v_mfma_f32_32x32x16_bf16 v[90:105], a[112:115], v[138:141], v[90:105]
ds_read_b128 v[130:133], v242 offset:32768
buffer_load_dwordx4 a[212:215], v50, s[4:7], s60 offen offset:1024
v_mul_f32 v199, v215, v199
v_mul_f32 v200, v216, v200
v_mul_f32 v201, v217, v201
v_cvt_pk_bf16_f32 v222, v194, v195
v_cvt_pk_bf16_f32 v223, v196, v197
v_cvt_pk_bf16_f32 v224, v198, v199
v_cvt_pk_bf16_f32 v225, v200, v201
s_cmp_lg_u32 s36, 0
s_cbranch_scc1 ALT_144
buffer_store_dwordx4 v[222:225], v243, s[4:7], s95 offen offset:512
ALTE_145:
s_waitcnt vmcnt(34)
v_mfma_f32_32x32x16_bf16 v[90:105], a[116:119], v[142:145], v[90:105]
ds_read_b128 v[134:137], v242 offset:25600
v_fma_f32 v202, v154, v237, v74
v_fma_f32 v203, v155, v237, v75
v_fma_f32 v204, v156, v237, v76
v_fma_f32 v205, v157, v237, v77
v_fma_f32 v206, v158, v237, v78
v_fma_f32 v207, v159, v237, v79
v_fma_f32 v208, v160, v237, v80
v_fma_f32 v209, v161, v237, v81
v_mul_f32 v186, v202, v202
v_mul_f32 v187, v203, v203
s_waitcnt lgkmcnt(4)
v_mfma_f32_32x32x16_bf16 v[106:121], a[96:99], v[146:149], v[106:121]
ds_read_b128 v[138:141], v242 offset:33280
buffer_load_dwordx4 a[216:219], v50, s[4:7], s60 offen offset:2048
v_mul_f32 v188, v204, v204
v_mul_f32 v189, v205, v205
v_mul_f32 v190, v206, v206
v_mul_f32 v191, v207, v207
v_mul_f32 v192, v208, v208
v_mul_f32 v193, v209, v209
v_fma_f32 v186, v186, v239, v238
v_fma_f32 v187, v187, v239, v238
v_fma_f32 v188, v188, v239, v238
s_waitcnt vmcnt(34)
v_mfma_f32_32x32x16_bf16 v[90:105], a[120:123], v[150:153], v[90:105]
ds_read_b128 v[142:145], v242 offset:33792
buffer_load_dwordx4 a[220:223], v50, s[4:7], s60 offen offset:3072
v_fma_f32 v189, v189, v239, v238
v_fma_f32 v190, v190, v239, v238
v_fma_f32 v191, v191, v239, v238
v_fma_f32 v192, v192, v239, v238
v_fma_f32 v193, v193, v239, v238
v_mul_f32 v186, v186, v202
v_mul_f32 v187, v187, v203
v_mul_f32 v188, v188, v204
v_mul_f32 v189, v189, v205
v_mul_f32 v190, v190, v206
s_waitcnt lgkmcnt(4)
v_mfma_f32_32x32x16_bf16 v[106:121], a[100:103], v[122:125], v[106:121]
ds_read_b128 v[146:149], v242 offset:26112
s_add_u32 s60, s49, 16384
buffer_load_dwordx4 a[0:3], v50, s[4:7], s60 offen offset:0
v_mul_f32 v191, v191, v207
v_mul_f32 v192, v192, v208
v_mul_f32 v193, v193, v209
v_exp_f32 v186, v186
v_exp_f32 v187, v187
v_exp_f32 v188, v188
s_waitcnt vmcnt(35)
v_mfma_f32_32x32x16_bf16 v[90:105], a[124:127], v[126:129], v[90:105]
ds_read_b128 v[150:153], v242 offset:34304
buffer_load_dwordx4 a[4:7], v50, s[4:7], s60 offen offset:1024
v_exp_f32 v189, v189
v_exp_f32 v190, v190
v_exp_f32 v191, v191
v_exp_f32 v192, v192
v_exp_f32 v193, v193
s_waitcnt vmcnt(35)
s_waitcnt lgkmcnt(4)
v_mfma_f32_32x32x16_bf16 v[90:105], a[128:131], v[130:133], v[90:105]
ds_read_b128 v[122:125], v242 offset:26624
buffer_load_dwordx4 a[8:11], v50, s[4:7], s60 offen offset:2048
v_fma_f32 v186, v186, v240, v240
v_fma_f32 v187, v187, v240, v240
v_fma_f32 v188, v188, v240, v240
v_fma_f32 v189, v189, v240, v240
v_fma_f32 v190, v190, v240, v240
v_fma_f32 v191, v191, v240, v240
v_fma_f32 v192, v192, v240, v240
v_fma_f32 v193, v193, v240, v240
v_rcp_f32 v186, v186
v_mfma_f32_32x32x16_bf16 v[106:121], a[104:107], v[134:137], v[106:121]
ds_read_b128 v[126:129], v242 offset:34816
buffer_load_dwordx4 a[12:15], v50, s[4:7], s60 offen offset:3072
v_rcp_f32 v187, v187
v_rcp_f32 v188, v188
v_rcp_f32 v189, v189
v_rcp_f32 v190, v190
v_rcp_f32 v191, v191
s_waitcnt vmcnt(36)
s_waitcnt lgkmcnt(4)
v_mfma_f32_32x32x16_bf16 v[90:105], a[132:135], v[138:141], v[90:105]
ds_read_b128 v[130:133], v242 offset:35328
s_add_u32 s60, s49, 20480
buffer_load_dwordx4 a[16:19], v50, s[4:7], s60 offen offset:0
v_rcp_f32 v192, v192
v_rcp_f32 v193, v193
v_mul_f32 v186, v202, v186
v_mul_f32 v187, v203, v187
v_mul_f32 v188, v204, v188
v_mul_f32 v189, v205, v189
v_mul_f32 v190, v206, v190
s_waitcnt vmcnt(36)
v_mfma_f32_32x32x16_bf16 v[90:105], a[136:139], v[142:145], v[90:105]
ds_read_b128 v[134:137], v242 offset:27136
buffer_load_dwordx4 a[20:23], v50, s[4:7], s60 offen offset:1024
v_mul_f32 v191, v207, v191
v_mul_f32 v192, v208, v192
v_mul_f32 v193, v209, v193
v_cvt_pk_bf16_f32 v218, v186, v187
v_cvt_pk_bf16_f32 v219, v188, v189
v_cvt_pk_bf16_f32 v220, v190, v191
v_cvt_pk_bf16_f32 v221, v192, v193
s_cmp_lg_u32 s36, 0
s_cbranch_scc1 ALT_146
buffer_store_dwordx4 v[218:221], v243, s[4:7], s94 offen offset:0
ALTE_147:
s_waitcnt lgkmcnt(4)
v_mfma_f32_32x32x16_bf16 v[106:121], a[108:111], v[146:149], v[106:121]
ds_read_b128 v[138:141], v242 offset:35840
v_fma_f32 v210, v162, v237, v82
v_fma_f32 v211, v163, v237, v83
v_fma_f32 v212, v164, v237, v84
v_fma_f32 v213, v165, v237, v85
v_fma_f32 v214, v166, v237, v86
v_fma_f32 v215, v167, v237, v87
v_fma_f32 v216, v168, v237, v88
v_fma_f32 v217, v169, v237, v89
v_mul_f32 v194, v210, v210
v_mul_f32 v195, v211, v211
s_waitcnt vmcnt(37)
v_mfma_f32_32x32x16_bf16 v[90:105], a[140:143], v[150:153], v[90:105]
ds_read_b128 v[142:145], v242 offset:27648
buffer_load_dwordx4 a[24:27], v50, s[4:7], s60 offen offset:2048
v_mul_f32 v196, v212, v212
v_mul_f32 v197, v213, v213
v_mul_f32 v198, v214, v214
v_mul_f32 v199, v215, v215
v_mul_f32 v200, v216, v216
v_mul_f32 v201, v217, v217
v_fma_f32 v194, v194, v239, v238
v_fma_f32 v195, v195, v239, v238
v_fma_f32 v196, v196, v239, v238
s_waitcnt lgkmcnt(4)
v_mfma_f32_32x32x16_bf16 v[106:121], a[112:115], v[122:125], v[106:121]
ds_read_b128 v[146:149], v242 offset:36352
buffer_load_dwordx4 a[28:31], v50, s[4:7], s60 offen offset:3072
v_fma_f32 v197, v197, v239, v238
v_fma_f32 v198, v198, v239, v238
v_fma_f32 v199, v199, v239, v238
v_fma_f32 v200, v200, v239, v238
v_fma_f32 v201, v201, v239, v238
v_mul_f32 v194, v194, v210
v_mul_f32 v195, v195, v211
v_mul_f32 v196, v196, v212
v_mul_f32 v197, v197, v213
v_mul_f32 v198, v198, v214
s_waitcnt vmcnt(38)
v_mfma_f32_32x32x16_bf16 v[90:105], a[144:147], v[126:129], v[90:105]
ds_read_b128 v[150:153], v242 offset:49152
s_add_u32 s60, s49, 24576
buffer_load_dwordx4 a[32:35], v50, s[4:7], s60 offen offset:0
v_mul_f32 v199, v199, v215
v_mul_f32 v200, v200, v216
v_mul_f32 v201, v201, v217
v_exp_f32 v194, v194
v_exp_f32 v195, v195
v_exp_f32 v196, v196
s_waitcnt vmcnt(38)
s_waitcnt lgkmcnt(4)
v_mfma_f32_32x32x16_bf16 v[90:105], a[148:151], v[130:133], v[90:105]
ds_read_b128 v[122:125], v242 offset:28160
buffer_load_dwordx4 a[36:39], v50, s[4:7], s60 offen offset:1024
v_exp_f32 v197, v197
v_exp_f32 v198, v198
v_exp_f32 v199, v199
v_exp_f32 v200, v200
v_exp_f32 v201, v201
v_mfma_f32_32x32x16_bf16 v[106:121], a[116:119], v[134:137], v[106:121]
ds_read_b128 v[126:129], v242 offset:49664
buffer_load_dwordx4 a[40:43], v50, s[4:7], s60 offen offset:2048
v_fma_f32 v194, v194, v240, v240
v_fma_f32 v195, v195, v240, v240
v_fma_f32 v196, v196, v240, v240
v_fma_f32 v197, v197, v240, v240
v_fma_f32 v198, v198, v240, v240
v_fma_f32 v199, v199, v240, v240
v_fma_f32 v200, v200, v240, v240
v_fma_f32 v201, v201, v240, v240
v_rcp_f32 v194, v194
s_waitcnt vmcnt(39)
s_waitcnt lgkmcnt(4)
v_mfma_f32_32x32x16_bf16 v[90:105], a[152:155], v[138:141], v[90:105]
ds_read_b128 v[130:133], v242 offset:50176
buffer_load_dwordx4 a[44:47], v50, s[4:7], s60 offen offset:3072
v_rcp_f32 v195, v195
v_rcp_f32 v196, v196
v_rcp_f32 v197, v197
v_rcp_f32 v198, v198
v_rcp_f32 v199, v199
v_mfma_f32_32x32x16_bf16 v[106:121], a[120:123], v[142:145], v[106:121]
ds_read_b128 v[134:137], v242 offset:40960
s_add_u32 s60, s49, 28672
buffer_load_dwordx4 a[48:51], v50, s[4:7], s60 offen offset:0
v_rcp_f32 v200, v200
v_rcp_f32 v201, v201
v_mul_f32 v194, v210, v194
v_mul_f32 v195, v211, v195
v_mul_f32 v196, v212, v196
v_mul_f32 v197, v213, v197
v_mul_f32 v198, v214, v198
s_waitcnt vmcnt(40)
s_waitcnt lgkmcnt(4)
v_mfma_f32_32x32x16_bf16 v[90:105], a[156:159], v[146:149], v[90:105]
ds_read_b128 v[138:141], v242 offset:50688
buffer_load_dwordx4 a[52:55], v50, s[4:7], s60 offen offset:1024
v_mul_f32 v199, v215, v199
v_mul_f32 v200, v216, v200
v_mul_f32 v201, v217, v201
v_cvt_pk_bf16_f32 v222, v194, v195
v_cvt_pk_bf16_f32 v223, v196, v197
v_cvt_pk_bf16_f32 v224, v198, v199
v_cvt_pk_bf16_f32 v225, v200, v201
s_cmp_lg_u32 s36, 0
s_cbranch_scc1 ALT_148
buffer_store_dwordx4 v[222:225], v243, s[4:7], s94 offen offset:512
ALTE_149:
s_waitcnt vmcnt(41)
v_mfma_f32_32x32x16_bf16 v[90:105], a[160:163], v[150:153], v[90:105]
ds_read_b128 v[142:145], v242 offset:41472
s_waitcnt lgkmcnt(4)
v_mfma_f32_32x32x16_bf16 v[106:121], a[124:127], v[122:125], v[106:121]
ds_read_b128 v[146:149], v242 offset:51200
buffer_load_dwordx4 a[56:59], v50, s[4:7], s60 offen offset:2048
s_waitcnt vmcnt(41)
v_mfma_f32_32x32x16_bf16 v[90:105], a[164:167], v[126:129], v[90:105]
ds_read_b128 v[150:153], v242 offset:51712
s_waitcnt vmcnt(40)
s_waitcnt lgkmcnt(4)
v_mfma_f32_32x32x16_bf16 v[90:105], a[168:171], v[130:133], v[90:105]
ds_read_b128 v[122:125], v242 offset:41984
buffer_load_dwordx4 a[60:63], v50, s[4:7], s60 offen offset:3072
v_mfma_f32_32x32x16_bf16 v[106:121], a[128:131], v[134:137], v[106:121]
ds_read_b128 v[126:129], v242 offset:52224
s_waitcnt vmcnt(40)
s_waitcnt lgkmcnt(4)
v_mfma_f32_32x32x16_bf16 v[90:105], a[172:175], v[138:141], v[90:105]
ds_read_b128 v[130:133], v242 offset:42496
s_add_u32 s60, s49, 32768
buffer_load_dwordx4 a[64:67], v50, s[4:7], s60 offen offset:0
v_mfma_f32_32x32x16_bf16 v[106:121], a[132:135], v[142:145], v[106:121]
ds_read_b128 v[134:137], v242 offset:52736
s_waitcnt vmcnt(40)
s_waitcnt lgkmcnt(4)
v_mfma_f32_32x32x16_bf16 v[90:105], a[176:179], v[146:149], v[90:105]
ds_read_b128 v[138:141], v242 offset:43008
buffer_load_dwordx4 a[68:71], v50, s[4:7], s60 offen offset:1024
s_waitcnt vmcnt(40)
v_mfma_f32_32x32x16_bf16 v[90:105], a[180:183], v[150:153], v[90:105]
ds_read_b128 v[142:145], v242 offset:43520
s_waitcnt lgkmcnt(4)
v_mfma_f32_32x32x16_bf16 v[106:121], a[136:139], v[122:125], v[106:121]
ds_read_b128 v[146:149], v242 offset:44032
buffer_load_dwordx4 a[72:75], v50, s[4:7], s60 offen offset:2048
s_waitcnt vmcnt(40)
v_mfma_f32_32x32x16_bf16 v[90:105], a[184:187], v[126:129], v[90:105]
ds_read_b128 v[150:153], v242 offset:44544
s_waitcnt lgkmcnt(4)
v_mfma_f32_32x32x16_bf16 v[106:121], a[140:143], v[130:133], v[106:121]
ds_read_b128 v[122:125], v242 offset:57344
buffer_load_dwordx4 a[76:79], v50, s[4:7], s60 offen offset:3072
s_waitcnt vmcnt(40)
v_mfma_f32_32x32x16_bf16 v[90:105], a[188:191], v[134:137], v[90:105]
ds_read_b128 v[126:129], v242 offset:57856
s_waitcnt lgkmcnt(4)
v_mfma_f32_32x32x16_bf16 v[106:121], a[144:147], v[138:141], v[106:121]
ds_read_b128 v[130:133], v242 offset:58368
s_add_u32 s60, s49, 36864
buffer_load_dwordx4 a[80:83], v50, s[4:7], s60 offen offset:0
v_mfma_f32_32x32x16_bf16 v[106:121], a[148:151], v[142:145], v[106:121]
ds_read_b128 v[134:137], v242 offset:58880
s_nop 3
v_mul_f32 v186, v90, v90
v_mul_f32 v187, v91, v91
v_mul_f32 v188, v92, v92
v_mul_f32 v189, v93, v93
v_mul_f32 v190, v94, v94
v_mul_f32 v191, v95, v95
v_mul_f32 v192, v96, v96
v_mul_f32 v193, v97, v97
v_fma_f32 v186, v186, v233, v232
v_fma_f32 v187, v187, v233, v232
v_fma_f32 v188, v188, v233, v232
v_fma_f32 v189, v189, v233, v232
v_fma_f32 v190, v190, v233, v232
v_fma_f32 v191, v191, v233, v232
v_fma_f32 v192, v192, v233, v232
v_fma_f32 v193, v193, v233, v232
s_waitcnt lgkmcnt(4)
v_mfma_f32_32x32x16_bf16 v[106:121], a[152:155], v[146:149], v[106:121]
ds_read_b128 v[138:141], v242 offset:59392
buffer_load_dwordx4 a[84:87], v50, s[4:7], s60 offen offset:1024
v_mul_f32 v186, v186, v90
v_mul_f32 v187, v187, v91
v_mul_f32 v188, v188, v92
v_mul_f32 v189, v189, v93
v_mul_f32 v190, v190, v94
v_mul_f32 v191, v191, v95
v_mul_f32 v192, v192, v96
v_mul_f32 v193, v193, v97
v_exp_f32 v186, v186
v_exp_f32 v187, v187
v_exp_f32 v188, v188
v_exp_f32 v189, v189
v_mfma_f32_32x32x16_bf16 v[106:121], a[156:159], v[150:153], v[106:121]
ds_read_b128 v[142:145], v242 offset:59904
buffer_load_dwordx4 a[88:91], v50, s[4:7], s60 offen offset:2048
v_exp_f32 v190, v190
v_exp_f32 v191, v191
v_exp_f32 v192, v192
v_exp_f32 v193, v193
v_fma_f32 v186, v186, v234, v234
v_fma_f32 v187, v187, v234, v234
v_fma_f32 v188, v188, v234, v234
v_fma_f32 v189, v189, v234, v234
v_fma_f32 v190, v190, v234, v234
v_fma_f32 v191, v191, v234, v234
v_fma_f32 v192, v192, v234, v234
s_waitcnt lgkmcnt(4)
v_mfma_f32_32x32x16_bf16 v[106:121], a[160:163], v[122:125], v[106:121]
ds_read_b128 v[146:149], v242 offset:60416
buffer_load_dwordx4 a[92:95], v50, s[4:7], s60 offen offset:3072
v_fma_f32 v193, v193, v234, v234
v_rcp_f32 v186, v186
v_rcp_f32 v187, v187
v_rcp_f32 v188, v188
v_rcp_f32 v189, v189
v_rcp_f32 v190, v190
v_rcp_f32 v191, v191
v_rcp_f32 v192, v192
v_rcp_f32 v193, v193
v_mfma_f32_32x32x16_bf16 v[106:121], a[164:167], v[126:129], v[106:121]
ds_read_b128 v[150:153], v242 offset:60928
s_add_u32 s60, s49, 40960
buffer_load_dwordx4 a[96:99], v50, s[4:7], s60 offen offset:0
v_mul_f32 v186, v90, v186
v_mul_f32 v187, v91, v187
v_mul_f32 v188, v92, v188
v_mul_f32 v189, v93, v189
v_mul_f32 v190, v94, v190
v_mul_f32 v191, v95, v191
v_mul_f32 v192, v96, v192
v_mul_f32 v193, v97, v193
v_cvt_pk_bf16_f32 v218, v186, v187
v_cvt_pk_bf16_f32 v219, v188, v189
v_cvt_pk_bf16_f32 v220, v190, v191
v_cvt_pk_bf16_f32 v221, v192, v193
s_add_u32 s58, s61, 1024
s_cmp_lg_u32 s36, 0
s_cbranch_scc1 ALT_150
buffer_store_dwordx4 v[218:221], v53, s[4:7], s58 offen offset:0
ALTE_151:
s_waitcnt lgkmcnt(4)
v_mfma_f32_32x32x16_bf16 v[106:121], a[168:171], v[130:133], v[106:121]
v_mul_f32 v194, v98, v98
v_mul_f32 v195, v99, v99
v_mul_f32 v196, v100, v100
v_mul_f32 v197, v101, v101
v_mul_f32 v198, v102, v102
v_mul_f32 v199, v103, v103
v_mul_f32 v200, v104, v104
v_mul_f32 v201, v105, v105
v_fma_f32 v194, v194, v233, v232
v_fma_f32 v195, v195, v233, v232
v_fma_f32 v196, v196, v233, v232
v_fma_f32 v197, v197, v233, v232
v_fma_f32 v198, v198, v233, v232
v_fma_f32 v199, v199, v233, v232
v_fma_f32 v200, v200, v233, v232
v_fma_f32 v201, v201, v233, v232
v_mfma_f32_32x32x16_bf16 v[106:121], a[172:175], v[134:137], v[106:121]
buffer_load_dwordx4 a[100:103], v50, s[4:7], s60 offen offset:1024
v_mul_f32 v194, v194, v98
v_mul_f32 v195, v195, v99
v_mul_f32 v196, v196, v100
v_mul_f32 v197, v197, v101
v_mul_f32 v198, v198, v102
v_mul_f32 v199, v199, v103
v_mul_f32 v200, v200, v104
v_mul_f32 v201, v201, v105
v_exp_f32 v194, v194
v_exp_f32 v195, v195
v_exp_f32 v196, v196
v_exp_f32 v197, v197
s_waitcnt lgkmcnt(2)
v_mfma_f32_32x32x16_bf16 v[106:121], a[176:179], v[138:141], v[106:121]
buffer_load_dwordx4 a[104:107], v50, s[4:7], s60 offen offset:2048
v_exp_f32 v198, v198
v_exp_f32 v199, v199
v_exp_f32 v200, v200
v_exp_f32 v201, v201
v_fma_f32 v194, v194, v234, v234
v_fma_f32 v195, v195, v234, v234
v_fma_f32 v196, v196, v234, v234
v_fma_f32 v197, v197, v234, v234
v_fma_f32 v198, v198, v234, v234
v_fma_f32 v199, v199, v234, v234
v_fma_f32 v200, v200, v234, v234
v_mfma_f32_32x32x16_bf16 v[106:121], a[180:183], v[142:145], v[106:121]
buffer_load_dwordx4 a[108:111], v50, s[4:7], s60 offen offset:3072
v_fma_f32 v201, v201, v234, v234
v_rcp_f32 v194, v194
v_rcp_f32 v195, v195
v_rcp_f32 v196, v196
v_rcp_f32 v197, v197
v_rcp_f32 v198, v198
v_rcp_f32 v199, v199
v_rcp_f32 v200, v200
v_rcp_f32 v201, v201
s_waitcnt lgkmcnt(0)
v_mfma_f32_32x32x16_bf16 v[106:121], a[184:187], v[146:149], v[106:121]
s_add_u32 s60, s49, 45056
buffer_load_dwordx4 a[112:115], v50, s[4:7], s60 offen offset:0
v_mul_f32 v194, v98, v194
v_mul_f32 v195, v99, v195
v_mul_f32 v196, v100, v196
v_mul_f32 v197, v101, v197
v_mul_f32 v198, v102, v198
v_mul_f32 v199, v103, v199
v_mul_f32 v200, v104, v200
v_mul_f32 v201, v105, v201
v_cvt_pk_bf16_f32 v222, v194, v195
v_cvt_pk_bf16_f32 v223, v196, v197
v_cvt_pk_bf16_f32 v224, v198, v199
v_cvt_pk_bf16_f32 v225, v200, v201
s_cmp_lg_u32 s36, 0
s_cbranch_scc1 ALT_152
buffer_store_dwordx4 v[222:225], v53, s[4:7], s58 offen offset:512
ALTE_153:
v_mfma_f32_32x32x16_bf16 v[106:121], a[188:191], v[150:153], v[106:121]
s_cmp_lg_u32 s36, 0
s_cbranch_scc1 ALT_154
v_mov_b32 v11, 12
s_waitcnt vmcnt(17)
s_mov_b64 exec, 1
buffer_store_dword v11, off, s[4:7], s42
s_mov_b64 exec, -1
ALTE_155:
s_nop 4
v_pk_mul_f32 v[186:187], v[106:107], v[106:107]
v_pk_mul_f32 v[188:189], v[108:109], v[108:109]
v_pk_mul_f32 v[190:191], v[110:111], v[110:111]
v_pk_mul_f32 v[192:193], v[112:113], v[112:113]
v_pk_fma_f32 v[186:187], v[186:187], v[238:239], v[238:239] op_sel:[0,1,0] op_sel_hi:[1,1,0]
v_pk_fma_f32 v[188:189], v[188:189], v[238:239], v[238:239] op_sel:[0,1,0] op_sel_hi:[1,1,0]
v_pk_fma_f32 v[190:191], v[190:191], v[238:239], v[238:239] op_sel:[0,1,0] op_sel_hi:[1,1,0]
v_pk_fma_f32 v[192:193], v[192:193], v[238:239], v[238:239] op_sel:[0,1,0] op_sel_hi:[1,1,0]
v_pk_mul_f32 v[186:187], v[186:187], v[106:107]
v_pk_mul_f32 v[188:189], v[188:189], v[108:109]
v_pk_mul_f32 v[190:191], v[190:191], v[110:111]
v_pk_mul_f32 v[192:193], v[192:193], v[112:113]
v_exp_f32 v186, v186
buffer_load_dwordx4 a[116:119], v50, s[4:7], s60 offen offset:1024
v_exp_f32 v187, v187
v_exp_f32 v188, v188
v_exp_f32 v189, v189
v_exp_f32 v190, v190
v_exp_f32 v191, v191
v_exp_f32 v192, v192
v_exp_f32 v193, v193
buffer_load_dwordx4 a[120:123], v50, s[4:7], s60 offen offset:2048
v_pk_fma_f32 v[186:187], v[186:187], v[240:241], v[240:241] op_sel_hi:[1,0,0]
v_pk_fma_f32 v[188:189], v[188:189], v[240:241], v[240:241] op_sel_hi:[1,0,0]
v_pk_fma_f32 v[190:191], v[190:191], v[240:241], v[240:241] op_sel_hi:[1,0,0]
v_pk_fma_f32 v[192:193], v[192:193], v[240:241], v[240:241] op_sel_hi:[1,0,0]
v_rcp_f32 v186, v186
v_rcp_f32 v187, v187
v_rcp_f32 v188, v188
v_rcp_f32 v189, v189
v_rcp_f32 v190, v190
buffer_load_dwordx4 a[124:127], v50, s[4:7], s60 offen offset:3072
v_rcp_f32 v191, v191
v_rcp_f32 v192, v192
v_rcp_f32 v193, v193
v_pk_mul_f32 v[186:187], v[106:107], v[186:187]
v_pk_mul_f32 v[188:189], v[108:109], v[188:189]
v_pk_mul_f32 v[190:191], v[110:111], v[190:191]
v_pk_mul_f32 v[192:193], v[112:113], v[192:193]
v_cvt_pk_bf16_f32 v218, v186, v187
v_cvt_pk_bf16_f32 v219, v188, v189
v_cvt_pk_bf16_f32 v220, v190, v191
s_add_u32 s60, s49, 49152
buffer_load_dwordx4 a[128:131], v50, s[4:7], s60 offen offset:0
v_cvt_pk_bf16_f32 v221, v192, v193
s_add_u32 s58, s61, 115712
s_cmp_lg_u32 s36, 0
s_cbranch_scc1 ALT_156
buffer_store_dwordx4 v[218:221], v53, s[4:7], s58 offen offset:0
ALTE_157:
v_pk_mul_f32 v[194:195], v[114:115], v[114:115]
v_pk_mul_f32 v[196:197], v[116:117], v[116:117]
v_pk_mul_f32 v[198:199], v[118:119], v[118:119]
v_pk_mul_f32 v[200:201], v[120:121], v[120:121]
v_pk_fma_f32 v[194:195], v[194:195], v[238:239], v[238:239] op_sel:[0,1,0] op_sel_hi:[1,1,0]
v_pk_fma_f32 v[196:197], v[196:197], v[238:239], v[238:239] op_sel:[0,1,0] op_sel_hi:[1,1,0]
v_pk_fma_f32 v[198:199], v[198:199], v[238:239], v[238:239] op_sel:[0,1,0] op_sel_hi:[1,1,0]
v_pk_fma_f32 v[200:201], v[200:201], v[238:239], v[238:239] op_sel:[0,1,0] op_sel_hi:[1,1,0]
v_pk_mul_f32 v[194:195], v[194:195], v[114:115]
v_pk_mul_f32 v[196:197], v[196:197], v[116:117]
v_pk_mul_f32 v[198:199], v[198:199], v[118:119]
v_pk_mul_f32 v[200:201], v[200:201], v[120:121]
v_exp_f32 v194, v194
v_exp_f32 v195, v195
v_exp_f32 v196, v196
v_exp_f32 v197, v197
v_exp_f32 v198, v198
v_exp_f32 v199, v199
v_exp_f32 v200, v200
v_exp_f32 v201, v201
v_pk_fma_f32 v[194:195], v[194:195], v[240:241], v[240:241] op_sel_hi:[1,0,0]
v_pk_fma_f32 v[196:197], v[196:197], v[240:241], v[240:241] op_sel_hi:[1,0,0]
v_pk_fma_f32 v[198:199], v[198:199], v[240:241], v[240:241] op_sel_hi:[1,0,0]
v_pk_fma_f32 v[200:201], v[200:201], v[240:241], v[240:241] op_sel_hi:[1,0,0]
v_rcp_f32 v194, v194
v_rcp_f32 v195, v195
v_rcp_f32 v196, v196
buffer_load_dword v255, v10, s[4:7], 0 offen sc1
v_rcp_f32 v197, v197
v_rcp_f32 v198, v198
v_rcp_f32 v199, v199
v_rcp_f32 v200, v200
v_rcp_f32 v201, v201
v_pk_mul_f32 v[194:195], v[114:115], v[194:195]
v_pk_mul_f32 v[196:197], v[116:117], v[196:197]
v_pk_mul_f32 v[198:199], v[118:119], v[198:199]
v_pk_mul_f32 v[200:201], v[120:121], v[200:201]
v_cvt_pk_bf16_f32 v222, v194, v195
v_cvt_pk_bf16_f32 v223, v196, v197
v_cvt_pk_bf16_f32 v224, v198, v199
v_cvt_pk_bf16_f32 v225, v200, v201
s_cmp_lg_u32 s36, 0
s_cbranch_scc1 ALT_158
buffer_store_dwordx4 v[222:225], v53, s[4:7], s58 offen offset:512
ALTE_159:
s_waitcnt vmcnt(1)
ACK_160:
v_cmp_gt_u32 vcc, 12, v255
s_cbranch_vccz ACKD_161
buffer_load_dword v255, v10, s[4:7], 0 offen sc1
s_waitcnt vmcnt(0)
s_sub_u32 s39, s39, 1
s_cbranch_scc0 ACK_160
s_branch BAIL
ACKD_161:
s_branch P5END_139
P5W3_138:
s_add_u32 s59, s51, 0x1320000
buffer_load_dwordx4 v[226:229], v1, s[4:7], s59 offen sc1
s_add_u32 m0, s74, 65536
s_add_u32 s48, s50, 0xa00000
buffer_load_dwordx4 v1, s[4:7], s48 offen offset:0 sc1 lds
buffer_load_dwordx4 v1, s[4:7], s48 offen offset:1024 sc1 lds
buffer_load_dwordx4 v1, s[4:7], s48 offen offset:2048 sc1 lds
buffer_load_dwordx4 v1, s[4:7], s48 offen offset:3072 sc1 lds
s_add_u32 m0, s74, 81920
s_add_u32 s48, s50, 0xa01000
buffer_load_dwordx4 v1, s[4:7], s48 offen offset:0 sc1 lds
buffer_load_dwordx4 v1, s[4:7], s48 offen offset:1024 sc1 lds
s_waitcnt vmcnt(2)
s_barrier
ds_read_b128 v[122:125], v242 offset:0
ds_read_b128 v[126:129], v242 offset:8192
ds_read_b128 v[130:133], v242 offset:512
ds_read_b128 v[134:137], v242 offset:8704
ds_read_b128 v[138:141], v242 offset:1024
ds_read_b128 v[142:145], v242 offset:9216
s_waitcnt lgkmcnt(4)
v_mfma_f32_32x32x16_bf16 v[58:73], a[224:227], v[122:125], 0
ds_read_b128 v[146:149], v242 offset:1536
buffer_load_dwordx4 v1, s[4:7], s48 offen offset:2048 sc1 lds
v_mfma_f32_32x32x16_bf16 v[74:89], a[224:227], v[126:129], 0
v_add_f32 v226, v226, v228
v_add_f32 v227, v227, v229
s_nop 1
v_permlane32_swap_b32 v226, v227
ds_read_b128 v[150:153], v242 offset:9728
s_waitcnt lgkmcnt(4)
v_mfma_f32_32x32x16_bf16 v[58:73], a[228:231], v[130:133], v[58:73]
v_add_f32 v226, v226, v227
v_mov_b32 v227, v226
s_nop 1
v_permlane16_swap_b32 v226, v227
ds_read_b128 v[122:125], v242 offset:2048
buffer_load_dwordx4 v1, s[4:7], s48 offen offset:3072 sc1 lds
v_mfma_f32_32x32x16_bf16 v[74:89], a[228:231], v[134:137], v[74:89]
v_add_f32 v226, v226, v227
v_mov_b32 v227, v226
s_nop 1
v_permlane32_swap_b32 v226, v227
ds_read_b128 v[126:129], v242 offset:10240
s_waitcnt lgkmcnt(4)
v_mfma_f32_32x32x16_bf16 v[58:73], a[232:235], v[138:141], v[58:73]
v_mul_f32 v244, 0x3b000000, v226
v_mul_f32 v227, 0x3b000000, v227
v_fma_f32 v245, -v244, v244, v227
ds_read_b128 v[130:133], v242 offset:2560
s_add_u32 m0, s74, 98304
s_add_u32 s48, s50, 0xa02000
buffer_load_dwordx4 v1, s[4:7], s48 offen offset:0 sc1 lds
v_mfma_f32_32x32x16_bf16 v[74:89], a[232:235], v[142:145], v[74:89]
v_max_f32 v245, 0, v245
v_add_f32 v245, 0x3727c5ac, v245
v_rsq_f32 v245, v245
ds_read_b128 v[134:137], v242 offset:10752
s_waitcnt lgkmcnt(4)
v_mfma_f32_32x32x16_bf16 v[58:73], a[236:239], v[146:149], v[58:73]
v_sub_f32 v244, 0, v244
ds_write2_b32 v246, v245, v244 offset0:0 offset1:128
ds_read_b128 v[138:141], v242 offset:3072
buffer_load_dwordx4 v1, s[4:7], s48 offen offset:1024 sc1 lds
v_mfma_f32_32x32x16_bf16 v[74:89], a[236:239], v[150:153], v[74:89]
ds_read_b128 v[142:145], v242 offset:11264
s_waitcnt lgkmcnt(5)
v_mfma_f32_32x32x16_bf16 v[58:73], a[240:243], v[122:125], v[58:73]
ds_read_b128 v[146:149], v242 offset:3584
buffer_load_dwordx4 v1, s[4:7], s48 offen offset:2048 sc1 lds
v_mfma_f32_32x32x16_bf16 v[74:89], a[240:243], v[126:129], v[74:89]
ds_read_b128 v[150:153], v242 offset:11776
s_waitcnt lgkmcnt(5)
v_mfma_f32_32x32x16_bf16 v[58:73], a[244:247], v[130:133], v[58:73]
s_waitcnt vmcnt(3)
s_waitcnt lgkmcnt(4)
s_barrier
ds_read2_b32 v[230:231], v247 offset0:0 offset1:128
ds_read2_b32 v[236:237], v247 offset0:32 offset1:160
ds_read_b128 v[122:125], v242 offset:16384
buffer_load_dwordx4 v1, s[4:7], s48 offen offset:3072 sc1 lds
v_mfma_f32_32x32x16_bf16 v[74:89], a[244:247], v[134:137], v[74:89]
ds_read_b128 v[126:129], v242 offset:24576
s_waitcnt lgkmcnt(6)
v_mfma_f32_32x32x16_bf16 v[58:73], a[248:251], v[138:141], v[58:73]
ds_read_b128 v[130:133], v242 offset:16896
s_add_u32 m0, s74, 114688
s_add_u32 s48, s50, 0xa03000
buffer_load_dwordx4 v1, s[4:7], s48 offen offset:0 sc1 lds
v_mfma_f32_32x32x16_bf16 v[74:89], a[248:251], v[142:145], v[74:89]
ds_read_b128 v[134:137], v242 offset:25088
s_waitcnt lgkmcnt(6)
v_mfma_f32_32x32x16_bf16 v[58:73], a[252:255], v[146:149], v[58:73]
ds_read_b128 v[138:141], v242 offset:17408
buffer_load_dwordx4 v1, s[4:7], s48 offen offset:1024 sc1 lds
v_mfma_f32_32x32x16_bf16 v[74:89], a[252:255], v[150:153], v[74:89]
ds_read_b128 v[142:145], v242 offset:25600
s_waitcnt lgkmcnt(4)
v_mfma_f32_32x32x16_bf16 v[58:73], a[192:195], v[122:125], v[58:73]
ds_read_b128 v[146:149], v242 offset:17920
buffer_load_dwordx4 v1, s[4:7], s48 offen offset:2048 sc1 lds
v_rcp_f32 v234, v230
v_mfma_f32_32x32x16_bf16 v[74:89], a[192:195], v[126:129], v[74:89]
ds_read_b128 v[150:153], v242 offset:26112
s_waitcnt lgkmcnt(4)
v_mfma_f32_32x32x16_bf16 v[58:73], a[196:199], v[130:133], v[58:73]
ds_read_b128 v[122:125], v242 offset:18432
buffer_load_dwordx4 v1, s[4:7], s48 offen offset:3072 sc1 lds
v_mul_f32 v232, 0xc0135761, v230
v_mfma_f32_32x32x16_bf16 v[74:89], a[196:199], v[134:137], v[74:89]
ds_read_b128 v[126:129], v242 offset:26624
v_mul_f32 v230, v230, v230
s_waitcnt lgkmcnt(4)
v_mfma_f32_32x32x16_bf16 v[58:73], a[200:203], v[138:141], v[58:73]
ds_read_b128 v[130:133], v242 offset:18944
buffer_load_dword v255, v248, s[4:7], 0 offen sc1
v_mul_f32 v233, 0x3d372713, v230
v_mfma_f32_32x32x16_bf16 v[74:89], a[200:203], v[142:145], v[74:89]
ds_read_b128 v[134:137], v242 offset:27136
v_mul_f32 v233, v233, v232
s_waitcnt lgkmcnt(4)
v_mfma_f32_32x32x16_bf16 v[58:73], a[204:207], v[146:149], v[58:73]
ds_read_b128 v[138:141], v242 offset:19456
s_add_u32 s60, s49, 0
buffer_load_dwordx4 a[224:227], v50, s[4:7], s60 offen offset:0
v_rcp_f32 v240, v236
v_mfma_f32_32x32x16_bf16 v[74:89], a[204:207], v[150:153], v[74:89]
ds_read_b128 v[142:145], v242 offset:27648
s_waitcnt lgkmcnt(4)
v_mfma_f32_32x32x16_bf16 v[58:73], a[208:211], v[122:125], v[58:73]
ds_read_b128 v[146:149], v242 offset:19968
buffer_load_dwordx4 a[228:231], v50, s[4:7], s60 offen offset:1024
v_mul_f32 v238, 0xc0135761, v236
v_mfma_f32_32x32x16_bf16 v[74:89], a[208:211], v[126:129], v[74:89]
ds_read_b128 v[150:153], v242 offset:28160
v_mul_f32 v236, v236, v236
s_waitcnt lgkmcnt(4)
v_mfma_f32_32x32x16_bf16 v[58:73], a[212:215], v[130:133], v[58:73]
s_waitcnt vmcnt(7)
s_barrier
ds_read_b128 v[122:125], v242 offset:32768
buffer_load_dwordx4 a[232:235], v50, s[4:7], s60 offen offset:2048
v_mul_f32 v239, 0x3d372713, v236
v_mfma_f32_32x32x16_bf16 v[74:89], a[212:215], v[134:137], v[74:89]
ds_read_b128 v[126:129], v242 offset:40960
v_mul_f32 v239, v239, v238
s_waitcnt lgkmcnt(4)
v_mfma_f32_32x32x16_bf16 v[58:73], a[216:219], v[138:141], v[58:73]
ds_read_b128 v[130:133], v242 offset:33280
buffer_load_dwordx4 a[236:239], v50, s[4:7], s60 offen offset:3072
v_mfma_f32_32x32x16_bf16 v[74:89], a[216:219], v[142:145], v[74:89]
ds_read_b128 v[134:137], v242 offset:41472
s_waitcnt lgkmcnt(4)
v_mfma_f32_32x32x16_bf16 v[58:73], a[220:223], v[146:149], v[58:73]
ds_read_b128 v[138:141], v242 offset:33792
s_add_u32 s60, s49, 4096
buffer_load_dwordx4 a[240:243], v50, s[4:7], s60 offen offset:0
v_mfma_f32_32x32x16_bf16 v[74:89], a[220:223], v[150:153], v[74:89]
ds_read_b128 v[142:145], v242 offset:41984
s_waitcnt lgkmcnt(4)
v_mfma_f32_32x32x16_bf16 v[58:73], a[0:3], v[122:125], v[58:73]
ds_read_b128 v[146:149], v242 offset:34304
buffer_load_dwordx4 a[244:247], v50, s[4:7], s60 offen offset:1024
v_mfma_f32_32x32x16_bf16 v[74:89], a[0:3], v[126:129], v[74:89]
ds_read_b128 v[150:153], v242 offset:42496
s_waitcnt lgkmcnt(4)
v_mfma_f32_32x32x16_bf16 v[58:73], a[4:7], v[130:133], v[58:73]
ds_read_b128 v[122:125], v242 offset:34816
buffer_load_dwordx4 a[248:251], v50, s[4:7], s60 offen offset:2048
v_mfma_f32_32x32x16_bf16 v[74:89], a[4:7], v[134:137], v[74:89]
ds_read_b128 v[126:129], v242 offset:43008
s_waitcnt lgkmcnt(4)
v_mfma_f32_32x32x16_bf16 v[58:73], a[8:11], v[138:141], v[58:73]
ds_read_b128 v[130:133], v242 offset:35328
buffer_load_dwordx4 a[252:255], v50, s[4:7], s60 offen offset:3072
v_mfma_f32_32x32x16_bf16 v[74:89], a[8:11], v[142:145], v[74:89]
ds_read_b128 v[134:137], v242 offset:43520
s_waitcnt lgkmcnt(4)
v_mfma_f32_32x32x16_bf16 v[58:73], a[12:15], v[146:149], v[58:73]
ds_read_b128 v[138:141], v242 offset:35840
s_add_u32 s60, s49, 8192
buffer_load_dwordx4 a[192:195], v50, s[4:7], s60 offen offset:0
v_mfma_f32_32x32x16_bf16 v[74:89], a[12:15], v[150:153], v[74:89]
ds_read_b128 v[142:145], v242 offset:44032
s_waitcnt lgkmcnt(4)
v_mfma_f32_32x32x16_bf16 v[58:73], a[16:19], v[122:125], v[58:73]
ds_read_b128 v[146:149], v242 offset:36352
buffer_load_dwordx4 a[196:199], v50, s[4:7], s60 offen offset:1024
v_mfma_f32_32x32x16_bf16 v[74:89], a[16:19], v[126:129], v[74:89]
ds_read_b128 v[150:153], v242 offset:44544
s_waitcnt lgkmcnt(4)
v_mfma_f32_32x32x16_bf16 v[58:73], a[20:23], v[130:133], v[58:73]
s_waitcnt vmcnt(11)
s_barrier
ds_read_b128 v[122:125], v242 offset:49152
buffer_load_dwordx4 a[200:203], v50, s[4:7], s60 offen offset:2048
v_mfma_f32_32x32x16_bf16 v[74:89], a[20:23], v[134:137], v[74:89]
ds_read_b128 v[126:129], v242 offset:57344
s_waitcnt lgkmcnt(4)
v_mfma_f32_32x32x16_bf16 v[58:73], a[24:27], v[138:141], v[58:73]
ds_read_b128 v[130:133], v242 offset:49664
buffer_load_dwordx4 a[204:207], v50, s[4:7], s60 offen offset:3072
v_mfma_f32_32x32x16_bf16 v[74:89], a[24:27], v[142:145], v[74:89]
ds_read_b128 v[134:137], v242 offset:57856
s_waitcnt lgkmcnt(4)
v_mfma_f32_32x32x16_bf16 v[58:73], a[28:31], v[146:149], v[58:73]
ds_read_b128 v[138:141], v242 offset:50176
s_add_u32 s60, s49, 12288
buffer_load_dwordx4 a[208:211], v50, s[4:7], s60 offen offset:0
v_mfma_f32_32x32x16_bf16 v[74:89], a[28:31], v[150:153], v[74:89]
ds_read_b128 v[142:145], v242 offset:58368
s_waitcnt lgkmcnt(4)
v_mfma_f32_32x32x16_bf16 v[58:73], a[32:35], v[122:125], v[58:73]
ds_read_b128 v[146:149], v242 offset:50688
buffer_load_dwordx4 a[212:215], v50, s[4:7], s60 offen offset:1024
v_mfma_f32_32x32x16_bf16 v[74:89], a[32:35], v[126:129], v[74:89]
ds_read_b128 v[150:153], v242 offset:58880
s_waitcnt lgkmcnt(4)
v_mfma_f32_32x32x16_bf16 v[58:73], a[36:39], v[130:133], v[58:73]
ds_read_b128 v[122:125], v242 offset:51200
buffer_load_dwordx4 a[216:219], v50, s[4:7], s60 offen offset:2048
v_mfma_f32_32x32x16_bf16 v[74:89], a[36:39], v[134:137], v[74:89]
ds_read_b128 v[126:129], v242 offset:59392
s_waitcnt lgkmcnt(4)
v_mfma_f32_32x32x16_bf16 v[58:73], a[40:43], v[138:141], v[58:73]
ds_read_b128 v[130:133], v242 offset:51712
buffer_load_dwordx4 a[220:223], v50, s[4:7], s60 offen offset:3072
v_mfma_f32_32x32x16_bf16 v[74:89], a[40:43], v[142:145], v[74:89]
ds_read_b128 v[134:137], v242 offset:59904
s_waitcnt lgkmcnt(4)
v_mfma_f32_32x32x16_bf16 v[58:73], a[44:47], v[146:149], v[58:73]
ds_read_b128 v[138:141], v242 offset:52224
s_add_u32 s60, s49, 16384
buffer_load_dwordx4 a[0:3], v50, s[4:7], s60 offen offset:0
v_mfma_f32_32x32x16_bf16 v[74:89], a[44:47], v[150:153], v[74:89]
ds_read_b128 v[142:145], v242 offset:60416
s_waitcnt lgkmcnt(4)
v_mfma_f32_32x32x16_bf16 v[58:73], a[48:51], v[122:125], v[58:73]
ds_read_b128 v[146:149], v242 offset:52736
buffer_load_dwordx4 a[4:7], v50, s[4:7], s60 offen offset:1024
v_mfma_f32_32x32x16_bf16 v[74:89], a[48:51], v[126:129], v[74:89]
ds_read_b128 v[150:153], v242 offset:60928
s_waitcnt lgkmcnt(4)
v_mfma_f32_32x32x16_bf16 v[58:73], a[52:55], v[130:133], v[58:73]
buffer_load_dwordx4 a[8:11], v50, s[4:7], s60 offen offset:2048
v_mfma_f32_32x32x16_bf16 v[74:89], a[52:55], v[134:137], v[74:89]
s_waitcnt lgkmcnt(2)
v_mfma_f32_32x32x16_bf16 v[58:73], a[56:59], v[138:141], v[58:73]
buffer_load_dwordx4 a[12:15], v50, s[4:7], s60 offen offset:3072
v_mfma_f32_32x32x16_bf16 v[74:89], a[56:59], v[142:145], v[74:89]
s_waitcnt lgkmcnt(0)
v_mfma_f32_32x32x16_bf16 v[58:73], a[60:63], v[146:149], v[58:73]
s_add_u32 s60, s49, 20480
buffer_load_dwordx4 a[16:19], v50, s[4:7], s60 offen offset:0
v_mfma_f32_32x32x16_bf16 v[74:89], a[60:63], v[150:153], v[74:89]
s_waitcnt vmcnt(21)
ACK_162:
v_cmp_gt_u32 vcc, 11, v255
s_cbranch_vccz ACKD_163
buffer_load_dword v255, v248, s[4:7], 0 offen sc1
s_waitcnt vmcnt(0)
s_sub_u32 s39, s39, 1
s_cbranch_scc0 ACK_162
s_branch BAIL
ACKD_163:
s_nop 5
v_pk_fma_f32 v[202:203], v[154:155], v[230:231], v[58:59] op_sel:[0,1,0]
v_pk_fma_f32 v[204:205], v[156:157], v[230:231], v[60:61] op_sel:[0,1,0]
v_pk_fma_f32 v[206:207], v[158:159], v[230:231], v[62:63] op_sel:[0,1,0]
v_pk_fma_f32 v[208:209], v[160:161], v[230:231], v[64:65] op_sel:[0,1,0]
v_pk_mul_f32 v[186:187], v[202:203], v[202:203]
v_pk_mul_f32 v[188:189], v[204:205], v[204:205]
v_pk_mul_f32 v[190:191], v[206:207], v[206:207]
v_pk_mul_f32 v[192:193], v[208:209], v[208:209]
v_pk_fma_f32 v[186:187], v[186:187], v[232:233], v[232:233] op_sel:[0,1,0] op_sel_hi:[1,1,0]
v_pk_fma_f32 v[188:189], v[188:189], v[232:233], v[232:233] op_sel:[0,1,0] op_sel_hi:[1,1,0]
v_pk_fma_f32 v[190:191], v[190:191], v[232:233], v[232:233] op_sel:[0,1,0] op_sel_hi:[1,1,0]
v_pk_fma_f32 v[192:193], v[192:193], v[232:233], v[232:233] op_sel:[0,1,0] op_sel_hi:[1,1,0]
v_pk_mul_f32 v[186:187], v[186:187], v[202:203]
v_pk_mul_f32 v[188:189], v[188:189], v[204:205]
v_pk_mul_f32 v[190:191], v[190:191], v[206:207]
v_pk_mul_f32 v[192:193], v[192:193], v[208:209]
v_exp_f32 v186, v186
v_exp_f32 v187, v187
v_exp_f32 v188, v188
v_exp_f32 v189, v189
v_exp_f32 v190, v190
v_exp_f32 v191, v191
v_exp_f32 v192, v192
v_exp_f32 v193, v193
v_pk_fma_f32 v[186:187], v[186:187], v[234:235], v[234:235] op_sel_hi:[1,0,0]
v_pk_fma_f32 v[188:189], v[188:189], v[234:235], v[234:235] op_sel_hi:[1,0,0]
v_pk_fma_f32 v[190:191], v[190:191], v[234:235], v[234:235] op_sel_hi:[1,0,0]
v_pk_fma_f32 v[192:193], v[192:193], v[234:235], v[234:235] op_sel_hi:[1,0,0]
v_rcp_f32 v186, v186
v_rcp_f32 v187, v187
v_rcp_f32 v188, v188
v_rcp_f32 v189, v189
v_rcp_f32 v190, v190
v_rcp_f32 v191, v191
v_rcp_f32 v192, v192
v_rcp_f32 v193, v193
v_pk_mul_f32 v[186:187], v[202:203], v[186:187]
v_pk_mul_f32 v[188:189], v[204:205], v[188:189]
v_pk_mul_f32 v[190:191], v[206:207], v[190:191]
v_pk_mul_f32 v[192:193], v[208:209], v[192:193]
v_cvt_pk_bf16_f32 v218, v186, v187
v_cvt_pk_bf16_f32 v219, v188, v189
v_cvt_pk_bf16_f32 v220, v190, v191
v_cvt_pk_bf16_f32 v221, v192, v193
s_cmp_lg_u32 s36, 0
s_cbranch_scc1 ALT_164
buffer_store_dwordx4 v[218:221], v243, s[4:7], s95 offen offset:0
ALTE_165:
v_pk_fma_f32 v[210:211], v[162:163], v[230:231], v[66:67] op_sel:[0,1,0]
v_pk_fma_f32 v[212:213], v[164:165], v[230:231], v[68:69] op_sel:[0,1,0]
v_pk_fma_f32 v[214:215], v[166:167], v[230:231], v[70:71] op_sel:[0,1,0]
v_pk_fma_f32 v[216:217], v[168:169], v[230:231], v[72:73] op_sel:[0,1,0]
v_pk_mul_f32 v[194:195], v[210:211], v[210:211]
v_pk_mul_f32 v[196:197], v[212:213], v[212:213]
v_pk_mul_f32 v[198:199], v[214:215], v[214:215]
v_pk_mul_f32 v[200:201], v[216:217], v[216:217]
v_pk_fma_f32 v[194:195], v[194:195], v[232:233], v[232:233] op_sel:[0,1,0] op_sel_hi:[1,1,0]
v_pk_fma_f32 v[196:197], v[196:197], v[232:233], v[232:233] op_sel:[0,1,0] op_sel_hi:[1,1,0]
v_pk_fma_f32 v[198:199], v[198:199], v[232:233], v[232:233] op_sel:[0,1,0] op_sel_hi:[1,1,0]
v_pk_fma_f32 v[200:201], v[200:201], v[232:233], v[232:233] op_sel:[0,1,0] op_sel_hi:[1,1,0]
v_pk_mul_f32 v[194:195], v[194:195], v[210:211]
v_pk_mul_f32 v[196:197], v[196:197], v[212:213]
v_pk_mul_f32 v[198:199], v[198:199], v[214:215]
v_pk_mul_f32 v[200:201], v[200:201], v[216:217]
v_exp_f32 v194, v194
v_exp_f32 v195, v195
v_exp_f32 v196, v196
v_exp_f32 v197, v197
v_exp_f32 v198, v198
v_exp_f32 v199, v199
v_exp_f32 v200, v200
v_exp_f32 v201, v201
v_pk_fma_f32 v[194:195], v[194:195], v[234:235], v[234:235] op_sel_hi:[1,0,0]
v_pk_fma_f32 v[196:197], v[196:197], v[234:235], v[234:235] op_sel_hi:[1,0,0]
v_pk_fma_f32 v[198:199], v[198:199], v[234:235], v[234:235] op_sel_hi:[1,0,0]
v_pk_fma_f32 v[200:201], v[200:201], v[234:235], v[234:235] op_sel_hi:[1,0,0]
v_rcp_f32 v194, v194
v_rcp_f32 v195, v195
v_rcp_f32 v196, v196
v_rcp_f32 v197, v197
v_rcp_f32 v198, v198
v_rcp_f32 v199, v199
v_rcp_f32 v200, v200
v_rcp_f32 v201, v201
v_pk_mul_f32 v[194:195], v[210:211], v[194:195]
v_pk_mul_f32 v[196:197], v[212:213], v[196:197]
v_pk_mul_f32 v[198:199], v[214:215], v[198:199]
v_pk_mul_f32 v[200:201], v[216:217], v[200:201]
v_cvt_pk_bf16_f32 v222, v194, v195
v_cvt_pk_bf16_f32 v223, v196, v197
v_cvt_pk_bf16_f32 v224, v198, v199
v_cvt_pk_bf16_f32 v225, v200, v201
s_cmp_lg_u32 s36, 0
s_cbranch_scc1 ALT_166
buffer_store_dwordx4 v[222:225], v243, s[4:7], s95 offen offset:512
ALTE_167:
v_pk_fma_f32 v[202:203], v[154:155], v[236:237], v[74:75] op_sel:[0,1,0]
v_pk_fma_f32 v[204:205], v[156:157], v[236:237], v[76:77] op_sel:[0,1,0]
v_pk_fma_f32 v[206:207], v[158:159], v[236:237], v[78:79] op_sel:[0,1,0]
v_pk_fma_f32 v[208:209], v[160:161], v[236:237], v[80:81] op_sel:[0,1,0]
v_pk_mul_f32 v[186:187], v[202:203], v[202:203]
v_pk_mul_f32 v[188:189], v[204:205], v[204:205]
v_pk_mul_f32 v[190:191], v[206:207], v[206:207]
v_pk_mul_f32 v[192:193], v[208:209], v[208:209]
v_pk_fma_f32 v[186:187], v[186:187], v[238:239], v[238:239] op_sel:[0,1,0] op_sel_hi:[1,1,0]
v_pk_fma_f32 v[188:189], v[188:189], v[238:239], v[238:239] op_sel:[0,1,0] op_sel_hi:[1,1,0]
v_pk_fma_f32 v[190:191], v[190:191], v[238:239], v[238:239] op_sel:[0,1,0] op_sel_hi:[1,1,0]
v_pk_fma_f32 v[192:193], v[192:193], v[238:239], v[238:239] op_sel:[0,1,0] op_sel_hi:[1,1,0]
v_pk_mul_f32 v[186:187], v[186:187], v[202:203]
v_pk_mul_f32 v[188:189], v[188:189], v[204:205]
v_pk_mul_f32 v[190:191], v[190:191], v[206:207]
v_pk_mul_f32 v[192:193], v[192:193], v[208:209]
v_exp_f32 v186, v186
v_exp_f32 v187, v187
v_exp_f32 v188, v188
v_exp_f32 v189, v189
v_exp_f32 v190, v190
v_exp_f32 v191, v191
v_exp_f32 v192, v192
v_exp_f32 v193, v193
v_pk_fma_f32 v[186:187], v[186:187], v[240:241], v[240:241] op_sel_hi:[1,0,0]
v_pk_fma_f32 v[188:189], v[188:189], v[240:241], v[240:241] op_sel_hi:[1,0,0]
v_pk_fma_f32 v[190:191], v[190:191], v[240:241], v[240:241] op_sel_hi:[1,0,0]
v_pk_fma_f32 v[192:193], v[192:193], v[240:241], v[240:241] op_sel_hi:[1,0,0]
v_rcp_f32 v186, v186
v_rcp_f32 v187, v187
v_rcp_f32 v188, v188
v_rcp_f32 v189, v189
v_rcp_f32 v190, v190
v_rcp_f32 v191, v191
v_rcp_f32 v192, v192
v_rcp_f32 v193, v193
v_pk_mul_f32 v[186:187], v[202:203], v[186:187]
v_pk_mul_f32 v[188:189], v[204:205], v[188:189]
v_pk_mul_f32 v[190:191], v[206:207], v[190:191]
v_pk_mul_f32 v[192:193], v[208:209], v[192:193]
v_cvt_pk_bf16_f32 v218, v186, v187
v_cvt_pk_bf16_f32 v219, v188, v189
v_cvt_pk_bf16_f32 v220, v190, v191
v_cvt_pk_bf16_f32 v221, v192, v193
s_cmp_lg_u32 s36, 0
s_cbranch_scc1 ALT_168
buffer_store_dwordx4 v[218:221], v243, s[4:7], s94 offen offset:0
ALTE_169:
v_pk_fma_f32 v[210:211], v[162:163], v[236:237], v[82:83] op_sel:[0,1,0]
v_pk_fma_f32 v[212:213], v[164:165], v[236:237], v[84:85] op_sel:[0,1,0]
v_pk_fma_f32 v[214:215], v[166:167], v[236:237], v[86:87] op_sel:[0,1,0]
v_pk_fma_f32 v[216:217], v[168:169], v[236:237], v[88:89] op_sel:[0,1,0]
v_pk_mul_f32 v[194:195], v[210:211], v[210:211]
v_pk_mul_f32 v[196:197], v[212:213], v[212:213]
v_pk_mul_f32 v[198:199], v[214:215], v[214:215]
v_pk_mul_f32 v[200:201], v[216:217], v[216:217]
v_pk_fma_f32 v[194:195], v[194:195], v[238:239], v[238:239] op_sel:[0,1,0] op_sel_hi:[1,1,0]
v_pk_fma_f32 v[196:197], v[196:197], v[238:239], v[238:239] op_sel:[0,1,0] op_sel_hi:[1,1,0]
v_pk_fma_f32 v[198:199], v[198:199], v[238:239], v[238:239] op_sel:[0,1,0] op_sel_hi:[1,1,0]
v_pk_fma_f32 v[200:201], v[200:201], v[238:239], v[238:239] op_sel:[0,1,0] op_sel_hi:[1,1,0]
v_pk_mul_f32 v[194:195], v[194:195], v[210:211]
v_pk_mul_f32 v[196:197], v[196:197], v[212:213]
v_pk_mul_f32 v[198:199], v[198:199], v[214:215]
v_pk_mul_f32 v[200:201], v[200:201], v[216:217]
v_exp_f32 v194, v194
v_exp_f32 v195, v195
v_exp_f32 v196, v196
v_exp_f32 v197, v197
v_exp_f32 v198, v198
v_exp_f32 v199, v199
v_exp_f32 v200, v200
v_exp_f32 v201, v201
v_pk_fma_f32 v[194:195], v[194:195], v[240:241], v[240:241] op_sel_hi:[1,0,0]
v_pk_fma_f32 v[196:197], v[196:197], v[240:241], v[240:241] op_sel_hi:[1,0,0]
v_pk_fma_f32 v[198:199], v[198:199], v[240:241], v[240:241] op_sel_hi:[1,0,0]
v_pk_fma_f32 v[200:201], v[200:201], v[240:241], v[240:241] op_sel_hi:[1,0,0]
v_rcp_f32 v194, v194
v_rcp_f32 v195, v195
v_rcp_f32 v196, v196
v_rcp_f32 v197, v197
v_rcp_f32 v198, v198
v_rcp_f32 v199, v199
v_rcp_f32 v200, v200
v_rcp_f32 v201, v201
v_pk_mul_f32 v[194:195], v[210:211], v[194:195]
v_pk_mul_f32 v[196:197], v[212:213], v[196:197]
v_pk_mul_f32 v[198:199], v[214:215], v[198:199]
v_pk_mul_f32 v[200:201], v[216:217], v[200:201]
v_cvt_pk_bf16_f32 v222, v194, v195
v_cvt_pk_bf16_f32 v223, v196, v197
v_cvt_pk_bf16_f32 v224, v198, v199
v_cvt_pk_bf16_f32 v225, v200, v201
s_cmp_lg_u32 s36, 0
s_cbranch_scc1 ALT_170
buffer_store_dwordx4 v[222:225], v243, s[4:7], s94 offen offset:512
ALTE_171:
s_cmp_lg_u32 s36, 0
s_cbranch_scc1 ALT_172
v_mov_b32 v11, 13
s_waitcnt vmcnt(0)
s_mov_b64 exec, 1
buffer_store_dword v11, off, s[4:7], s42
s_mov_b64 exec, -1
ALTE_173:
buffer_load_dwordx4 a[20:23], v50, s[4:7], s60 offen offset:1024
buffer_load_dwordx4 a[24:27], v50, s[4:7], s60 offen offset:2048
buffer_load_dwordx4 a[28:31], v50, s[4:7], s60 offen offset:3072
s_add_u32 s60, s49, 24576
buffer_load_dwordx4 a[32:35], v50, s[4:7], s60 offen offset:0
buffer_load_dwordx4 a[36:39], v50, s[4:7], s60 offen offset:1024
buffer_load_dwordx4 a[40:43], v50, s[4:7], s60 offen offset:2048
buffer_load_dwordx4 a[44:47], v50, s[4:7], s60 offen offset:3072
s_add_u32 s60, s49, 28672
buffer_load_dwordx4 a[48:51], v50, s[4:7], s60 offen offset:0
buffer_load_dwordx4 a[52:55], v50, s[4:7], s60 offen offset:1024
buffer_load_dwordx4 a[56:59], v50, s[4:7], s60 offen offset:2048
buffer_load_dwordx4 a[60:63], v50, s[4:7], s60 offen offset:3072
s_add_u32 s60, s49, 41984
buffer_load_dwordx4 a[100:103], v50, s[4:7], s60 offen offset:0
buffer_load_dwordx4 a[104:107], v50, s[4:7], s60 offen offset:1024
buffer_load_dwordx4 a[108:111], v50, s[4:7], s60 offen offset:2048
buffer_load_dwordx4 a[112:115], v50, s[4:7], s60 offen offset:3072
s_add_u32 s60, s49, 46080
buffer_load_dwordx4 a[116:119], v50, s[4:7], s60 offen offset:0
buffer_load_dwordx4 a[120:123], v50, s[4:7], s60 offen offset:1024
buffer_load_dwordx4 a[124:127], v50, s[4:7], s60 offen offset:2048
buffer_load_dwordx4 a[128:131], v50, s[4:7], s60 offen offset:3072
buffer_load_dword v255, v10, s[4:7], 0 offen sc1
s_waitcnt vmcnt(0)
ACK_174:
v_cmp_gt_u32 vcc, 12, v255
s_cbranch_vccz ACKD_175
buffer_load_dword v255, v10, s[4:7], 0 offen sc1
s_waitcnt vmcnt(0)
s_sub_u32 s39, s39, 1
s_cbranch_scc0 ACK_174
s_branch BAIL
ACKD_175:
P5END_139:
PH12:
buffer_load_dwordx4 v[106:109], v1, s[4:7], s81 offen offset:0 sc1
buffer_load_dwordx4 v[110:113], v1, s[4:7], s82 offen offset:0 sc1
buffer_load_dwordx4 v[114:117], v1, s[4:7], s83 offen offset:0 sc1
buffer_load_dwordx4 v[118:121], v1, s[4:7], s80 offen offset:0 sc1
buffer_load_dwordx4 v[122:125], v1, s[4:7], s81 offen offset:1024 sc1
s_cmp_lg_u32 s36, 0
s_cbranch_scc1 ALT_176
v_mov_b32 v11, 13
s_waitcnt vmcnt(5)
s_mov_b64 exec, 1
buffer_store_dword v11, off, s[4:7], s42
s_mov_b64 exec, -1
ALTE_177:
buffer_load_dwordx4 v[126:129], v1, s[4:7], s82 offen offset:1024 sc1
buffer_load_dwordx4 v[130:133], v1, s[4:7], s83 offen offset:1024 sc1
buffer_load_dwordx4 v[134:137], v1, s[4:7], s80 offen offset:1024 sc1
buffer_load_dwordx4 v[138:141], v1, s[4:7], s81 offen offset:2048 sc1
buffer_load_dwordx4 v[142:145], v1, s[4:7], s82 offen offset:2048 sc1
buffer_load_dwordx4 v[146:149], v1, s[4:7], s83 offen offset:2048 sc1
buffer_load_dwordx4 v[150:153], v1, s[4:7], s80 offen offset:2048 sc1
s_waitcnt vmcnt(12)
v_mfma_f32_16x16x32_bf16 v[58:61], a[224:227], v[106:109], 0
buffer_load_dwordx4 v[154:157], v1, s[4:7], s81 offen offset:3072 sc1
v_mfma_f32_16x16x32_bf16 v[62:65], a[228:231], v[106:109], 0
v_add_u32 v239, s68, v1
v_mfma_f32_16x16x32_bf16 v[66:69], a[232:235], v[106:109], 0
v_add_u32 v240, s69, v1
v_mfma_f32_16x16x32_bf16 v[70:73], a[236:239], v[106:109], 0
s_waitcnt vmcnt(12)
v_mfma_f32_16x16x32_bf16 v[74:77], a[224:227], v[110:113], 0
buffer_load_dwordx4 v[158:161], v1, s[4:7], s82 offen offset:3072 sc1
v_mfma_f32_16x16x32_bf16 v[78:81], a[228:231], v[110:113], 0
v_add_u32 v241, s70, v1
v_mfma_f32_16x16x32_bf16 v[82:85], a[232:235], v[110:113], 0
s_mul_i32 s58, s34, 12288
v_mfma_f32_16x16x32_bf16 v[86:89], a[236:239], v[110:113], 0
s_waitcnt vmcnt(12)
v_mfma_f32_16x16x32_bf16 v[90:93], a[224:227], v[114:117], 0
buffer_load_dwordx4 v[162:165], v1, s[4:7], s83 offen offset:3072 sc1
v_mfma_f32_16x16x32_bf16 v[94:97], a[228:231], v[114:117], 0
s_add_u32 s58, s58, 0
v_mfma_f32_16x16x32_bf16 v[98:101], a[232:235], v[114:117], 0
v_add_u32 v238, s58, v1
v_mfma_f32_16x16x32_bf16 v[102:105], a[236:239], v[114:117], 0
s_waitcnt vmcnt(12)
v_mfma_f32_16x16x32_bf16 v[12:15], a[224:227], v[118:121], v[12:15]
buffer_load_dwordx4 v[166:169], v1, s[4:7], s80 offen offset:3072 sc1
v_mfma_f32_16x16x32_bf16 v[16:19], a[228:231], v[118:121], v[16:19]
v_and_b32 v247, 15, v0
v_mfma_f32_16x16x32_bf16 v[20:23], a[232:235], v[118:121], v[20:23]
v_lshrrev_b32 v248, 4, v0
v_mfma_f32_16x16x32_bf16 v[24:27], a[236:239], v[118:121], v[24:27]
s_waitcnt vmcnt(12)
v_mfma_f32_16x16x32_bf16 v[58:61], a[240:243], v[122:125], v[58:61]
s_add_u32 s91, s65, 0xc01000
buffer_load_dwordx4 v[170:173], v1, s[4:7], s91 offen offset:3072 sc1
v_mfma_f32_16x16x32_bf16 v[62:65], a[244:247], v[122:125], v[62:65]
s_lshl_b32 s40, s35, 14
v_mfma_f32_16x16x32_bf16 v[66:69], a[248:251], v[122:125], v[66:69]
s_lshl_b32 s41, s33, 7
v_mfma_f32_16x16x32_bf16 v[70:73], a[252:255], v[122:125], v[70:73]
s_waitcnt vmcnt(11)
v_mfma_f32_16x16x32_bf16 v[74:77], a[240:243], v[126:129], v[74:77]
s_add_u32 s92, s66, 0xc01000
buffer_load_dwordx4 v[174:177], v1, s[4:7], s92 offen offset:3072 sc1
v_mfma_f32_16x16x32_bf16 v[78:81], a[244:247], v[126:129], v[78:81]
s_add_u32 s40, s40, s41
v_mfma_f32_16x16x32_bf16 v[82:85], a[248:251], v[126:129], v[82:85]
v_lshlrev_b32 v246, 10, v247
v_mfma_f32_16x16x32_bf16 v[86:89], a[252:255], v[126:129], v[86:89]
s_waitcnt vmcnt(11)
v_mfma_f32_16x16x32_bf16 v[90:93], a[240:243], v[130:133], v[90:93]
s_add_u32 s93, s67, 0xc01000
buffer_load_dwordx4 v[178:181], v1, s[4:7], s93 offen offset:3072 sc1
v_mfma_f32_16x16x32_bf16 v[94:97], a[244:247], v[130:133], v[94:97]
v_add_u32 v246, s40, v246
v_mfma_f32_16x16x32_bf16 v[98:101], a[248:251], v[130:133], v[98:101]
v_lshl_add_u32 v246, v248, 0, v246
v_mfma_f32_16x16x32_bf16 v[102:105], a[252:255], v[130:133], v[102:105]
s_waitcnt vmcnt(11)
v_mfma_f32_16x16x32_bf16 v[12:15], a[240:243], v[134:137], v[12:15]
s_add_u32 s90, s64, 0xc01000
buffer_load_dwordx4 v[182:185], v1, s[4:7], s90 offen offset:3072 sc1
v_mfma_f32_16x16x32_bf16 v[16:19], a[244:247], v[134:137], v[16:19]
v_subrev_u32 v246, v248, v246
v_mfma_f32_16x16x32_bf16 v[20:23], a[248:251], v[134:137], v[20:23]
v_and_b32 v247, 1, v248
v_mfma_f32_16x16x32_bf16 v[24:27], a[252:255], v[134:137], v[24:27]
s_waitcnt vmcnt(11)
v_mfma_f32_16x16x32_bf16 v[58:61], a[192:195], v[138:141], v[58:61]
s_add_u32 s91, s65, 0xc02000
buffer_load_dwordx4 v[186:189], v1, s[4:7], s91 offen offset:1024 sc1
v_mfma_f32_16x16x32_bf16 v[62:65], a[196:199], v[138:141], v[62:65]
v_lshl_add_u32 v246, v247, 5, v246
v_mfma_f32_16x16x32_bf16 v[66:69], a[200:203], v[138:141], v[66:69]
v_lshrrev_b32 v247, 1, v248
v_mfma_f32_16x16x32_bf16 v[70:73], a[204:207], v[138:141], v[70:73]
s_waitcnt vmcnt(11)
v_mfma_f32_16x16x32_bf16 v[74:77], a[192:195], v[142:145], v[74:77]
s_add_u32 s92, s66, 0xc02000
buffer_load_dwordx4 v[190:193], v1, s[4:7], s92 offen offset:1024 sc1
v_mfma_f32_16x16x32_bf16 v[78:81], a[196:199], v[142:145], v[78:81]
v_lshl_add_u32 v246, v247, 4, v246
v_mfma_f32_16x16x32_bf16 v[82:85], a[200:203], v[142:145], v[82:85]
s_add_u32 s58, s74, 49152
v_mfma_f32_16x16x32_bf16 v[86:89], a[204:207], v[142:145], v[86:89]
s_waitcnt vmcnt(11)
v_mfma_f32_16x16x32_bf16 v[90:93], a[192:195], v[146:149], v[90:93]
s_add_u32 s93, s67, 0xc02000
buffer_load_dwordx4 v[194:197], v1, s[4:7], s93 offen offset:1024 sc1
v_mfma_f32_16x16x32_bf16 v[94:97], a[196:199], v[146:149], v[94:97]
v_and_b32 v247, 15, v0
v_mfma_f32_16x16x32_bf16 v[98:101], a[200:203], v[146:149], v[98:101]
v_mul_u32_u24 v247, 144, v247
v_mfma_f32_16x16x32_bf16 v[102:105], a[204:207], v[146:149], v[102:105]
s_waitcnt vmcnt(11)
v_mfma_f32_16x16x32_bf16 v[12:15], a[192:195], v[150:153], v[12:15]
s_add_u32 s90, s64, 0xc02000
buffer_load_dwordx4 v[198:201], v1, s[4:7], s90 offen offset:1024 sc1
v_mfma_f32_16x16x32_bf16 v[16:19], a[196:199], v[150:153], v[16:19]
v_lshl_add_u32 v247, v248, 3, v247
v_mfma_f32_16x16x32_bf16 v[20:23], a[200:203], v[150:153], v[20:23]
v_add_u32 v250, s58, v247
v_mfma_f32_16x16x32_bf16 v[24:27], a[204:207], v[150:153], v[24:27]
s_waitcnt vmcnt(11)
v_mfma_f32_16x16x32_bf16 v[58:61], a[208:211], v[154:157], v[58:61]
buffer_load_dwordx4 v[202:205], v1, s[4:7], s91 offen offset:3072 sc1
v_mfma_f32_16x16x32_bf16 v[62:65], a[212:215], v[154:157], v[62:65]
v_lshrrev_b32 v247, 3, v0
v_mfma_f32_16x16x32_bf16 v[66:69], a[216:219], v[154:157], v[66:69]
v_and_b32 v248, 7, v0
v_mfma_f32_16x16x32_bf16 v[70:73], a[220:223], v[154:157], v[70:73]
s_waitcnt vmcnt(11)
v_mfma_f32_16x16x32_bf16 v[74:77], a[208:211], v[158:161], v[74:77]
buffer_load_dword v255, v10, s[4:7], 0 offen sc1
buffer_load_dwordx4 v[206:209], v1, s[4:7], s92 offen offset:3072 sc1
v_mfma_f32_16x16x32_bf16 v[78:81], a[212:215], v[158:161], v[78:81]
v_lshlrev_b32 v248, 4, v248
v_mfma_f32_16x16x32_bf16 v[82:85], a[216:219], v[158:161], v[82:85]
v_lshl_add_u32 v249, v247, 10, v248
v_mfma_f32_16x16x32_bf16 v[86:89], a[220:223], v[158:161], v[86:89]
s_waitcnt vmcnt(12)
v_mfma_f32_16x16x32_bf16 v[90:93], a[208:211], v[162:165], v[90:93]
buffer_load_dwordx4 v[210:213], v1, s[4:7], s93 offen offset:3072 sc1
v_mfma_f32_16x16x32_bf16 v[94:97], a[212:215], v[162:165], v[94:97]
v_mul_u32_u24 v247, 144, v247
v_mfma_f32_16x16x32_bf16 v[98:101], a[216:219], v[162:165], v[98:101]
v_add3_u32 v251, v247, v248, s58
v_mfma_f32_16x16x32_bf16 v[102:105], a[220:223], v[162:165], v[102:105]
s_waitcnt vmcnt(12)
v_mfma_f32_16x16x32_bf16 v[12:15], a[208:211], v[166:169], v[12:15]
buffer_load_dwordx4 v[214:217], v1, s[4:7], s90 offen offset:3072 sc1
v_mfma_f32_16x16x32_bf16 v[16:19], a[212:215], v[166:169], v[16:19]
s_lshl_b32 s58, s33, 7
v_mfma_f32_16x16x32_bf16 v[20:23], a[216:219], v[166:169], v[20:23]
s_add_u32 s58, s58, s50
v_mfma_f32_16x16x32_bf16 v[24:27], a[220:223], v[166:169], v[24:27]
s_waitcnt vmcnt(12)
v_mfma_f32_16x16x32_bf16 v[58:61], a[0:3], v[170:173], v[58:61]
s_add_u32 s91, s65, 0xc03000
buffer_load_dwordx4 v[106:109], v1, s[4:7], s91 offen offset:1024 sc1
v_mfma_f32_16x16x32_bf16 v[62:65], a[4:7], v[170:173], v[62:65]
v_add_u32 v249, s58, v249
v_mfma_f32_16x16x32_bf16 v[66:69], a[8:11], v[170:173], v[66:69]
s_mov_b32 s94, 0x2000
v_mfma_f32_16x16x32_bf16 v[70:73], a[12:15], v[170:173], v[70:73]
s_waitcnt vmcnt(12)
v_mfma_f32_16x16x32_bf16 v[74:77], a[0:3], v[174:177], v[74:77]
s_add_u32 s92, s66, 0xc03000
buffer_load_dwordx4 v[110:113], v1, s[4:7], s92 offen offset:1024 sc1
v_mfma_f32_16x16x32_bf16 v[78:81], a[4:7], v[174:177], v[78:81]
v_mfma_f32_16x16x32_bf16 v[82:85], a[8:11], v[174:177], v[82:85]
v_mfma_f32_16x16x32_bf16 v[86:89], a[12:15], v[174:177], v[86:89]
s_waitcnt vmcnt(12)
v_mfma_f32_16x16x32_bf16 v[90:93], a[0:3], v[178:181], v[90:93]
s_add_u32 s93, s67, 0xc03000
buffer_load_dwordx4 v[114:117], v1, s[4:7], s93 offen offset:1024 sc1
v_mfma_f32_16x16x32_bf16 v[94:97], a[4:7], v[178:181], v[94:97]
v_mfma_f32_16x16x32_bf16 v[98:101], a[8:11], v[178:181], v[98:101]
v_mfma_f32_16x16x32_bf16 v[102:105], a[12:15], v[178:181], v[102:105]
s_waitcnt vmcnt(12)
v_mfma_f32_16x16x32_bf16 v[12:15], a[0:3], v[182:185], v[12:15]
s_add_u32 s90, s64, 0xc03000
buffer_load_dwordx4 v[118:121], v1, s[4:7], s90 offen offset:1024 sc1
v_mfma_f32_16x16x32_bf16 v[16:19], a[4:7], v[182:185], v[16:19]
v_mfma_f32_16x16x32_bf16 v[20:23], a[8:11], v[182:185], v[20:23]
v_mfma_f32_16x16x32_bf16 v[24:27], a[12:15], v[182:185], v[24:27]
s_waitcnt vmcnt(12)
v_mfma_f32_16x16x32_bf16 v[58:61], a[16:19], v[186:189], v[58:61]
s_waitcnt vmcnt(7)
ACK_178:
v_cmp_gt_u32 vcc, 13, v255
s_cbranch_vccz ACKD_179
buffer_load_dword v255, v10, s[4:7], 0 offen sc1
s_waitcnt vmcnt(0)
s_sub_u32 s39, s39, 1
s_cbranch_scc0 ACK_178
s_branch BAIL
ACKD_179:
s_add_u32 s91, s65, 0xc00000
buffer_load_dwordx4 v[122:125], v1, s[4:7], s91 offen offset:1024 sc1
v_mfma_f32_16x16x32_bf16 v[62:65], a[20:23], v[186:189], v[62:65]
v_mfma_f32_16x16x32_bf16 v[66:69], a[24:27], v[186:189], v[66:69]
v_mfma_f32_16x16x32_bf16 v[70:73], a[28:31], v[186:189], v[70:73]
v_mfma_f32_16x16x32_bf16 v[74:77], a[16:19], v[190:193], v[74:77]
buffer_load_dwordx4 v[126:129], v1, s[4:7], s91 offen offset:3072 sc1
v_mfma_f32_16x16x32_bf16 v[78:81], a[20:23], v[190:193], v[78:81]
v_mfma_f32_16x16x32_bf16 v[82:85], a[24:27], v[190:193], v[82:85]
v_mfma_f32_16x16x32_bf16 v[86:89], a[28:31], v[190:193], v[86:89]
v_mfma_f32_16x16x32_bf16 v[90:93], a[16:19], v[194:197], v[90:93]
s_add_u32 s91, s65, 0xc01000
buffer_load_dwordx4 v[130:133], v1, s[4:7], s91 offen offset:1024 sc1
v_mfma_f32_16x16x32_bf16 v[94:97], a[20:23], v[194:197], v[94:97]
v_mfma_f32_16x16x32_bf16 v[98:101], a[24:27], v[194:197], v[98:101]
v_mfma_f32_16x16x32_bf16 v[102:105], a[28:31], v[194:197], v[102:105]
v_mfma_f32_16x16x32_bf16 v[12:15], a[16:19], v[198:201], v[12:15]
s_add_u32 s91, s65, 0xc02000
buffer_load_dwordx4 v[134:137], v1, s[4:7], s91 offen offset:0 sc1
v_mfma_f32_16x16x32_bf16 v[16:19], a[20:23], v[198:201], v[16:19]
v_mfma_f32_16x16x32_bf16 v[20:23], a[24:27], v[198:201], v[20:23]
v_mfma_f32_16x16x32_bf16 v[24:27], a[28:31], v[198:201], v[24:27]
v_mfma_f32_16x16x32_bf16 v[58:61], a[32:35], v[202:205], v[58:61]
s_add_u32 s60, s49, 50176
buffer_load_dwordx4 a[132:135], v50, s[4:7], s60 offen offset:0
buffer_load_dwordx4 a[136:139], v50, s[4:7], s60 offen offset:1024
buffer_load_dwordx4 a[140:143], v50, s[4:7], s60 offen offset:2048
buffer_load_dwordx4 a[144:147], v50, s[4:7], s60 offen offset:3072
s_add_u32 s60, s49, 54272
buffer_load_dwordx4 a[148:151], v50, s[4:7], s60 offen offset:0
buffer_load_dwordx4 a[152:155], v50, s[4:7], s60 offen offset:1024
buffer_load_dwordx4 a[156:159], v50, s[4:7], s60 offen offset:2048
buffer_load_dwordx4 v[138:141], v1, s[4:7], s91 offen offset:2048 sc1
v_mfma_f32_16x16x32_bf16 v[62:65], a[36:39], v[202:205], v[62:65]
v_mfma_f32_16x16x32_bf16 v[66:69], a[40:43], v[202:205], v[66:69]
v_mfma_f32_16x16x32_bf16 v[70:73], a[44:47], v[202:205], v[70:73]
s_waitcnt vmcnt(18)
v_mfma_f32_16x16x32_bf16 v[74:77], a[32:35], v[206:209], v[74:77]
s_add_u32 s91, s65, 0xc03000
buffer_load_dwordx4 v[142:145], v1, s[4:7], s91 offen offset:0 sc1
v_mfma_f32_16x16x32_bf16 v[78:81], a[36:39], v[206:209], v[78:81]
v_mfma_f32_16x16x32_bf16 v[82:85], a[40:43], v[206:209], v[82:85]
v_mfma_f32_16x16x32_bf16 v[86:89], a[44:47], v[206:209], v[86:89]
s_waitcnt vmcnt(18)
v_mfma_f32_16x16x32_bf16 v[90:93], a[32:35], v[210:213], v[90:93]
s_add_u32 s92, s66, 0xc00000
buffer_load_dwordx4 v[146:149], v1, s[4:7], s92 offen offset:1024 sc1
v_mfma_f32_16x16x32_bf16 v[94:97], a[36:39], v[210:213], v[94:97]
v_mfma_f32_16x16x32_bf16 v[98:101], a[40:43], v[210:213], v[98:101]
v_mfma_f32_16x16x32_bf16 v[102:105], a[44:47], v[210:213], v[102:105]
s_waitcnt vmcnt(18)
v_mfma_f32_16x16x32_bf16 v[12:15], a[32:35], v[214:217], v[12:15]
buffer_load_dwordx4 v[150:153], v1, s[4:7], s92 offen offset:3072 sc1
v_mfma_f32_16x16x32_bf16 v[16:19], a[36:39], v[214:217], v[16:19]
v_mfma_f32_16x16x32_bf16 v[20:23], a[40:43], v[214:217], v[20:23]
v_mfma_f32_16x16x32_bf16 v[24:27], a[44:47], v[214:217], v[24:27]
s_waitcnt vmcnt(18)
v_mfma_f32_16x16x32_bf16 v[58:61], a[48:51], v[106:109], v[58:61]
s_add_u32 s92, s66, 0xc01000
buffer_load_dwordx4 v[154:157], v1, s[4:7], s92 offen offset:1024 sc1
v_mfma_f32_16x16x32_bf16 v[62:65], a[52:55], v[106:109], v[62:65]
v_mfma_f32_16x16x32_bf16 v[66:69], a[56:59], v[106:109], v[66:69]
v_mfma_f32_16x16x32_bf16 v[70:73], a[60:63], v[106:109], v[70:73]
s_waitcnt vmcnt(18)
v_mfma_f32_16x16x32_bf16 v[74:77], a[48:51], v[110:113], v[74:77]
s_add_u32 s92, s66, 0xc02000
buffer_load_dwordx4 v[158:161], v1, s[4:7], s92 offen offset:0 sc1
v_mfma_f32_16x16x32_bf16 v[78:81], a[52:55], v[110:113], v[78:81]
v_mfma_f32_16x16x32_bf16 v[82:85], a[56:59], v[110:113], v[82:85]
v_mfma_f32_16x16x32_bf16 v[86:89], a[60:63], v[110:113], v[86:89]
s_waitcnt vmcnt(18)
v_mfma_f32_16x16x32_bf16 v[90:93], a[48:51], v[114:117], v[90:93]
buffer_load_dwordx4 v[162:165], v1, s[4:7], s92 offen offset:2048 sc1
v_mfma_f32_16x16x32_bf16 v[94:97], a[52:55], v[114:117], v[94:97]
v_mfma_f32_16x16x32_bf16 v[98:101], a[56:59], v[114:117], v[98:101]
v_mfma_f32_16x16x32_bf16 v[102:105], a[60:63], v[114:117], v[102:105]
s_waitcnt vmcnt(18)
v_mfma_f32_16x16x32_bf16 v[12:15], a[48:51], v[118:121], v[12:15]
s_add_u32 s92, s66, 0xc03000
buffer_load_dwordx4 v[166:169], v1, s[4:7], s92 offen offset:0 sc1
v_mfma_f32_16x16x32_bf16 v[16:19], a[52:55], v[118:121], v[16:19]
v_mfma_f32_16x16x32_bf16 v[20:23], a[56:59], v[118:121], v[20:23]
v_mfma_f32_16x16x32_bf16 v[24:27], a[60:63], v[118:121], v[24:27]
s_waitcnt vmcnt(18)
v_mfma_f32_16x16x32_bf16 v[58:61], a[64:67], v[122:125], v[58:61]
s_add_u32 s93, s67, 0xc00000
buffer_load_dwordx4 v[170:173], v1, s[4:7], s93 offen offset:1024 sc1
v_mfma_f32_16x16x32_bf16 v[62:65], a[68:71], v[122:125], v[62:65]
v_mfma_f32_16x16x32_bf16 v[66:69], a[72:75], v[122:125], v[66:69]
v_mfma_f32_16x16x32_bf16 v[70:73], a[76:79], v[122:125], v[70:73]
s_waitcnt vmcnt(18)
v_mfma_f32_16x16x32_bf16 v[58:61], a[80:83], v[126:129], v[58:61]
buffer_load_dwordx4 v[174:177], v1, s[4:7], s93 offen offset:3072 sc1
v_mfma_f32_16x16x32_bf16 v[62:65], a[84:87], v[126:129], v[62:65]
v_mfma_f32_16x16x32_bf16 v[66:69], a[88:91], v[126:129], v[66:69]
v_mfma_f32_16x16x32_bf16 v[70:73], a[92:95], v[126:129], v[70:73]
s_waitcnt vmcnt(18)
v_mfma_f32_16x16x32_bf16 v[58:61], a[96:99], v[130:133], v[58:61]
s_add_u32 s93, s67, 0xc01000
buffer_load_dwordx4 v[178:181], v1, s[4:7], s93 offen offset:1024 sc1
v_mfma_f32_16x16x32_bf16 v[62:65], a[100:103], v[130:133], v[62:65]
v_mfma_f32_16x16x32_bf16 v[66:69], a[104:107], v[130:133], v[66:69]
v_mfma_f32_16x16x32_bf16 v[70:73], a[108:111], v[130:133], v[70:73]
s_waitcnt vmcnt(18)
v_mfma_f32_16x16x32_bf16 v[58:61], a[112:115], v[134:137], v[58:61]
s_add_u32 s93, s67, 0xc02000
buffer_load_dwordx4 v[182:185], v1, s[4:7], s93 offen offset:0 sc1
v_mfma_f32_16x16x32_bf16 v[62:65], a[116:119], v[134:137], v[62:65]
v_mfma_f32_16x16x32_bf16 v[66:69], a[120:123], v[134:137], v[66:69]
v_mfma_f32_16x16x32_bf16 v[70:73], a[124:127], v[134:137], v[70:73]
s_waitcnt vmcnt(16)
s_waitcnt vmcnt(11)
v_mfma_f32_16x16x32_bf16 v[58:61], a[128:131], v[138:141], v[58:61]
buffer_load_dwordx4 v[186:189], v1, s[4:7], s93 offen offset:2048 sc1
v_mfma_f32_16x16x32_bf16 v[62:65], a[132:135], v[138:141], v[62:65]
v_mfma_f32_16x16x32_bf16 v[66:69], a[136:139], v[138:141], v[66:69]
v_mfma_f32_16x16x32_bf16 v[70:73], a[140:143], v[138:141], v[70:73]
s_waitcnt vmcnt(11)
v_mfma_f32_16x16x32_bf16 v[58:61], a[144:147], v[142:145], v[58:61]
s_add_u32 s93, s67, 0xc03000
buffer_load_dwordx4 v[190:193], v1, s[4:7], s93 offen offset:0 sc1
v_mfma_f32_16x16x32_bf16 v[62:65], a[148:151], v[142:145], v[62:65]
v_mfma_f32_16x16x32_bf16 v[66:69], a[152:155], v[142:145], v[66:69]
v_mfma_f32_16x16x32_bf16 v[70:73], a[156:159], v[142:145], v[70:73]
s_waitcnt vmcnt(11)
v_mfma_f32_16x16x32_bf16 v[74:77], a[64:67], v[146:149], v[74:77]
s_add_u32 s90, s64, 0xc00000
buffer_load_dwordx4 v[194:197], v1, s[4:7], s90 offen offset:1024 sc1
v_mfma_f32_16x16x32_bf16 v[78:81], a[68:71], v[146:149], v[78:81]
v_mfma_f32_16x16x32_bf16 v[82:85], a[72:75], v[146:149], v[82:85]
ds_write_b128 v239, v[58:61] offset:0
v_mfma_f32_16x16x32_bf16 v[86:89], a[76:79], v[146:149], v[86:89]
s_waitcnt vmcnt(11)
v_mfma_f32_16x16x32_bf16 v[74:77], a[80:83], v[150:153], v[74:77]
buffer_load_dwordx4 v[198:201], v1, s[4:7], s90 offen offset:3072 sc1
v_mfma_f32_16x16x32_bf16 v[78:81], a[84:87], v[150:153], v[78:81]
v_mfma_f32_16x16x32_bf16 v[82:85], a[88:91], v[150:153], v[82:85]
ds_write_b128 v239, v[62:65] offset:1024
v_mfma_f32_16x16x32_bf16 v[86:89], a[92:95], v[150:153], v[86:89]
s_waitcnt vmcnt(11)
v_mfma_f32_16x16x32_bf16 v[74:77], a[96:99], v[154:157], v[74:77]
s_add_u32 s90, s64, 0xc01000
buffer_load_dwordx4 v[202:205], v1, s[4:7], s90 offen offset:1024 sc1
v_mfma_f32_16x16x32_bf16 v[78:81], a[100:103], v[154:157], v[78:81]
v_mfma_f32_16x16x32_bf16 v[82:85], a[104:107], v[154:157], v[82:85]
ds_write_b128 v239, v[66:69] offset:2048
v_mfma_f32_16x16x32_bf16 v[86:89], a[108:111], v[154:157], v[86:89]
s_waitcnt vmcnt(11)
v_mfma_f32_16x16x32_bf16 v[74:77], a[112:115], v[158:161], v[74:77]
s_add_u32 s90, s64, 0xc02000
buffer_load_dwordx4 v[206:209], v1, s[4:7], s90 offen offset:0 sc1
v_mfma_f32_16x16x32_bf16 v[78:81], a[116:119], v[158:161], v[78:81]
v_mfma_f32_16x16x32_bf16 v[82:85], a[120:123], v[158:161], v[82:85]
ds_write_b128 v239, v[70:73] offset:3072
v_mfma_f32_16x16x32_bf16 v[86:89], a[124:127], v[158:161], v[86:89]
s_waitcnt vmcnt(11)
v_mfma_f32_16x16x32_bf16 v[74:77], a[128:131], v[162:165], v[74:77]
buffer_load_dwordx4 v[210:213], v1, s[4:7], s90 offen offset:2048 sc1
v_mfma_f32_16x16x32_bf16 v[78:81], a[132:135], v[162:165], v[78:81]
v_mfma_f32_16x16x32_bf16 v[82:85], a[136:139], v[162:165], v[82:85]
v_mfma_f32_16x16x32_bf16 v[86:89], a[140:143], v[162:165], v[86:89]
s_waitcnt vmcnt(11)
v_mfma_f32_16x16x32_bf16 v[74:77], a[144:147], v[166:169], v[74:77]
s_add_u32 s90, s64, 0xc03000
buffer_load_dwordx4 v[214:217], v1, s[4:7], s90 offen offset:0 sc1
v_mfma_f32_16x16x32_bf16 v[78:81], a[148:151], v[166:169], v[78:81]
v_mfma_f32_16x16x32_bf16 v[82:85], a[152:155], v[166:169], v[82:85]
v_mfma_f32_16x16x32_bf16 v[86:89], a[156:159], v[166:169], v[86:89]
s_waitcnt vmcnt(11)
v_mfma_f32_16x16x32_bf16 v[90:93], a[64:67], v[170:173], v[90:93]
v_mfma_f32_16x16x32_bf16 v[94:97], a[68:71], v[170:173], v[94:97]
v_mfma_f32_16x16x32_bf16 v[98:101], a[72:75], v[170:173], v[98:101]
ds_write_b128 v240, v[74:77] offset:0
v_mfma_f32_16x16x32_bf16 v[102:105], a[76:79], v[170:173], v[102:105]
s_waitcnt vmcnt(10)
v_mfma_f32_16x16x32_bf16 v[90:93], a[80:83], v[174:177], v[90:93]
v_mfma_f32_16x16x32_bf16 v[94:97], a[84:87], v[174:177], v[94:97]
v_mfma_f32_16x16x32_bf16 v[98:101], a[88:91], v[174:177], v[98:101]
ds_write_b128 v240, v[78:81] offset:1024
v_mfma_f32_16x16x32_bf16 v[102:105], a[92:95], v[174:177], v[102:105]
s_waitcnt vmcnt(9)
v_mfma_f32_16x16x32_bf16 v[90:93], a[96:99], v[178:181], v[90:93]
v_mfma_f32_16x16x32_bf16 v[94:97], a[100:103], v[178:181], v[94:97]
v_mfma_f32_16x16x32_bf16 v[98:101], a[104:107], v[178:181], v[98:101]
ds_write_b128 v240, v[82:85] offset:2048
v_mfma_f32_16x16x32_bf16 v[102:105], a[108:111], v[178:181], v[102:105]
s_waitcnt vmcnt(8)
v_mfma_f32_16x16x32_bf16 v[90:93], a[112:115], v[182:185], v[90:93]
v_mfma_f32_16x16x32_bf16 v[94:97], a[116:119], v[182:185], v[94:97]
v_mfma_f32_16x16x32_bf16 v[98:101], a[120:123], v[182:185], v[98:101]
ds_write_b128 v240, v[86:89] offset:3072
v_mfma_f32_16x16x32_bf16 v[102:105], a[124:127], v[182:185], v[102:105]
s_waitcnt vmcnt(7)
v_mfma_f32_16x16x32_bf16 v[90:93], a[128:131], v[186:189], v[90:93]
v_mfma_f32_16x16x32_bf16 v[94:97], a[132:135], v[186:189], v[94:97]
v_mfma_f32_16x16x32_bf16 v[98:101], a[136:139], v[186:189], v[98:101]
v_mfma_f32_16x16x32_bf16 v[102:105], a[140:143], v[186:189], v[102:105]
s_waitcnt vmcnt(6)
v_mfma_f32_16x16x32_bf16 v[90:93], a[144:147], v[190:193], v[90:93]
v_mfma_f32_16x16x32_bf16 v[94:97], a[148:151], v[190:193], v[94:97]
v_mfma_f32_16x16x32_bf16 v[98:101], a[152:155], v[190:193], v[98:101]
v_mfma_f32_16x16x32_bf16 v[102:105], a[156:159], v[190:193], v[102:105]
s_waitcnt vmcnt(5)
v_mfma_f32_16x16x32_bf16 v[12:15], a[64:67], v[194:197], v[12:15]
v_mfma_f32_16x16x32_bf16 v[16:19], a[68:71], v[194:197], v[16:19]
v_mfma_f32_16x16x32_bf16 v[20:23], a[72:75], v[194:197], v[20:23]
s_nop 0
ds_write_b128 v241, v[90:93] offset:0
v_mfma_f32_16x16x32_bf16 v[24:27], a[76:79], v[194:197], v[24:27]
s_waitcnt vmcnt(4)
v_mfma_f32_16x16x32_bf16 v[12:15], a[80:83], v[198:201], v[12:15]
v_mfma_f32_16x16x32_bf16 v[16:19], a[84:87], v[198:201], v[16:19]
v_mfma_f32_16x16x32_bf16 v[20:23], a[88:91], v[198:201], v[20:23]
ds_write_b128 v241, v[94:97] offset:1024
v_mfma_f32_16x16x32_bf16 v[24:27], a[92:95], v[198:201], v[24:27]
s_waitcnt vmcnt(3)
v_mfma_f32_16x16x32_bf16 v[12:15], a[96:99], v[202:205], v[12:15]
v_mfma_f32_16x16x32_bf16 v[16:19], a[100:103], v[202:205], v[16:19]
v_mfma_f32_16x16x32_bf16 v[20:23], a[104:107], v[202:205], v[20:23]
ds_write_b128 v241, v[98:101] offset:2048
v_mfma_f32_16x16x32_bf16 v[24:27], a[108:111], v[202:205], v[24:27]
s_waitcnt vmcnt(2)
v_mfma_f32_16x16x32_bf16 v[12:15], a[112:115], v[206:209], v[12:15]
v_mfma_f32_16x16x32_bf16 v[16:19], a[116:119], v[206:209], v[16:19]
v_mfma_f32_16x16x32_bf16 v[20:23], a[120:123], v[206:209], v[20:23]
ds_write_b128 v241, v[102:105] offset:3072
v_mfma_f32_16x16x32_bf16 v[24:27], a[124:127], v[206:209], v[24:27]
s_waitcnt vmcnt(1)
v_mfma_f32_16x16x32_bf16 v[12:15], a[128:131], v[210:213], v[12:15]
v_mfma_f32_16x16x32_bf16 v[16:19], a[132:135], v[210:213], v[16:19]
v_mfma_f32_16x16x32_bf16 v[20:23], a[136:139], v[210:213], v[20:23]
v_mfma_f32_16x16x32_bf16 v[24:27], a[140:143], v[210:213], v[24:27]
s_waitcnt lgkmcnt(0)
s_barrier
ds_read_b128 v[58:61], v238 offset:0
ds_read_b128 v[62:65], v238 offset:1024
ds_read_b128 v[66:69], v238 offset:2048
ds_read_b128 v[70:73], v238 offset:3072
ds_read_b128 v[74:77], v238 offset:4096
ds_read_b128 v[78:81], v238 offset:5120
ds_read_b128 v[82:85], v238 offset:6144
ds_read_b128 v[86:89], v238 offset:7168
ds_read_b128 v[90:93], v238 offset:8192
ds_read_b128 v[94:97], v238 offset:9216
ds_read_b128 v[98:101], v238 offset:10240
ds_read_b128 v[102:105], v238 offset:11264
s_waitcnt vmcnt(0)
v_mfma_f32_16x16x32_bf16 v[12:15], a[144:147], v[214:217], v[12:15]
v_mfma_f32_16x16x32_bf16 v[16:19], a[148:151], v[214:217], v[16:19]
v_mfma_f32_16x16x32_bf16 v[20:23], a[152:155], v[214:217], v[20:23]
v_mfma_f32_16x16x32_bf16 v[24:27], a[156:159], v[214:217], v[24:27]
s_waitcnt lgkmcnt(7)
v_pk_add_f32 v[58:59], v[58:59], v[74:75]
v_pk_add_f32 v[60:61], v[60:61], v[76:77]
s_waitcnt lgkmcnt(6)
v_pk_add_f32 v[62:63], v[62:63], v[78:79]
v_pk_add_f32 v[64:65], v[64:65], v[80:81]
s_waitcnt lgkmcnt(5)
v_pk_add_f32 v[66:67], v[66:67], v[82:83]
v_pk_add_f32 v[68:69], v[68:69], v[84:85]
s_waitcnt lgkmcnt(4)
v_pk_add_f32 v[70:71], v[70:71], v[86:87]
v_pk_add_f32 v[72:73], v[72:73], v[88:89]
s_waitcnt lgkmcnt(3)
v_pk_add_f32 v[58:59], v[58:59], v[90:91]
v_pk_add_f32 v[60:61], v[60:61], v[92:93]
s_waitcnt lgkmcnt(2)
v_pk_add_f32 v[62:63], v[62:63], v[94:95]
v_pk_add_f32 v[64:65], v[64:65], v[96:97]
s_waitcnt lgkmcnt(1)
v_pk_add_f32 v[66:67], v[66:67], v[98:99]
v_pk_add_f32 v[68:69], v[68:69], v[100:101]
s_waitcnt lgkmcnt(0)
v_pk_add_f32 v[70:71], v[70:71], v[102:103]
v_pk_add_f32 v[72:73], v[72:73], v[104:105]
v_pk_add_f32 v[12:13], v[12:13], v[58:59]
v_pk_add_f32 v[14:15], v[14:15], v[60:61]
v_pk_add_f32 v[16:17], v[16:17], v[62:63]
v_pk_add_f32 v[18:19], v[18:19], v[64:65]
v_pk_add_f32 v[20:21], v[20:21], v[66:67]
v_pk_add_f32 v[22:23], v[22:23], v[68:69]
v_pk_add_f32 v[24:25], v[24:25], v[70:71]
v_pk_add_f32 v[26:27], v[26:27], v[72:73]
v_cvt_pk_bf16_f32 v106, v12, v13
v_cvt_pk_bf16_f32 v107, v14, v15
v_cvt_pk_bf16_f32 v108, v16, v17
v_cvt_pk_bf16_f32 v109, v18, v19
v_cvt_pk_bf16_f32 v110, v20, v21
v_cvt_pk_bf16_f32 v111, v22, v23
v_cvt_pk_bf16_f32 v112, v24, v25
v_cvt_pk_bf16_f32 v113, v26, v27
ds_write_b64 v250, v[106:107] offset:0
ds_write_b64 v250, v[108:109] offset:32
ds_write_b64 v250, v[110:111] offset:64
ds_write_b64 v250, v[112:113] offset:96
s_waitcnt lgkmcnt(0)
ds_read_b128 v[114:117], v251 offset:0
ds_read_b128 v[118:121], v251 offset:1152
s_waitcnt lgkmcnt(1)
buffer_store_dwordx4 v[114:117], v249, s[24:27], 0 offen
s_waitcnt lgkmcnt(0)
buffer_store_dwordx4 v[118:121], v249, s[24:27], s94 offen
PH13:
BAIL:
s_endpgm
ALT_24:
s_nop 7
s_nop 3
buffer_store_dwordx4 v[190:193], v52, s[4:7], s61 offen sc1
buffer_store_dwordx4 v[194:197], v52, s[4:7], s94 offen sc1
s_nop 7
s_branch ALTE_25
ALT_26:
s_nop 7
s_nop 3
v_mov_b32 v11, 1
s_waitcnt vmcnt(0)
s_mov_b64 exec, 1
buffer_store_dword v11, off, s[4:7], s42 sc1
s_mov_b64 exec, -1
s_nop 7
s_branch ALTE_27
ALT_30:
s_nop 7
s_nop 3
buffer_store_dwordx4 v[106:109], v1, s[4:7], s58 offen sc1
buffer_store_dwordx4 v[110:113], v1, s[4:7], s58 offen offset:1024 sc1
s_nop 7
s_branch ALTE_31
ALT_32:
s_nop 7
s_nop 3
buffer_store_dword v242, v44, s[4:7], s58 offen sc1
v_mov_b32 v11, 2
s_waitcnt vmcnt(0)
s_mov_b64 exec, 1
buffer_store_dword v11, off, s[4:7], s42 sc1
s_mov_b64 exec, -1
s_nop 7
s_branch ALTE_33
ALT_36:
s_nop 7
s_nop 3
buffer_store_dwordx4 v[106:109], v1, s[4:7], s58 offen sc1
buffer_store_dwordx4 v[110:113], v1, s[4:7], s58 offen offset:1024 sc1
s_nop 7
s_branch ALTE_37
ALT_38:
s_nop 7
s_nop 3
v_mov_b32 v11, 3
s_cmp_eq_u32 s38, 0
s_cbranch_scc1 EXP_40
buffer_store_dwordx4 v[106:109], v1, s[4:7], s61 offen sc1
buffer_store_dwordx4 v[110:113], v1, s[4:7], s61 offen offset:1024 sc1
s_waitcnt vmcnt(2)
s_branch EXW_41
EXP_40:
s_waitcnt vmcnt(0)
EXW_41:
s_mov_b64 exec, 1
buffer_store_dword v11, off, s[4:7], s42 sc1
s_mov_b64 exec, -1
s_nop 7
s_branch ALTE_39
ALT_47:
s_nop 7
s_nop 3
buffer_store_dwordx4 v[106:109], v1, s[4:7], s58 offen sc1
buffer_store_dwordx4 v[110:113], v1, s[4:7], s58 offen offset:1024 sc1
s_nop 7
s_branch ALTE_48
ALT_49:
s_nop 7
s_nop 3
buffer_store_dword v242, v44, s[4:7], s58 offen sc1
v_mov_b32 v11, 4
s_waitcnt vmcnt(0)
s_mov_b64 exec, 1
buffer_store_dword v11, off, s[4:7], s42 sc1
s_mov_b64 exec, -1
s_nop 7
s_branch ALTE_50
ALT_57:
s_nop 7
s_nop 3
buffer_store_dwordx4 v[218:221], v243, s[4:7], s95 offen offset:0 sc1
s_nop 7
s_branch ALTE_58
ALT_59:
s_nop 7
s_nop 3
buffer_store_dwordx4 v[222:225], v243, s[4:7], s95 offen offset:512 sc1
s_nop 7
s_branch ALTE_60
ALT_61:
s_nop 7
s_nop 3
buffer_store_dwordx4 v[218:221], v243, s[4:7], s94 offen offset:0 sc1
s_nop 7
s_branch ALTE_62
ALT_63:
s_nop 7
s_nop 3
buffer_store_dwordx4 v[222:225], v243, s[4:7], s94 offen offset:512 sc1
s_nop 7
s_branch ALTE_64
ALT_66:
s_nop 7
s_nop 3
v_mov_b32 v11, 5
s_mov_b64 exec, 1
buffer_store_dword v11, off, s[4:7], s42 sc1
s_mov_b64 exec, -1
s_nop 7
s_branch ALTE_67
ALT_68:
s_nop 7
s_nop 3
buffer_store_dwordx4 v[218:221], v53, s[4:7], s58 offen offset:0 sc1
s_nop 7
s_branch ALTE_69
ALT_70:
s_nop 7
s_nop 3
buffer_store_dwordx4 v[222:225], v53, s[4:7], s58 offen offset:512 sc1
s_nop 7
s_branch ALTE_71
ALT_72:
s_nop 7
s_nop 3
buffer_store_dwordx4 v[218:221], v53, s[4:7], s58 offen offset:0 sc1
s_nop 7
s_branch ALTE_73
ALT_74:
s_nop 7
s_nop 3
buffer_store_dwordx4 v[222:225], v53, s[4:7], s58 offen offset:512 sc1
s_nop 7
s_branch ALTE_75
ALT_81:
s_nop 7
s_nop 3
buffer_store_dwordx4 v[218:221], v243, s[4:7], s95 offen offset:0 sc1
s_nop 7
s_branch ALTE_82
ALT_83:
s_nop 7
s_nop 3
buffer_store_dwordx4 v[222:225], v243, s[4:7], s95 offen offset:512 sc1
s_nop 7
s_branch ALTE_84
ALT_85:
s_nop 7
s_nop 3
buffer_store_dwordx4 v[218:221], v243, s[4:7], s94 offen offset:0 sc1
s_nop 7
s_branch ALTE_86
ALT_87:
s_nop 7
s_nop 3
buffer_store_dwordx4 v[222:225], v243, s[4:7], s94 offen offset:512 sc1
s_nop 7
s_branch ALTE_88
ALT_89:
s_nop 7
s_nop 3
v_mov_b32 v11, 6
s_waitcnt vmcnt(0)
s_mov_b64 exec, 1
buffer_store_dword v11, off, s[4:7], s42 sc1
s_mov_b64 exec, -1
s_nop 7
s_branch ALTE_90
ALT_93:
s_nop 7
s_nop 3
v_mov_b32 v11, 6
s_waitcnt vmcnt(5)
s_mov_b64 exec, 1
buffer_store_dword v11, off, s[4:7], s42 sc1
s_mov_b64 exec, -1
s_nop 7
s_branch ALTE_94
ALT_97:
s_nop 7
s_nop 3
buffer_store_dwordx4 v[106:109], v246, s[4:7], s58 offen sc1
buffer_store_dwordx4 v[110:113], v246, s[4:7], s58 offen offset:1024 sc1
s_nop 7
s_branch ALTE_98
ALT_99:
s_nop 7
s_nop 3
buffer_store_dword v242, v44, s[4:7], s94 offen sc1
v_mov_b32 v11, 7
s_cmp_eq_u32 s37, 0
s_cbranch_scc1 EXP_101
buffer_store_dwordx4 v[106:109], v246, s[4:7], s61 offen sc1
buffer_store_dwordx4 v[110:113], v246, s[4:7], s61 offen offset:1024 sc1
buffer_store_dword v242, v44, s[4:7], s59 offen sc1
s_waitcnt vmcnt(3)
s_branch EXW_102
EXP_101:
s_waitcnt vmcnt(0)
EXW_102:
s_mov_b64 exec, 1
buffer_store_dword v11, off, s[4:7], s42 sc1
s_mov_b64 exec, -1
s_nop 7
s_branch ALTE_100
ALT_109:
s_nop 7
s_nop 3
buffer_store_dwordx4 v[190:193], v52, s[4:7], s61 offen sc1
buffer_store_dwordx4 v[194:197], v52, s[4:7], s94 offen sc1
s_nop 7
s_branch ALTE_110
ALT_111:
s_nop 7
s_nop 3
v_mov_b32 v11, 8
s_waitcnt vmcnt(0)
s_mov_b64 exec, 1
buffer_store_dword v11, off, s[4:7], s42 sc1
s_mov_b64 exec, -1
s_nop 7
s_branch ALTE_112
ALT_115:
s_nop 7
s_nop 3
buffer_store_dwordx4 v[106:109], v1, s[4:7], s58 offen sc1
buffer_store_dwordx4 v[110:113], v1, s[4:7], s58 offen offset:1024 sc1
s_nop 7
s_branch ALTE_116
ALT_117:
s_nop 7
s_nop 3
buffer_store_dword v242, v44, s[4:7], s58 offen sc1
v_mov_b32 v11, 9
s_waitcnt vmcnt(0)
s_mov_b64 exec, 1
buffer_store_dword v11, off, s[4:7], s42 sc1
s_mov_b64 exec, -1
s_nop 7
s_branch ALTE_118
ALT_121:
s_nop 7
s_nop 3
buffer_store_dwordx4 v[106:109], v1, s[4:7], s58 offen sc1
buffer_store_dwordx4 v[110:113], v1, s[4:7], s58 offen offset:1024 sc1
s_nop 7
s_branch ALTE_122
ALT_123:
s_nop 7
s_nop 3
v_mov_b32 v11, 10
s_cmp_eq_u32 s38, 0
s_cbranch_scc1 EXP_125
buffer_store_dwordx4 v[106:109], v1, s[4:7], s61 offen sc1
buffer_store_dwordx4 v[110:113], v1, s[4:7], s61 offen offset:1024 sc1
s_waitcnt vmcnt(2)
s_branch EXW_126
EXP_125:
s_waitcnt vmcnt(0)
EXW_126:
s_mov_b64 exec, 1
buffer_store_dword v11, off, s[4:7], s42 sc1
s_mov_b64 exec, -1
s_nop 7
s_branch ALTE_124
ALT_132:
s_nop 7
s_nop 3
buffer_store_dwordx4 v[106:109], v1, s[4:7], s58 offen sc1
buffer_store_dwordx4 v[110:113], v1, s[4:7], s58 offen offset:1024 sc1
s_nop 7
s_branch ALTE_133
ALT_134:
s_nop 7
s_nop 3
buffer_store_dword v242, v44, s[4:7], s58 offen sc1
v_mov_b32 v11, 11
s_waitcnt vmcnt(0)
s_mov_b64 exec, 1
buffer_store_dword v11, off, s[4:7], s42 sc1
s_mov_b64 exec, -1
s_nop 7
s_branch ALTE_135
ALT_142:
s_nop 7
s_nop 3
buffer_store_dwordx4 v[218:221], v243, s[4:7], s95 offen offset:0 sc1
s_nop 7
s_branch ALTE_143
ALT_144:
s_nop 7
s_nop 3
buffer_store_dwordx4 v[222:225], v243, s[4:7], s95 offen offset:512 sc1
s_nop 7
s_branch ALTE_145
ALT_146:
s_nop 7
s_nop 3
buffer_store_dwordx4 v[218:221], v243, s[4:7], s94 offen offset:0 sc1
s_nop 7
s_branch ALTE_147
ALT_148:
s_nop 7
s_nop 3
buffer_store_dwordx4 v[222:225], v243, s[4:7], s94 offen offset:512 sc1
s_nop 7
s_branch ALTE_149
ALT_150:
s_nop 7
s_nop 3
buffer_store_dwordx4 v[218:221], v53, s[4:7], s58 offen offset:0 sc1
s_nop 7
s_branch ALTE_151
ALT_152:
s_nop 7
s_nop 3
buffer_store_dwordx4 v[222:225], v53, s[4:7], s58 offen offset:512 sc1
s_nop 7
s_branch ALTE_153
ALT_154:
s_nop 7
s_nop 3
v_mov_b32 v11, 12
s_waitcnt vmcnt(17)
s_mov_b64 exec, 1
buffer_store_dword v11, off, s[4:7], s42 sc1
s_mov_b64 exec, -1
s_nop 7
s_branch ALTE_155
ALT_156:
s_nop 7
s_nop 3
buffer_store_dwordx4 v[218:221], v53, s[4:7], s58 offen offset:0 sc1
s_nop 7
s_branch ALTE_157
ALT_158:
s_nop 7
s_nop 3
buffer_store_dwordx4 v[222:225], v53, s[4:7], s58 offen offset:512 sc1
s_nop 7
s_branch ALTE_159
ALT_164:
s_nop 7
s_nop 3
buffer_store_dwordx4 v[218:221], v243, s[4:7], s95 offen offset:0 sc1
s_nop 7
s_branch ALTE_165
ALT_166:
s_nop 7
s_nop 3
buffer_store_dwordx4 v[222:225], v243, s[4:7], s95 offen offset:512 sc1
s_nop 7
s_branch ALTE_167
ALT_168:
s_nop 7
s_nop 3
buffer_store_dwordx4 v[218:221], v243, s[4:7], s94 offen offset:0 sc1
s_nop 7
s_branch ALTE_169
ALT_170:
s_nop 7
s_nop 3
buffer_store_dwordx4 v[222:225], v243, s[4:7], s94 offen offset:512 sc1
s_nop 7
s_branch ALTE_171
ALT_172:
s_nop 7
s_nop 3
v_mov_b32 v11, 13
s_waitcnt vmcnt(0)
s_mov_b64 exec, 1
buffer_store_dword v11, off, s[4:7], s42 sc1
s_mov_b64 exec, -1
s_nop 7
s_branch ALTE_173
ALT_176:
s_nop 7
s_nop 3
v_mov_b32 v11, 13
s_waitcnt vmcnt(5)
s_mov_b64 exec, 1
buffer_store_dword v11, off, s[4:7], s42 sc1
s_mov_b64 exec, -1
s_nop 7
s_branch ALTE_177

.section .rodata,"a"
.p2align 6
.amdhsa_kernel interleave_layers__sliding_local_dilated__mixer_s_mlp__prompt_kernel
  .amdhsa_next_free_vgpr 512
  .amdhsa_next_free_sgpr 102
  .amdhsa_accum_offset 256
  .amdhsa_group_segment_fixed_size 0
  .amdhsa_kernarg_size 88
  .amdhsa_user_sgpr_count 2
  .amdhsa_user_sgpr_kernarg_segment_ptr 1
  .amdhsa_system_sgpr_workgroup_id_x 1
  .amdhsa_float_denorm_mode_32 3
.end_amdhsa_kernel
.text
```
